```python
import torch

def _softmax(x, axis=-1):
    return torch.softmax(x, dim=axis)
def _gelu(x):
    return torch.nn.functional.gelu(x, approximate="tanh")
def _silu(x):
    return torch.nn.functional.silu(x)
def _sigmoid(x):
    return torch.sigmoid(x)
def _layernorm(x, axis=-1, eps=1e-5):
    m = x.mean(dim=axis, keepdim=True)
    v = x.var(dim=axis, keepdim=True, unbiased=False)
    return (x - m) / torch.sqrt(v + eps)
def _scatter_add(tgt, idx, src, axis=0):
    return tgt.clone().index_add_(axis, idx, src)
def _segment_sum(src, seg, n):
    out = torch.zeros((n,) + src.shape[1:], dtype=src.dtype)
    return out.index_add_(0, seg, src)
def _pad(x, pw):
    flat = tuple(v for pair in reversed(pw) for v in pair)
    return torch.nn.functional.pad(x, flat)

kernel_name = 'gated_mix__ssm_conv_s5__dense_activation_silu__prompt'

def setup_inputs():

    _w = (lambda a: (lambda t: t.to(torch.bfloat16) if t.is_floating_point() else t)(torch.as_tensor(a)))
    def _A_setup():
        B, S, D = 1, 2048, 640
        P = D
        Lambda_re = -0.5 * (lambda _x: torch.exp(torch.as_tensor(_x)))((lambda *s: torch.randn(*s, dtype=torch.bfloat16) * 0.2)(P))
        Lambda_im = (lambda *s: torch.randn(*s, dtype=torch.bfloat16) * 0.4)(P) * 1.0
        B_re = (lambda *s: torch.randn(*s, dtype=torch.bfloat16) * 0.2)(P, D) * (D ** -0.5)
        B_im = (lambda *s: torch.randn(*s, dtype=torch.bfloat16) * 0.2)(P, D) * (D ** -0.5)
        C_re = (lambda *s: torch.randn(*s, dtype=torch.bfloat16) * 0.2)(D, P) * (P ** -0.5)
        C_im = (lambda *s: torch.randn(*s, dtype=torch.bfloat16) * 0.2)(D, P) * (P ** -0.5)
        log_dt = (lambda *s: torch.randn(*s, dtype=torch.bfloat16) * 0.2)(P) * 0.3 - 2.0
        Dskip = (lambda *s: torch.randn(*s, dtype=torch.bfloat16) * 0.05)(D)
        return {
            "x": _w((lambda *s: torch.randn(*s, dtype=torch.bfloat16) * 0.05)(B, S, D)),
            "Lambda_re": _w(Lambda_re),
            "Lambda_im": _w(Lambda_im),
            "B_re": _w(B_re),
            "B_im": _w(B_im),
            "C_re": _w(C_re),
            "C_im": _w(C_im),
            "log_dt": _w(log_dt),
            "Dskip": _w(Dskip),
        }
    _A_in = _A_setup()

    def _B_setup():
        B, S, D, F = 1, 2048, 640, 1536
        return {
            "x": _w((lambda *s: torch.randn(*s, dtype=torch.bfloat16) * 0.05)(B, S, D)),
            "w1": _w((lambda *s: torch.randn(*s, dtype=torch.bfloat16) * 3.2)(D, F) * (D ** -0.5)),
            "w2": _w((lambda *s: torch.randn(*s, dtype=torch.bfloat16) * 0.1)(F, D) * (F ** -0.5)),
        }
    _B_in = _B_setup()

    return {
        "A_x": _A_in["x"],
        "A_Lambda_re": _A_in["Lambda_re"],
        "A_Lambda_im": _A_in["Lambda_im"],
        "A_B_re": _A_in["B_re"],
        "A_B_im": _A_in["B_im"],
        "A_C_re": _A_in["C_re"],
        "A_C_im": _A_in["C_im"],
        "A_log_dt": _A_in["log_dt"],
        "A_Dskip": _A_in["Dskip"],
        "B_x": _B_in["x"],
        "B_w1": _B_in["w1"],
        "B_w2": _B_in["w2"],
        "gate_w": _w((lambda *s: torch.randn(*s, dtype=torch.bfloat16) * 0.05)(640) * 16.0),
    }

def reference(A_x, A_Lambda_re, A_Lambda_im, A_B_re, A_B_im, A_C_re, A_C_im, A_log_dt, A_Dskip, B_x, B_w1, B_w2, gate_w):
    def _A_ref(x, Lambda_re, Lambda_im, B_re, B_im, C_re, C_im, log_dt, Dskip):
        Bsz, L, H = x.shape
        Lam = Lambda_re + 1j * Lambda_im
        Bmat = B_re + 1j * B_im
        Cmat = C_re + 1j * C_im
        dt = torch.exp(log_dt)
        Lam_bar = torch.exp(dt * Lam)
        B_bar = ((Lam_bar - 1.0) / Lam)[:, None] * Bmat
        Bu = torch.einsum("bld,pd->blp", x + 0j, B_bar)
        h = torch.zeros_like(Bu[:, 0, :])
        hs = []
        for t in range(L):
            h = Lam_bar[None, :] * h + Bu[:, t, :]
            hs.append(h)
        hseq = torch.stack(hs, 1)
        y = 2.0 * torch.einsum("blp,dp->bld", hseq, Cmat).real + x * Dskip[None, None, :]
        return y

    def _B_ref(x, w1, w2):
        h = torch.einsum("bsd,df->bsf", x, w1)
        h = _silu(h)
        out = torch.einsum("bsf,fd->bsd", h, w2)
        return out

    x = A_x
    g = _sigmoid((x * gate_w).sum(-1, keepdims=True))
    a = _A_ref(x, A_Lambda_re, A_Lambda_im, A_B_re, A_B_im, A_C_re, A_C_im, A_log_dt, A_Dskip)
    b = _B_ref(x, B_w1, B_w2)
    return g * a + (1 - g) * b
```

```asm
; @launch grid=(256,1,1) block=(256,1,1) lds=163840
.amdgcn_target "amdgcn-amd-amdhsa--gfx950"
.text
.globl gated_mix__ssm_conv_s5__dense_activation_silu__prompt_kernel
.p2align 8
.type gated_mix__ssm_conv_s5__dense_activation_silu__prompt_kernel,@function
gated_mix__ssm_conv_s5__dense_activation_silu__prompt_kernel:
    s_cmp_ge_u32 s2, 256
    s_cbranch_scc1 L_exit
    s_getpc_b64 s[30:31]
    v_min_u32 v6, 15, v0
    v_lshlrev_b32 v6, 7, v6
    global_load_dword v243, v6, s[30:31]
    s_load_dwordx16 s[40:55], s[0:1], 0
    s_load_dwordx16 s[56:71], s[0:1], 64
    v_lshrrev_b32 v4, 6, v0
    v_and_b32 v1, 63, v0
    v_readfirstlane_b32 s72, v4
    v_lshlrev_b32 v2, 4, v1
    s_lshr_b32 s99, s2, 3
    s_getpc_b64 s[28:29]
L_pca:
    s_lshr_b32 s98, s2, 3
    s_lshl_b32 s98, s98, 2
    s_add_u32 s98, s98, s72
    s_and_b32 s98, s98, 63
    s_min_u32 s98, s98, ((L_codeend-L_pca)>>10)-1
    s_lshl_b32 s98, s98, 10
    s_add_u32 s28, s28, s98
    s_addc_u32 s29, s29, 0
    global_load_dwordx4 v[244:247], v2, s[28:29]
    v_add_u32 v3, 0x1000, v2
    s_bfe_u32 s101, s2, 0x20001
    s_lshr_b32 s100, s101, 1
    s_xor_b32 s101, s101, s100
    s_and_b32 s100, s99, 3
    s_and_b32 s73, s2, 1
    s_lshr_b32 s75, s99, 2
    s_lshl_b32 s74, s101, 2
    s_add_u32 s74, s74, s100
    s_lshl_b32 s76, s101, 3
    s_add_u32 s76, s76, s75
    s_lshl_b32 s76, s76, 2
    s_add_u32 s76, s76, s100
    s_mul_i32 s100, s100, 3
    s_mul_i32 s98, s73, 5
    s_add_u32 s79, s75, s100
    s_add_u32 s79, s79, s98
    s_add_u32 s79, s79, s101
    s_mul_i32 s79, s101, 5
    s_add_u32 s79, s79, 1
    s_lshr_b32 s79, s79, 1
    s_add_u32 s79, s79, s98
    s_add_u32 s98, s74, s75
    s_and_b32 s98, s98, 3
    s_add_u32 s79, s79, s98
    s_sub_u32 s98, s79, 10
    s_min_u32 s79, s79, s98
    s_sub_u32 s98, s79, 10
    s_min_u32 s79, s79, s98
    s_lshl_b32 s80, s79, 7
    v_lshrrev_b32 v4, 3, v1
    v_and_b32 v5, 7, v1
    v_lshrrev_b32 v6, 4, v1
    s_mov_b32 s6, 0x280000
    s_mov_b32 s7, 0x20000
    s_mov_b32 s14, 0x1700000
    s_mov_b32 s15, 0x20000
    s_cmp_eq_u32 s73, 0
    s_cbranch_scc0 L_ffn
L_ssm:
    s_lshl_b32 s98, s74, 2
    s_add_u32 s98, s98, s72
    s_mul_i32 s98, s98, 40960
    v_lshrrev_b32 v7, 5, v1
    v_and_b32 v8, 1, v4
    v_lshl_add_u32 v7, v7, 1, v8
    v_and_b32 v8, 1, v6
    v_lshl_add_u32 v7, v7, 2, v8
    v_mul_u32_u24 v7, 1280, v7
    v_xor_b32 v8, v5, v6
    v_lshlrev_b32 v8, 4, v8
    v_xor_b32 v9, 64, v8
    v_add3_u32 v140, v8, v7, s98
    v_add3_u32 v9, v9, v7, s98
    v_add_u32 v141, 19456, v9
    v_add_u32 v142, 512, v140
    v_add_u32 v143, 19968, v9
    s_and_b32 s99, s72, 1
    s_lshl_b32 s98, s75, 1
    s_add_u32 s98, s98, s99
    s_mul_i32 s98, s98, 51200
    s_lshl_b32 s99, s99, 6
    v_xor_b32 v8, s99, v8
    v_xor_b32 v9, 64, v8
    v_mul_u32_u24 v7, 1280, v4
    v_add3_u32 v144, v8, v7, s98
    v_add3_u32 v9, v9, v7, s98
    v_add_u32 v145, 9216, v9
    v_add_u32 v146, 18432, v144
    v_add_u32 v147, 27648, v9
    v_add_u32 v148, 40960, v144
    s_lshl_b32 s91, s72, 14
    s_mul_i32 s92, s72, 5120
    s_add_u32 s92, s92, 65536
    s_mov_b32 s10, 0xc8000
    s_mov_b32 s11, 0x20000
    s_sub_u32 s98, s80, 1152
    s_add_u32 s81, s80, 128
    s_min_u32 s81, s81, s98
    s_mul_i32 s98, s75, 160
    v_mul_u32_u24 v216, 13, v1
    v_lshrrev_b32 v216, 8, v216
    v_mul_u32_u24 v155, 20, v216
    v_sub_u32 v155, v1, v155
    s_mul_i32 s99, s72, 20
    v_add_u32 v155, s99, v155
    v_lshl_add_u32 v10, v155, 1, s98
    s_waitcnt lgkmcnt(0)
    s_mov_b32 s4, s40
    s_mov_b32 s5, s41
    s_cmp_lt_u32 s72, 2
    s_cselect_b32 s8, s46, s48
    s_cselect_b32 s9, s47, s49
    s_add_u32 m0, s91, 0
    s_nop 0
    buffer_load_dwordx4 v140, s[4:7], s80 offen offset:0 lds
    buffer_load_dwordx4 v141, s[4:7], s80 offen offset:1024 lds
    buffer_load_dwordx4 v142, s[4:7], s80 offen offset:2048 lds
    buffer_load_dwordx4 v143, s[4:7], s80 offen offset:3072 lds
    s_add_u32 m0, s92, 0
    s_nop 0
    buffer_load_dwordx4 v144, s[8:11], s80 offen offset:0 lds
    buffer_load_dwordx4 v145, s[8:11], s80 offen offset:1024 lds
    buffer_load_dwordx4 v146, s[8:11], s80 offen offset:2048 lds
    buffer_load_dwordx4 v147, s[8:11], s80 offen offset:3072 lds
    s_add_u32 m0, s92, 4096
    s_nop 0
    buffer_load_dwordx4 v148, s[8:11], s80 offen lds
    global_load_ushort v160, v10, s[42:43]
    global_load_ushort v161, v10, s[44:45]
    global_load_ushort v162, v10, s[54:55]
    s_mov_b32 s12, s70
    s_mov_b32 s13, s71
    s_load_dword s78, s[70:71], 0
    s_add_u32 m0, s91, 4096
    s_nop 0
    buffer_load_dwordx4 v140, s[4:7], s81 offen offset:0 lds
    buffer_load_dwordx4 v141, s[4:7], s81 offen offset:1024 lds
    buffer_load_dwordx4 v142, s[4:7], s81 offen offset:2048 lds
    buffer_load_dwordx4 v143, s[4:7], s81 offen offset:3072 lds
    s_branch L_ssm2
L_ffn:
    s_lshl_b32 s98, s74, 2
    s_add_u32 s98, s98, s72
    s_mul_i32 s98, s98, 40960
    v_mul_u32_u24 v7, 1280, v4
    v_xor_b32 v8, v5, v6
    v_lshlrev_b32 v8, 4, v8
    v_xor_b32 v9, 64, v8
    v_add3_u32 v144, v8, v7, s98
    v_add3_u32 v9, v9, v7, s98
    v_add_u32 v145, 9216, v9
    v_add_u32 v146, 18432, v144
    v_add_u32 v147, 27648, v9
    v_and_b32 v7, 1, v6
    v_lshlrev_b32 v7, 2, v7
    v_xor_b32 v7, v5, v7
    v_mul_u32_u24 v8, 3072, v4
    v_lshl_add_u32 v7, v7, 4, v8
    s_mul_i32 s98, s72, 49152
    v_add_u32 v148, s98, v7
    v_add_u32 v149, 23552, v148
    s_mul_i32 s91, s72, 20480
    s_lshl_b32 s92, s72, 11
    s_mul_i32 s93, s75, 384
    s_mov_b32 s10, 0x1e0000
    s_mov_b32 s11, 0x20000
    s_mov_b32 s79, s80
    s_waitcnt lgkmcnt(0)
    s_mov_b32 s4, s40
    s_mov_b32 s5, s41
    s_mov_b32 s8, s60
    s_mov_b32 s9, s61
    s_add_u32 m0, s91, 0
    s_nop 0
    buffer_load_dwordx4 v144, s[4:7], s80 offen offset:0 lds
    buffer_load_dwordx4 v145, s[4:7], s80 offen offset:1024 lds
    buffer_load_dwordx4 v146, s[4:7], s80 offen offset:2048 lds
    buffer_load_dwordx4 v147, s[4:7], s80 offen offset:3072 lds
    s_add_u32 m0, s92, 81920
    s_mul_i32 s80, s80, 1536
    s_add_u32 s80, s80, s93
    buffer_load_dwordx4 v148, s[8:11], s80 offen lds
    buffer_load_dwordx4 v149, s[8:11], s80 offen offset:1024 lds
    s_sub_u32 s98, s79, 1152
    s_add_u32 s81, s79, 128
    s_min_u32 s81, s81, s98
    s_sub_u32 s98, s79, 1024
    s_add_u32 s82, s79, 256
    s_min_u32 s82, s82, s98
    s_sub_u32 s98, s79, 896
    s_add_u32 s83, s79, 384
    s_min_u32 s83, s83, s98
    s_sub_u32 s98, s79, 768
    s_add_u32 s84, s79, 512
    s_min_u32 s84, s84, s98
    s_sub_u32 s98, s79, 640
    s_add_u32 s85, s79, 640
    s_min_u32 s85, s85, s98
    s_sub_u32 s98, s79, 512
    s_add_u32 s86, s79, 768
    s_min_u32 s86, s86, s98
    s_sub_u32 s98, s79, 384
    s_add_u32 s87, s79, 896
    s_min_u32 s87, s87, s98
    s_sub_u32 s98, s79, 256
    s_add_u32 s88, s79, 1024
    s_min_u32 s88, s88, s98
    s_sub_u32 s98, s79, 128
    s_add_u32 s89, s79, 1152
    s_min_u32 s89, s89, s98
    s_add_u32 m0, s91, 4096
    s_nop 0
    buffer_load_dwordx4 v144, s[4:7], s81 offen offset:0 lds
    buffer_load_dwordx4 v145, s[4:7], s81 offen offset:1024 lds
    buffer_load_dwordx4 v146, s[4:7], s81 offen offset:2048 lds
    buffer_load_dwordx4 v147, s[4:7], s81 offen offset:3072 lds
    s_add_u32 m0, s92, 90112
    s_mul_i32 s81, s81, 1536
    s_add_u32 s81, s81, s93
    buffer_load_dwordx4 v148, s[8:11], s81 offen lds
    buffer_load_dwordx4 v149, s[8:11], s81 offen offset:1024 lds
    s_mov_b32 s12, s70
    s_mov_b32 s13, s71
    s_load_dword s78, s[70:71], 0
    s_lshl_b32 s98, s73, 7
    s_add_u32 s98, s98, s76
    s_lshl_b32 s98, s98, 2
    s_add_u32 s98, s98, s72
    s_lshl_b32 s98, s98, 7
    s_add_u32 s98, s98, 327680
    v_mov_b32 v250, s98
    s_add_u32 s99, s98, 0x20000
    v_writelane_b32 v250, s99, 1
    s_add_u32 s99, s98, 0x40000
    v_writelane_b32 v250, s99, 2
    s_add_u32 s99, s98, 0x30000
    v_writelane_b32 v250, s99, 3
    s_add_u32 s99, s98, 0xa0000
    v_writelane_b32 v250, s99, 4
    s_add_u32 s99, s98, 0x70000
    v_writelane_b32 v250, s99, 5
    s_add_u32 s99, s98, 0x60000
    v_writelane_b32 v250, s99, 6
    s_add_u32 s99, s98, 0x90000
    v_writelane_b32 v250, s99, 7
    s_mul_i32 s98, s74, 720896
    s_add_u32 s98, s98, 0x500000
    v_writelane_b32 v250, s98, 32
    s_add_u32 s98, s98, 393088
    v_writelane_b32 v250, s98, 33
    s_mul_i32 s98, s75, 450560
    s_add_u32 s98, s98, 0x130000
    v_writelane_b32 v250, s98, 34
    s_add_u32 s98, s98, 245632
    v_writelane_b32 v250, s98, 35
    s_mul_i32 s98, s76, 20480
    s_add_u32 s98, s98, 0x1001000
    v_writelane_b32 v250, s98, 36
    s_add_u32 s98, s98, 2621440
    v_writelane_b32 v250, s98, 37
    buffer_load_dword v251, v250, s[12:15], 0 offen sc1
    s_mul_i32 s98, s74, 327680
    s_add_u32 s98, s98, 0
    v_and_b32 v249, 1, v1
    v_mul_u32_u24 v249, 161280, v249
    v_add_u32 v249, s98, v249
    global_load_dword v241, v249, s[66:67]
    v_and_b32 v7, 31, v1
    v_bfe_u32 v8, v1, 1, 3
    v_lshrrev_b32 v11, 5, v1
    v_xor_b32 v8, v8, v11
    v_lshlrev_b32 v8, 4, v8
    v_lshl_add_u32 v8, v7, 7, v8
    v_add_u32 v150, s91, v8
    v_xor_b32 v151, 32, v150
    v_xor_b32 v152, 64, v150
    v_xor_b32 v153, 96, v150
    v_bfe_u32 v8, v1, 2, 2
    v_lshl_add_u32 v10, v11, 3, v8
    v_lshlrev_b32 v10, 7, v10
    v_lshrrev_b32 v8, 1, v8
    v_lshl_add_u32 v10, v8, 6, v10
    v_bfe_u32 v8, v1, 4, 1
    v_lshl_add_u32 v10, v8, 5, v10
    v_and_b32 v8, 3, v1
    v_lshl_add_u32 v10, v8, 3, v10
    v_add_u32 v154, 81920, v10
    v_xor_b32 v155, 64, v154
    s_add_u32 m0, s91, 8192
    s_nop 0
    buffer_load_dwordx4 v144, s[4:7], s82 offen offset:0 lds
    buffer_load_dwordx4 v145, s[4:7], s82 offen offset:1024 lds
    buffer_load_dwordx4 v146, s[4:7], s82 offen offset:2048 lds
    buffer_load_dwordx4 v147, s[4:7], s82 offen offset:3072 lds
    s_add_u32 m0, s92, 98304
    s_mul_i32 s82, s82, 1536
    s_add_u32 s82, s82, s93
    buffer_load_dwordx4 v148, s[8:11], s82 offen lds
    buffer_load_dwordx4 v149, s[8:11], s82 offen offset:1024 lds
    s_add_u32 m0, s91, 12288
    s_nop 0
    buffer_load_dwordx4 v144, s[4:7], s83 offen offset:0 lds
    buffer_load_dwordx4 v145, s[4:7], s83 offen offset:1024 lds
    buffer_load_dwordx4 v146, s[4:7], s83 offen offset:2048 lds
    buffer_load_dwordx4 v147, s[4:7], s83 offen offset:3072 lds
    s_add_u32 m0, s92, 106496
    s_mul_i32 s83, s83, 1536
    s_add_u32 s83, s83, s93
    buffer_load_dwordx4 v148, s[8:11], s83 offen lds
    buffer_load_dwordx4 v149, s[8:11], s83 offen offset:1024 lds
    s_waitcnt vmcnt(20)
    s_barrier
    ds_read_b128 a[0:3], v150 offset:0
    ds_read_b64_tr_b16 v[80:81], v154 offset:0
    ds_read_b64_tr_b16 v[82:83], v154 offset:512
    s_add_u32 m0, s91, 16384
    ds_read_b64_tr_b16 v[84:85], v155 offset:0
    ds_read_b64_tr_b16 v[86:87], v155 offset:512
    ds_read_b128 a[4:7], v151 offset:0
    buffer_load_dwordx4 v144, s[4:7], s84 offen offset:0 lds
    buffer_load_dwordx4 v145, s[4:7], s84 offen offset:1024 lds
    ds_read_b64_tr_b16 v[88:89], v154 offset:2048
    ds_read_b64_tr_b16 v[90:91], v154 offset:2560
    ds_read_b128 a[8:11], v152 offset:0
    buffer_load_dwordx4 v146, s[4:7], s84 offen offset:2048 lds
    buffer_load_dwordx4 v147, s[4:7], s84 offen offset:3072 lds
    ds_read_b64_tr_b16 v[92:93], v155 offset:2048
    ds_read_b64_tr_b16 v[94:95], v155 offset:2560
    ds_read_b128 a[12:15], v153 offset:0
    s_add_u32 m0, s92, 114688
    s_mul_i32 s84, s84, 1536
    ds_read_b64_tr_b16 v[96:97], v154 offset:4096
    ds_read_b64_tr_b16 v[98:99], v154 offset:4608
    s_add_u32 s84, s84, s93
    buffer_load_dwordx4 v148, s[8:11], s84 offen lds
    ds_read_b64_tr_b16 v[100:101], v155 offset:4096
    ds_read_b64_tr_b16 v[102:103], v155 offset:4608
    buffer_load_dwordx4 v149, s[8:11], s84 offen offset:1024 lds
    ds_read_b64_tr_b16 v[104:105], v154 offset:6144
    ds_read_b64_tr_b16 v[106:107], v154 offset:6656
    ds_read_b64_tr_b16 v[108:109], v155 offset:6144
    ds_read_b64_tr_b16 v[110:111], v155 offset:6656
    s_waitcnt lgkmcnt(0)
    v_mfma_f32_32x32x16_bf16 v[16:31], v[80:83], a[0:3], 0
    s_waitcnt vmcnt(20)
    s_barrier
    ds_read_b128 a[16:19], v150 offset:4096
    ds_read_b64_tr_b16 v[112:113], v154 offset:8192
    ds_read_b64_tr_b16 v[114:115], v154 offset:8704
    s_lshl_b32 s90, s72, 7
    s_add_u32 s90, s90, s76
    s_mov_b32 s24, s70
    s_mov_b32 s25, s71
    v_mfma_f32_32x32x16_bf16 v[32:47], v[84:87], a[0:3], 0
    s_add_u32 m0, s91, 0
    ds_read_b64_tr_b16 v[116:117], v155 offset:8192
    ds_read_b64_tr_b16 v[118:119], v155 offset:8704
    ds_read_b128 a[20:23], v151 offset:4096
    s_mov_b32 s16, s62
    s_mov_b32 s17, s63
    s_cmp_lt_u32 s90, 480
    s_cselect_b32 s26, 0x1700000, 0
    s_cselect_b32 s18, 1966080, 0
    v_mfma_f32_32x32x16_bf16 v[16:31], v[88:91], a[4:7], v[16:31]
    buffer_load_dwordx4 v144, s[4:7], s85 offen offset:0 lds
    buffer_load_dwordx4 v145, s[4:7], s85 offen offset:1024 lds
    ds_read_b64_tr_b16 v[80:81], v154 offset:10240
    ds_read_b64_tr_b16 v[82:83], v154 offset:10752
    ds_read_b128 a[24:27], v152 offset:4096
    s_mov_b32 s27, 0x20000
    s_mov_b32 s19, 0x20000
    s_mul_i32 s99, s90, 6554
    v_mfma_f32_32x32x16_bf16 v[32:47], v[92:95], a[4:7], v[32:47]
    buffer_load_dwordx4 v146, s[4:7], s85 offen offset:2048 lds
    buffer_load_dwordx4 v147, s[4:7], s85 offen offset:3072 lds
    ds_read_b64_tr_b16 v[84:85], v155 offset:10240
    ds_read_b64_tr_b16 v[86:87], v155 offset:10752
    ds_read_b128 a[28:31], v153 offset:4096
    s_lshr_b32 s99, s99, 16
    s_mul_i32 s100, s99, 10
    s_sub_u32 s100, s90, s100
    s_lshl_b32 s101, s100, 7
    v_mfma_f32_32x32x16_bf16 v[16:31], v[96:99], a[8:11], v[16:31]
    s_add_u32 m0, s92, 122880
    s_mul_i32 s85, s85, 1536
    ds_read_b64_tr_b16 v[88:89], v154 offset:12288
    ds_read_b64_tr_b16 v[90:91], v154 offset:12800
    s_mul_i32 s90, s99, 40960
    s_add_u32 s90, s90, s101
    s_mul_i32 s99, s99, 5
    v_mfma_f32_32x32x16_bf16 v[32:47], v[100:103], a[8:11], v[32:47]
    s_add_u32 s85, s85, s93
    buffer_load_dwordx4 v148, s[8:11], s85 offen lds
    ds_read_b64_tr_b16 v[92:93], v155 offset:12288
    ds_read_b64_tr_b16 v[94:95], v155 offset:12800
    s_lshl_b32 s100, s100, 2
    s_add_u32 s94, s100, 0
    s_mul_i32 s101, s94, 52
    s_lshr_b32 s101, s101, 8
    v_mfma_f32_32x32x16_bf16 v[16:31], v[104:107], a[12:15], v[16:31]
    buffer_load_dwordx4 v149, s[8:11], s85 offen offset:1024 lds
    ds_read_b64_tr_b16 v[96:97], v154 offset:14336
    ds_read_b64_tr_b16 v[98:99], v154 offset:14848
    s_mul_i32 s101, s101, 435
    s_add_u32 s94, s94, s101
    s_add_u32 s94, s94, s99
    s_lshl_b32 s94, s94, 10
    v_mfma_f32_32x32x16_bf16 v[32:47], v[108:111], a[12:15], v[32:47]
    ds_read_b64_tr_b16 v[100:101], v155 offset:14336
    ds_read_b64_tr_b16 v[102:103], v155 offset:14848
    s_add_u32 s94, s94, 0x130000
    s_add_u32 s95, s100, 1
    s_mul_i32 s101, s95, 52
    s_lshr_b32 s101, s101, 8
    s_waitcnt lgkmcnt(9)
    v_mfma_f32_32x32x16_bf16 v[16:31], v[112:115], a[16:19], v[16:31]
    s_waitcnt vmcnt(18) lgkmcnt(8)
    s_barrier
    ds_read_b128 a[32:35], v150 offset:8192
    ds_read_b64_tr_b16 v[104:105], v154 offset:16384
    ds_read_b64_tr_b16 v[106:107], v154 offset:16896
    s_mul_i32 s101, s101, 435
    s_add_u32 s95, s95, s101
    s_add_u32 s95, s95, s99
    s_lshl_b32 s95, s95, 10
    v_mfma_f32_32x32x16_bf16 v[32:47], v[116:119], a[16:19], v[32:47]
    s_add_u32 m0, s91, 4096
    ds_read_b64_tr_b16 v[108:109], v155 offset:16384
    ds_read_b64_tr_b16 v[110:111], v155 offset:16896
    ds_read_b128 a[36:39], v151 offset:8192
    s_add_u32 s95, s95, 0x130000
    s_add_u32 s96, s100, 2
    s_mul_i32 s101, s96, 52
    s_lshr_b32 s101, s101, 8
    v_mfma_f32_32x32x16_bf16 v[16:31], v[80:83], a[20:23], v[16:31]
    buffer_load_dwordx4 v144, s[4:7], s86 offen offset:0 lds
    buffer_load_dwordx4 v145, s[4:7], s86 offen offset:1024 lds
    ds_read_b64_tr_b16 v[112:113], v154 offset:18432
    ds_read_b64_tr_b16 v[114:115], v154 offset:18944
    ds_read_b128 a[40:43], v152 offset:8192
    s_mul_i32 s101, s101, 435
    s_add_u32 s96, s96, s101
    s_add_u32 s96, s96, s99
    v_mfma_f32_32x32x16_bf16 v[32:47], v[84:87], a[20:23], v[32:47]
    buffer_load_dwordx4 v146, s[4:7], s86 offen offset:2048 lds
    buffer_load_dwordx4 v147, s[4:7], s86 offen offset:3072 lds
    ds_read_b64_tr_b16 v[116:117], v155 offset:18432
    ds_read_b64_tr_b16 v[118:119], v155 offset:18944
    ds_read_b128 a[44:47], v153 offset:8192
    s_lshl_b32 s96, s96, 10
    s_add_u32 s96, s96, 0x130000
    s_add_u32 s97, s100, 3
    s_mul_i32 s101, s97, 52
    s_waitcnt lgkmcnt(12)
    v_mfma_f32_32x32x16_bf16 v[16:31], v[88:91], a[24:27], v[16:31]
    s_add_u32 m0, s92, 131072
    s_mul_i32 s86, s86, 1536
    ds_read_b64_tr_b16 v[80:81], v154 offset:20480
    ds_read_b64_tr_b16 v[82:83], v154 offset:20992
    s_lshr_b32 s101, s101, 8
    s_mul_i32 s101, s101, 435
    s_add_u32 s97, s97, s101
    s_add_u32 s97, s97, s99
    v_mfma_f32_32x32x16_bf16 v[32:47], v[92:95], a[24:27], v[32:47]
    s_add_u32 s86, s86, s93
    buffer_load_dwordx4 v148, s[8:11], s86 offen lds
    ds_read_b64_tr_b16 v[84:85], v155 offset:20480
    ds_read_b64_tr_b16 v[86:87], v155 offset:20992
    s_lshl_b32 s97, s97, 10
    s_add_u32 s97, s97, 0x130000
    v_bfe_u32 v8, v1, 4, 1
    v_lshlrev_b32 v8, 11, v8
    v_mfma_f32_32x32x16_bf16 v[16:31], v[96:99], a[28:31], v[16:31]
    buffer_load_dwordx4 v149, s[8:11], s86 offen offset:1024 lds
    ds_read_b64_tr_b16 v[88:89], v154 offset:22528
    ds_read_b64_tr_b16 v[90:91], v154 offset:23040
    v_lshrrev_b32 v9, 5, v1
    v_lshl_add_u32 v8, v9, 9, v8
    v_bfe_u32 v9, v1, 2, 2
    v_mfma_f32_32x32x16_bf16 v[32:47], v[100:103], a[28:31], v[32:47]
    ds_read_b64_tr_b16 v[92:93], v155 offset:22528
    ds_read_b64_tr_b16 v[94:95], v155 offset:23040
    v_lshl_add_u32 v8, v9, 7, v8
    v_and_b32 v9, 3, v1
    v_lshl_add_u32 v8, v9, 3, v8
    s_waitcnt lgkmcnt(9)
    v_mfma_f32_32x32x16_bf16 v[16:31], v[104:107], a[32:35], v[16:31]
    s_waitcnt vmcnt(18) lgkmcnt(8)
    s_barrier
    ds_read_b128 a[48:51], v150 offset:12288
    ds_read_b64_tr_b16 v[96:97], v154 offset:24576
    ds_read_b64_tr_b16 v[98:99], v154 offset:25088
    s_lshl_b32 s101, s72, 12
    s_add_u32 s101, s101, 147456
    v_add_u32 v157, s101, v8
    s_mov_b32 s43, s101
    v_mfma_f32_32x32x16_bf16 v[32:47], v[108:111], a[32:35], v[32:47]
    s_add_u32 m0, s91, 8192
    ds_read_b64_tr_b16 v[100:101], v155 offset:24576
    ds_read_b64_tr_b16 v[102:103], v155 offset:25088
    ds_read_b128 a[52:55], v151 offset:12288
    v_lshrrev_b32 v8, 3, v1
    v_and_b32 v9, 7, v1
    v_mul_u32_u24 v8, 1280, v8
    v_lshl_add_u32 v158, v9, 4, v8
    v_mfma_f32_32x32x16_bf16 v[16:31], v[112:115], a[36:39], v[16:31]
    buffer_load_dwordx4 v144, s[4:7], s87 offen offset:0 lds
    buffer_load_dwordx4 v145, s[4:7], s87 offen offset:1024 lds
    ds_read_b64_tr_b16 v[104:105], v154 offset:26624
    ds_read_b64_tr_b16 v[106:107], v154 offset:27136
    ds_read_b128 a[56:59], v152 offset:12288
    s_mul_i32 s78, s78, 1664525
    s_add_u32 s78, s78, 1013904223
    v_mov_b32 v253, s78
    v_mfma_f32_32x32x16_bf16 v[32:47], v[116:119], a[36:39], v[32:47]
    buffer_load_dwordx4 v146, s[4:7], s87 offen offset:2048 lds
    buffer_load_dwordx4 v147, s[4:7], s87 offen offset:3072 lds
    ds_read_b64_tr_b16 v[108:109], v155 offset:26624
    ds_read_b64_tr_b16 v[110:111], v155 offset:27136
    ds_read_b128 a[60:63], v153 offset:12288
    s_mov_b32 s28, s66
    s_mov_b32 s29, s67
    s_mov_b32 s30, 0x500000
    s_mov_b32 s31, 0x20000
    s_waitcnt lgkmcnt(12)
    v_mfma_f32_32x32x16_bf16 v[16:31], v[80:83], a[40:43], v[16:31]
    s_add_u32 m0, s92, 139264
    s_mul_i32 s87, s87, 1536
    ds_read_b64_tr_b16 v[112:113], v154 offset:28672
    ds_read_b64_tr_b16 v[114:115], v154 offset:29184
    s_mul_i32 s79, s75, 450560
    s_add_u32 s79, s79, 0x130000
    s_add_u32 s32, s70, s79
    s_addc_u32 s33, s71, 0
    v_mfma_f32_32x32x16_bf16 v[32:47], v[84:87], a[40:43], v[32:47]
    s_add_u32 s87, s87, s93
    buffer_load_dwordx4 v148, s[8:11], s87 offen lds
    ds_read_b64_tr_b16 v[116:117], v155 offset:28672
    ds_read_b64_tr_b16 v[118:119], v155 offset:29184
    s_mov_b32 s34, 0x6e000
    s_mov_b32 s35, 0x20000
    s_mul_i32 s79, s74, 720896
    s_add_u32 s79, s79, 0x500000
    v_mfma_f32_32x32x16_bf16 v[16:31], v[88:91], a[44:47], v[16:31]
    buffer_load_dwordx4 v149, s[8:11], s87 offen offset:1024 lds
    ds_read_b64_tr_b16 v[80:81], v154 offset:30720
    ds_read_b64_tr_b16 v[82:83], v154 offset:31232
    s_add_u32 s36, s70, s79
    s_addc_u32 s37, s71, 0
    s_mov_b32 s38, 0xb0000
    v_mfma_f32_32x32x16_bf16 v[32:47], v[92:95], a[44:47], v[32:47]
    ds_read_b64_tr_b16 v[84:85], v155 offset:30720
    ds_read_b64_tr_b16 v[86:87], v155 offset:31232
    s_mov_b32 s39, 0x20000
    s_mul_i32 s79, s75, 5
    s_lshr_b32 s79, s79, 2
    v_min_u32 v5, 23, v1
    s_waitcnt lgkmcnt(9)
    v_mfma_f32_32x32x16_bf16 v[16:31], v[96:99], a[48:51], v[16:31]
    s_waitcnt vmcnt(18) lgkmcnt(8)
    s_barrier
    ds_read_b128 a[64:67], v150 offset:16384
    ds_read_b64_tr_b16 v[88:89], v154 offset:32768
    ds_read_b64_tr_b16 v[90:91], v154 offset:33280
    v_lshrrev_b32 v4, 1, v5
    v_mul_u32_u24 v4, 10, v4
    v_and_b32 v5, 1, v5
    v_add3_u32 v4, v4, v5, s79
    v_mfma_f32_32x32x16_bf16 v[32:47], v[100:103], a[48:51], v[32:47]
    s_add_u32 m0, s91, 12288
    ds_read_b64_tr_b16 v[92:93], v155 offset:32768
    ds_read_b64_tr_b16 v[94:95], v155 offset:33280
    ds_read_b128 a[68:71], v151 offset:16384
    s_mul_i32 s79, s72, 120
    v_add_u32 v4, s79, v4
    v_and_b32 v5, 127, v4
    v_mfma_f32_32x32x16_bf16 v[16:31], v[104:107], a[52:55], v[16:31]
    buffer_load_dwordx4 v144, s[4:7], s88 offen offset:0 lds
    buffer_load_dwordx4 v145, s[4:7], s88 offen offset:1024 lds
    ds_read_b64_tr_b16 v[96:97], v154 offset:34816
    ds_read_b64_tr_b16 v[98:99], v154 offset:35328
    ds_read_b128 a[72:75], v152 offset:16384
    v_lshrrev_b32 v4, 7, v4
    v_lshlrev_b32 v5, 9, v5
    v_lshl_add_u32 v159, v4, 7, v5
    v_add_u32 v159, 786432, v159
    v_mfma_f32_32x32x16_bf16 v[32:47], v[108:111], a[52:55], v[32:47]
    buffer_load_dwordx4 v146, s[4:7], s88 offen offset:2048 lds
    buffer_load_dwordx4 v147, s[4:7], s88 offen offset:3072 lds
    ds_read_b64_tr_b16 v[100:101], v155 offset:34816
    ds_read_b64_tr_b16 v[102:103], v155 offset:35328
    ds_read_b128 a[76:79], v153 offset:16384
    s_lshl_b32 s79, s73, 7
    s_add_u32 s79, s79, s76
    s_lshl_b32 s79, s79, 2
    s_add_u32 s79, s79, s72
    s_lshl_b32 s79, s79, 7
    s_add_u32 s79, s79, 720896
    v_mov_b32 v254, s79
    s_waitcnt lgkmcnt(12)
    v_mfma_f32_32x32x16_bf16 v[16:31], v[112:115], a[56:59], v[16:31]
    s_add_u32 m0, s92, 81920
    s_mul_i32 s88, s88, 1536
    ds_read_b64_tr_b16 v[104:105], v154 offset:36864
    ds_read_b64_tr_b16 v[106:107], v154 offset:37376
    s_lshl_b32 s79, s72, 11
    s_mul_i32 s101, s75, 49152
    v_mfma_f32_32x32x16_bf16 v[32:47], v[116:119], a[56:59], v[32:47]
    s_add_u32 s88, s88, s93
    buffer_load_dwordx4 v148, s[8:11], s88 offen lds
    ds_read_b64_tr_b16 v[108:109], v155 offset:36864
    ds_read_b64_tr_b16 v[110:111], v155 offset:37376
    s_add_u32 s79, s79, s101
    s_add_u32 s79, s79, 0x0
    v_mfma_f32_32x32x16_bf16 v[16:31], v[80:83], a[60:63], v[16:31]
    buffer_load_dwordx4 v149, s[8:11], s88 offen offset:1024 lds
    s_mov_b32 m0, s43
    s_nop 0
    buffer_load_dwordx4 v158, s[16:19], s90 offen offset:0 nt lds
    s_add_u32 s90, s90, 9216
    buffer_load_dwordx4 v158, s[16:19], s90 offen offset:1024 nt lds
    s_add_u32 s90, s90, 9216
    buffer_load_dwordx4 v158, s[16:19], s90 offen offset:2048 nt lds
    s_add_u32 s90, s90, 9216
    buffer_load_dwordx4 v158, s[16:19], s90 offen offset:3072 nt lds
    ds_read_b64_tr_b16 v[112:113], v154 offset:38912
    ds_read_b64_tr_b16 v[114:115], v154 offset:39424
    v_mfma_f32_32x32x16_bf16 v[32:47], v[84:87], a[60:63], v[32:47]
    ds_read_b64_tr_b16 v[116:117], v155 offset:38912
    ds_read_b64_tr_b16 v[118:119], v155 offset:39424
    v_bfe_u32 v4, v1, 4, 1
    v_lshlrev_b32 v4, 10, v4
    s_waitcnt lgkmcnt(9)
    v_mfma_f32_32x32x16_bf16 v[16:31], v[88:91], a[64:67], v[16:31]
    s_waitcnt vmcnt(22) lgkmcnt(8)
    s_barrier
    ds_read_b128 a[80:83], v150 offset:0
    ds_read_b64_tr_b16 v[80:81], v154 offset:40960
    ds_read_b64_tr_b16 v[82:83], v154 offset:41472
    v_lshl_add_u32 v4, v11, 9, v4
    v_and_b32 v5, 15, v1
    v_lshl_add_u32 v4, v5, 4, v4
    v_mfma_f32_32x32x16_bf16 v[32:47], v[92:95], a[64:67], v[32:47]
    s_add_u32 m0, s91, 16384
    ds_read_b64_tr_b16 v[84:85], v155 offset:40960
    ds_read_b64_tr_b16 v[86:87], v155 offset:41472
    ds_read_b128 a[84:87], v151 offset:0
    v_add_u32 v184, s79, v4
    s_mov_b32 s42, 0xbfb8aa3b
    v_mfma_f32_32x32x16_bf16 v[16:31], v[96:99], a[68:71], v[16:31]
    buffer_load_dwordx4 v144, s[4:7], s89 offen offset:0 lds
    buffer_load_dwordx4 v145, s[4:7], s89 offen offset:1024 lds
    ds_read_b64_tr_b16 v[88:89], v154 offset:43008
    ds_read_b64_tr_b16 v[90:91], v154 offset:43520
    ds_read_b128 a[88:91], v152 offset:0
    s_add_u32 s45, s74, s75
    s_mul_i32 s59, s72, 12
    s_mul_i32 s58, s45, 43
    v_mfma_f32_32x32x16_bf16 v[32:47], v[100:103], a[68:71], v[32:47]
    buffer_load_dwordx4 v146, s[4:7], s89 offen offset:2048 lds
    buffer_load_dwordx4 v147, s[4:7], s89 offen offset:3072 lds
    ds_read_b64_tr_b16 v[92:93], v155 offset:43008
    ds_read_b64_tr_b16 v[94:95], v155 offset:43520
    ds_read_b128 a[92:95], v153 offset:0
    s_lshr_b32 s58, s58, 8
    s_mul_i32 s58, s58, 6
    s_waitcnt lgkmcnt(12)
    v_mfma_f32_32x32x16_bf16 v[16:31], v[104:107], a[72:75], v[16:31]
    s_add_u32 m0, s92, 90112
    s_mul_i32 s89, s89, 1536
    ds_read_b64_tr_b16 v[96:97], v154 offset:45056
    ds_read_b64_tr_b16 v[98:99], v154 offset:45568
    s_sub_u32 s58, s45, s58
    s_add_u32 s60, s58, 0
    s_sub_u32 s79, s60, 6
    v_mfma_f32_32x32x16_bf16 v[32:47], v[108:111], a[72:75], v[32:47]
    s_add_u32 s89, s89, s93
    buffer_load_dwordx4 v148, s[8:11], s89 offen lds
    ds_read_b64_tr_b16 v[100:101], v155 offset:45056
    ds_read_b64_tr_b16 v[102:103], v155 offset:45568
    s_min_u32 s60, s60, s79
    s_mul_i32 s79, s60, 11
    v_mfma_f32_32x32x16_bf16 v[16:31], v[112:115], a[76:79], v[16:31]
    buffer_load_dwordx4 v149, s[8:11], s89 offen offset:1024 lds
    ds_read_b64_tr_b16 v[104:105], v154 offset:47104
    ds_read_b64_tr_b16 v[106:107], v154 offset:47616
    s_lshr_b32 s79, s79, 5
    s_mul_i32 s79, s79, 3
    s_add_u32 s60, s60, s79
    v_mfma_f32_32x32x16_bf16 v[32:47], v[116:119], a[76:79], v[32:47]
    ds_read_b64_tr_b16 v[108:109], v155 offset:47104
    ds_read_b64_tr_b16 v[110:111], v155 offset:47616
    s_add_u32 s60, s60, s59
    s_mul_i32 s40, s60, 5120
    s_lshl_b32 s60, s60, 13
    s_waitcnt lgkmcnt(9)
    v_mfma_f32_32x32x16_bf16 v[16:31], v[80:83], a[80:83], v[16:31]
    s_waitcnt vmcnt(22) lgkmcnt(8)
    s_barrier
    ds_read_b128 a[96:99], v150 offset:4096
    ds_read_b64_tr_b16 v[112:113], v154 offset:49152
    ds_read_b64_tr_b16 v[114:115], v154 offset:49664
    s_add_u32 s61, s58, 1
    s_sub_u32 s79, s61, 6
    v_mfma_f32_32x32x16_bf16 v[32:47], v[84:87], a[80:83], v[32:47]
    s_add_u32 m0, s92, 98304
    ds_read_b64_tr_b16 v[116:117], v155 offset:49152
    ds_read_b64_tr_b16 v[118:119], v155 offset:49664
    ds_read_b128 a[100:103], v151 offset:4096
    s_min_u32 s61, s61, s79
    s_mul_i32 s79, s61, 11
    s_lshr_b32 s79, s79, 5
    v_mfma_f32_32x32x16_bf16 v[16:31], v[88:91], a[84:87], v[16:31]
    v_add_u32 v148, 128, v148
    v_add_u32 v149, 128, v149
    ds_read_b64_tr_b16 v[80:81], v154 offset:51200
    ds_read_b64_tr_b16 v[82:83], v154 offset:51712
    ds_read_b128 a[104:107], v152 offset:4096
    s_mul_i32 s79, s79, 3
    s_add_u32 s61, s61, s79
    v_mfma_f32_32x32x16_bf16 v[32:47], v[92:95], a[84:87], v[32:47]
    buffer_load_dwordx4 v148, s[8:11], s80 offen lds
    buffer_load_dwordx4 v149, s[8:11], s80 offen offset:1024 lds
    ds_read_b64_tr_b16 v[84:85], v155 offset:51200
    ds_read_b64_tr_b16 v[86:87], v155 offset:51712
    ds_read_b128 a[108:111], v153 offset:4096
    s_add_u32 s61, s61, s59
    s_mul_i32 s41, s61, 5120
    s_lshl_b32 s61, s61, 13
    s_waitcnt lgkmcnt(12)
    v_mfma_f32_32x32x16_bf16 v[16:31], v[96:99], a[88:91], v[16:31]
    s_add_u32 m0, s92, 106496
    s_nop 0
    buffer_load_dwordx4 v148, s[8:11], s81 offen lds
    ds_read_b64_tr_b16 v[88:89], v154 offset:53248
    ds_read_b64_tr_b16 v[90:91], v154 offset:53760
    s_add_u32 s62, s58, 2
    s_sub_u32 s79, s62, 6
    v_mfma_f32_32x32x16_bf16 v[32:47], v[100:103], a[88:91], v[32:47]
    buffer_load_dwordx4 v149, s[8:11], s81 offen offset:1024 lds
    ds_read_b64_tr_b16 v[92:93], v155 offset:53248
    ds_read_b64_tr_b16 v[94:95], v155 offset:53760
    s_min_u32 s62, s62, s79
    s_mul_i32 s79, s62, 11
    s_lshr_b32 s79, s79, 5
    v_mfma_f32_32x32x16_bf16 v[16:31], v[104:107], a[92:95], v[16:31]
    ds_read_b64_tr_b16 v[96:97], v154 offset:55296
    ds_read_b64_tr_b16 v[98:99], v154 offset:55808
    s_mul_i32 s79, s79, 3
    s_add_u32 s62, s62, s79
    s_add_u32 s62, s62, s59
    s_mul_i32 s46, s62, 5120
    v_mfma_f32_32x32x16_bf16 v[32:47], v[108:111], a[92:95], v[32:47]
    ds_read_b64_tr_b16 v[100:101], v155 offset:55296
    ds_read_b64_tr_b16 v[102:103], v155 offset:55808
    s_lshl_b32 s62, s62, 13
    s_add_u32 s63, s58, 3
    s_sub_u32 s79, s63, 6
    s_waitcnt lgkmcnt(9)
    v_mfma_f32_32x32x16_bf16 v[16:31], v[112:115], a[96:99], v[16:31]
    s_waitcnt vmcnt(20) lgkmcnt(8)
    s_barrier
    ds_read_b128 a[112:115], v150 offset:8192
    ds_read_b64_tr_b16 v[104:105], v154 offset:57344
    ds_read_b64_tr_b16 v[106:107], v154 offset:57856
    s_min_u32 s63, s63, s79
    v_mfma_f32_32x32x16_bf16 v[32:47], v[116:119], a[96:99], v[32:47]
    s_add_u32 m0, s92, 114688
    ds_read_b64_tr_b16 v[108:109], v155 offset:57344
    ds_read_b64_tr_b16 v[110:111], v155 offset:57856
    ds_read_b128 a[116:119], v151 offset:8192
    s_mul_i32 s79, s63, 11
    s_lshr_b32 s79, s79, 5
    v_mfma_f32_32x32x16_bf16 v[16:31], v[80:83], a[100:103], v[16:31]
    buffer_load_dwordx4 v148, s[8:11], s82 offen lds
    buffer_load_dwordx4 v149, s[8:11], s82 offen offset:1024 lds
    ds_read_b64_tr_b16 v[112:113], v154 offset:59392
    ds_read_b64_tr_b16 v[114:115], v154 offset:59904
    ds_read_b128 a[120:123], v152 offset:8192
    s_mul_i32 s79, s79, 3
    s_add_u32 s63, s63, s79
    s_add_u32 s63, s63, s59
    v_mfma_f32_32x32x16_bf16 v[32:47], v[84:87], a[100:103], v[32:47]
    s_add_u32 m0, s92, 122880
    s_nop 0
    buffer_load_dwordx4 v148, s[8:11], s83 offen lds
    ds_read_b64_tr_b16 v[116:117], v155 offset:59392
    ds_read_b64_tr_b16 v[118:119], v155 offset:59904
    ds_read_b128 a[124:127], v153 offset:8192
    s_mul_i32 s47, s63, 5120
    s_lshl_b32 s63, s63, 13
    s_waitcnt lgkmcnt(12)
    v_mfma_f32_32x32x16_bf16 v[16:31], v[88:91], a[104:107], v[16:31]
    buffer_load_dwordx4 v149, s[8:11], s83 offen offset:1024 lds
    ds_read_b64_tr_b16 v[80:81], v154 offset:61440
    ds_read_b64_tr_b16 v[82:83], v154 offset:61952
    s_add_u32 s66, s58, 4
    s_sub_u32 s79, s66, 6
    s_min_u32 s66, s66, s79
    v_mfma_f32_32x32x16_bf16 v[32:47], v[92:95], a[104:107], v[32:47]
    ds_read_b64_tr_b16 v[84:85], v155 offset:61440
    ds_read_b64_tr_b16 v[86:87], v155 offset:61952
    s_mul_i32 s79, s66, 11
    s_lshr_b32 s79, s79, 5
    s_mul_i32 s79, s79, 3
    s_add_u32 s66, s66, s79
    v_mfma_f32_32x32x16_bf16 v[16:31], v[96:99], a[108:111], v[16:31]
    ds_read_b64_tr_b16 v[88:89], v154 offset:63488
    ds_read_b64_tr_b16 v[90:91], v154 offset:64000
    s_add_u32 s66, s66, s59
    s_mul_i32 s48, s66, 5120
    s_lshl_b32 s66, s66, 13
    s_add_u32 s67, s58, 5
    v_mfma_f32_32x32x16_bf16 v[32:47], v[100:103], a[108:111], v[32:47]
    ds_read_b64_tr_b16 v[92:93], v155 offset:63488
    ds_read_b64_tr_b16 v[94:95], v155 offset:64000
    s_sub_u32 s79, s67, 6
    s_min_u32 s67, s67, s79
    s_mul_i32 s79, s67, 11
    s_waitcnt lgkmcnt(9)
    v_mfma_f32_32x32x16_bf16 v[16:31], v[104:107], a[112:115], v[16:31]
    s_waitcnt vmcnt(18) lgkmcnt(8)
    s_barrier
    ds_read_b128 a[128:131], v150 offset:12288
    ds_read_b64_tr_b16 v[96:97], v154 offset:0
    ds_read_b64_tr_b16 v[98:99], v154 offset:512
    s_lshr_b32 s79, s79, 5
    v_mfma_f32_32x32x16_bf16 v[32:47], v[108:111], a[112:115], v[32:47]
    s_add_u32 m0, s92, 131072
    ds_read_b64_tr_b16 v[100:101], v155 offset:0
    ds_read_b64_tr_b16 v[102:103], v155 offset:512
    ds_read_b128 a[132:135], v151 offset:12288
    s_mul_i32 s79, s79, 3
    s_add_u32 s67, s67, s79
    v_mfma_f32_32x32x16_bf16 v[16:31], v[112:115], a[116:119], v[16:31]
    buffer_load_dwordx4 v148, s[8:11], s84 offen lds
    buffer_load_dwordx4 v149, s[8:11], s84 offen offset:1024 lds
    ds_read_b64_tr_b16 v[104:105], v154 offset:2048
    ds_read_b64_tr_b16 v[106:107], v154 offset:2560
    ds_read_b128 a[136:139], v152 offset:12288
    s_add_u32 s67, s67, s59
    v_mfma_f32_32x32x16_bf16 v[32:47], v[116:119], a[116:119], v[32:47]
    s_waitcnt vmcnt(16)
    ds_read_b64_tr_b16 a[240:241], v157 offset:0
    ds_read_b64_tr_b16 v[108:109], v155 offset:2048
    ds_read_b64_tr_b16 v[110:111], v155 offset:2560
    ds_read_b128 a[140:143], v153 offset:12288
    s_mul_i32 s49, s67, 5120
    s_lshl_b32 s67, s67, 13
    s_add_u32 s79, s45, 6
    s_waitcnt lgkmcnt(13)
    v_mfma_f32_32x32x16_bf16 v[16:31], v[80:83], a[120:123], v[16:31]
    ds_read_b64_tr_b16 a[242:243], v157 offset:1024
    ds_read_b64_tr_b16 a[244:245], v157 offset:32
    ds_read_b64_tr_b16 v[112:113], v154 offset:4096
    ds_read_b64_tr_b16 v[114:115], v154 offset:4608
    s_and_b32 s79, s79, 1
    s_mul_i32 s79, s79, 6
    v_mfma_f32_32x32x16_bf16 v[32:47], v[84:87], a[120:123], v[32:47]
    ds_read_b64_tr_b16 a[246:247], v157 offset:1056
    ds_read_b64_tr_b16 a[248:249], v157 offset:64
    ds_read_b64_tr_b16 v[116:117], v155 offset:4096
    ds_read_b64_tr_b16 v[118:119], v155 offset:4608
    s_add_u32 s68, s79, 3
    s_add_u32 s68, s68, s59
    s_mul_i32 s50, s68, 5120
    v_mfma_f32_32x32x16_bf16 v[16:31], v[88:91], a[124:127], v[16:31]
    ds_read_b64_tr_b16 a[250:251], v157 offset:1088
    ds_read_b64_tr_b16 a[252:253], v157 offset:96
    ds_read_b64_tr_b16 v[80:81], v154 offset:6144
    ds_read_b64_tr_b16 v[82:83], v154 offset:6656
    s_lshl_b32 s68, s68, 13
    s_add_u32 s79, s45, 7
    v_mfma_f32_32x32x16_bf16 v[32:47], v[92:95], a[124:127], v[32:47]
    ds_read_b64_tr_b16 a[254:255], v157 offset:1120
    ds_read_b64_tr_b16 v[84:85], v155 offset:6144
    ds_read_b64_tr_b16 v[86:87], v155 offset:6656
    s_and_b32 s79, s79, 1
    s_mul_i32 s79, s79, 6
    s_add_u32 s69, s79, 3
    s_waitcnt lgkmcnt(15)
    v_mfma_f32_32x32x16_bf16 v[16:31], v[96:99], a[128:131], v[16:31]
    s_waitcnt vmcnt(10)
    s_barrier
    ds_read_b128 a[144:147], v150 offset:16384
    ds_read_b64_tr_b16 v[88:89], v154 offset:8192
    ds_read_b64_tr_b16 v[90:91], v154 offset:8704
    s_add_u32 s69, s69, s59
    s_mul_i32 s51, s69, 5120
    v_mfma_f32_32x32x16_bf16 v[32:47], v[100:103], a[128:131], v[32:47]
    s_add_u32 m0, s92, 139264
    ds_read_b64_tr_b16 v[92:93], v155 offset:8192
    ds_read_b64_tr_b16 v[94:95], v155 offset:8704
    ds_read_b128 a[148:151], v151 offset:16384
    s_lshl_b32 s69, s69, 13
    s_add_u32 s79, s45, 8
    s_and_b32 s70, s79, 1
    v_mfma_f32_32x32x16_bf16 v[16:31], v[104:107], a[132:135], v[16:31]
    buffer_load_dwordx4 v148, s[8:11], s85 offen lds
    buffer_load_dwordx4 v149, s[8:11], s85 offen offset:1024 lds
    ds_read_b64_tr_b16 v[96:97], v154 offset:10240
    ds_read_b64_tr_b16 v[98:99], v154 offset:10752
    ds_read_b128 a[152:155], v152 offset:16384
    s_bfe_u32 s79, s79, 0x10001
    s_mul_i32 s79, s79, 6
    v_mfma_f32_32x32x16_bf16 v[32:47], v[108:111], a[132:135], v[32:47]
    s_waitcnt lgkmcnt(15)
    buffer_store_dwordx4 a[240:243], v2, s[24:27], s94 offen sc1
    buffer_store_dwordx4 a[244:247], v2, s[24:27], s95 offen sc1
    ds_read_b64_tr_b16 v[100:101], v155 offset:10240
    ds_read_b64_tr_b16 v[102:103], v155 offset:10752
    ds_read_b128 a[156:159], v153 offset:16384
    s_add_u32 s70, s70, s79
    s_add_u32 s70, s70, 4
    s_add_u32 s70, s70, s59
    s_waitcnt lgkmcnt(12)
    v_mfma_f32_32x32x16_bf16 v[16:31], v[112:115], a[136:139], v[16:31]
    buffer_store_dwordx4 a[248:251], v2, s[24:27], s96 offen sc1
    buffer_store_dwordx4 a[252:255], v2, s[24:27], s97 offen sc1
    ds_read_b64_tr_b16 v[104:105], v154 offset:12288
    ds_read_b64_tr_b16 v[106:107], v154 offset:12800
    s_mul_i32 s52, s70, 5120
    s_lshl_b32 s70, s70, 13
    s_add_u32 s79, s45, 9
    v_mfma_f32_32x32x16_bf16 v[32:47], v[116:119], a[136:139], v[32:47]
    ds_read_b64_tr_b16 v[108:109], v155 offset:12288
    ds_read_b64_tr_b16 v[110:111], v155 offset:12800
    s_and_b32 s71, s79, 1
    s_bfe_u32 s79, s79, 0x10001
    s_mul_i32 s79, s79, 6
    s_add_u32 s71, s71, s79
    v_mfma_f32_32x32x16_bf16 v[16:31], v[80:83], a[140:143], v[16:31]
    ds_read_b64_tr_b16 v[112:113], v154 offset:14336
    ds_read_b64_tr_b16 v[114:115], v154 offset:14848
    s_add_u32 s71, s71, 4
    s_add_u32 s71, s71, s59
    s_mul_i32 s53, s71, 5120
    s_lshl_b32 s71, s71, 13
    v_mfma_f32_32x32x16_bf16 v[32:47], v[84:87], a[140:143], v[32:47]
    ds_read_b64_tr_b16 v[116:117], v155 offset:14336
    ds_read_b64_tr_b16 v[118:119], v155 offset:14848
    s_add_u32 s79, s45, 10
    s_and_b32 s44, s79, 1
    s_bfe_u32 s79, s79, 0x10001
    s_waitcnt lgkmcnt(9)
    v_mfma_f32_32x32x16_bf16 v[16:31], v[88:91], a[144:147], v[16:31]
    s_waitcnt vmcnt(12) lgkmcnt(8)
    s_barrier
    ds_read_b64_tr_b16 v[80:81], v154 offset:16384
    ds_read_b64_tr_b16 v[82:83], v154 offset:16896
    s_mul_i32 s79, s79, 6
    s_add_u32 s44, s44, s79
    v_mfma_f32_32x32x16_bf16 v[32:47], v[92:95], a[144:147], v[32:47]
    s_add_u32 m0, s92, 0
    ds_read_b64_tr_b16 v[84:85], v155 offset:16384
    ds_read_b64_tr_b16 v[86:87], v155 offset:16896
    s_add_u32 s44, s44, 4
    s_add_u32 s44, s44, s59
    s_mul_i32 s58, s44, 5120
    v_mfma_f32_32x32x16_bf16 v[16:31], v[96:99], a[148:151], v[16:31]
    ds_read_b64_tr_b16 v[88:89], v154 offset:18432
    ds_read_b64_tr_b16 v[90:91], v154 offset:18944
    s_lshl_b32 s44, s44, 13
    s_add_u32 s79, s45, 11
    s_and_b32 s45, s79, 1
    s_bfe_u32 s79, s79, 0x10001
    v_mfma_f32_32x32x16_bf16 v[32:47], v[100:103], a[148:151], v[32:47]
    buffer_load_dwordx4 v148, s[8:11], s86 offen lds
    ds_read_b64_tr_b16 v[92:93], v155 offset:18432
    ds_read_b64_tr_b16 v[94:95], v155 offset:18944
    s_mul_i32 s79, s79, 6
    s_add_u32 s45, s45, s79
    s_waitcnt lgkmcnt(8)
    v_mfma_f32_32x32x16_bf16 v[16:31], v[104:107], a[152:155], v[16:31]
    buffer_load_dwordx4 v149, s[8:11], s86 offen offset:1024 lds
    ds_read_b64_tr_b16 v[96:97], v154 offset:20480
    ds_read_b64_tr_b16 v[98:99], v154 offset:20992
    s_add_u32 s45, s45, 4
    s_add_u32 s45, s45, s59
    s_mul_i32 s59, s45, 5120
    v_mfma_f32_32x32x16_bf16 v[32:47], v[108:111], a[152:155], v[32:47]
    ds_read_b64_tr_b16 v[100:101], v155 offset:20480
    ds_read_b64_tr_b16 v[102:103], v155 offset:20992
    s_lshl_b32 s45, s45, 13
    v_mfma_f32_32x32x16_bf16 v[16:31], v[112:115], a[156:159], v[16:31]
    s_add_u32 m0, s92, 8192
    ds_read_b64_tr_b16 v[104:105], v154 offset:22528
    ds_read_b64_tr_b16 v[106:107], v154 offset:23040
    v_mfma_f32_32x32x16_bf16 v[32:47], v[116:119], a[156:159], v[32:47]
    ds_read_b64_tr_b16 v[108:109], v155 offset:22528
    ds_read_b64_tr_b16 v[110:111], v155 offset:23040
    s_waitcnt lgkmcnt(8)
    v_mfma_f32_32x32x16_bf16 v[48:63], v[80:83], a[0:3], 0
    buffer_load_dwordx4 v148, s[8:11], s87 offen lds
    ds_read_b64_tr_b16 v[112:113], v154 offset:24576
    ds_read_b64_tr_b16 v[114:115], v154 offset:25088
    v_mfma_f32_32x32x16_bf16 v[64:79], v[84:87], a[0:3], 0
    buffer_load_dwordx4 v149, s[8:11], s87 offen offset:1024 lds
    ds_read_b64_tr_b16 v[116:117], v155 offset:24576
    ds_read_b64_tr_b16 v[118:119], v155 offset:25088
    v_mul_f32 v160, s42, v16
    v_exp_f32 v160, v160
    v_mfma_f32_32x32x16_bf16 v[48:63], v[88:91], a[4:7], v[48:63]
    ds_read_b64_tr_b16 v[80:81], v154 offset:26624
    ds_read_b64_tr_b16 v[82:83], v154 offset:27136
    v_mul_f32 v161, s42, v17
    v_add_f32 v160, 1.0, v160
    v_exp_f32 v161, v161
    v_mfma_f32_32x32x16_bf16 v[64:79], v[92:95], a[4:7], v[64:79]
    s_add_u32 m0, s92, 16384
    ds_read_b64_tr_b16 v[84:85], v155 offset:26624
    ds_read_b64_tr_b16 v[86:87], v155 offset:27136
    v_mul_f32 v162, s42, v18
    s_waitcnt lgkmcnt(8)
    v_mfma_f32_32x32x16_bf16 v[48:63], v[96:99], a[8:11], v[48:63]
    ds_read_b64_tr_b16 v[88:89], v154 offset:28672
    ds_read_b64_tr_b16 v[90:91], v154 offset:29184
    v_rcp_f32 v160, v160
    v_add_f32 v161, 1.0, v161
    v_mfma_f32_32x32x16_bf16 v[64:79], v[100:103], a[8:11], v[64:79]
    buffer_load_dwordx4 v148, s[8:11], s88 offen lds
    ds_read_b64_tr_b16 v[92:93], v155 offset:28672
    ds_read_b64_tr_b16 v[94:95], v155 offset:29184
    v_exp_f32 v162, v162
    v_mul_f32 v163, s42, v19
    v_mfma_f32_32x32x16_bf16 v[48:63], v[104:107], a[12:15], v[48:63]
    buffer_load_dwordx4 v149, s[8:11], s88 offen offset:1024 lds
    ds_read_b64_tr_b16 v[96:97], v154 offset:30720
    ds_read_b64_tr_b16 v[98:99], v154 offset:31232
    v_mul_f32 v16, v16, v160
    v_rcp_f32 v161, v161
    v_mfma_f32_32x32x16_bf16 v[64:79], v[108:111], a[12:15], v[64:79]
    ds_read_b64_tr_b16 v[100:101], v155 offset:30720
    ds_read_b64_tr_b16 v[102:103], v155 offset:31232
    v_add_f32 v162, 1.0, v162
    v_exp_f32 v163, v163
    s_waitcnt lgkmcnt(8)
    v_mfma_f32_32x32x16_bf16 v[48:63], v[112:115], a[16:19], v[48:63]
    s_waitcnt vmcnt(14)
    s_barrier
    ds_read_b64_tr_b16 v[104:105], v154 offset:32768
    ds_read_b64_tr_b16 v[106:107], v154 offset:33280
    v_mul_f32 v164, s42, v20
    v_mul_f32 v17, v17, v161
    v_rcp_f32 v162, v162
    v_mfma_f32_32x32x16_bf16 v[64:79], v[116:119], a[16:19], v[64:79]
    s_waitcnt vmcnt(6)
    buffer_store_dword v253, v254, s[24:27], 0 offen sc1
    s_add_u32 m0, s92, 24576
    v_subrev_u32 v150, 81920, v154
    ds_read_b64_tr_b16 v[108:109], v155 offset:32768
    ds_read_b64_tr_b16 v[110:111], v155 offset:33280
    v_add_f32 v163, 1.0, v163
    v_exp_f32 v164, v164
    v_mfma_f32_32x32x16_bf16 v[48:63], v[80:83], a[20:23], v[48:63]
    buffer_load_dwordx4 v148, s[8:11], s89 offen lds
    v_subrev_u32 v151, 81920, v155
    ds_read_b64_tr_b16 v[112:113], v154 offset:34816
    ds_read_b64_tr_b16 v[114:115], v154 offset:35328
    v_mul_f32 v165, s42, v21
    v_mul_f32 v18, v18, v162
    v_mfma_f32_32x32x16_bf16 v[64:79], v[84:87], a[20:23], v[64:79]
    ds_read_b64_tr_b16 v[116:117], v155 offset:34816
    ds_read_b64_tr_b16 v[118:119], v155 offset:35328
    v_rcp_f32 v163, v163
    v_add_f32 v164, 1.0, v164
    s_waitcnt lgkmcnt(8)
    v_mfma_f32_32x32x16_bf16 v[48:63], v[88:91], a[24:27], v[48:63]
    buffer_load_dwordx4 v149, s[8:11], s89 offen offset:1024 lds
    ds_read_b64_tr_b16 v[80:81], v154 offset:36864
    ds_read_b64_tr_b16 v[82:83], v154 offset:37376
    v_exp_f32 v165, v165
    v_mul_f32 v166, s42, v22
    v_cvt_pk_bf16_f32 v168, v16, v17
    v_mfma_f32_32x32x16_bf16 v[64:79], v[92:95], a[24:27], v[64:79]
    s_add_u32 m0, s92, 32768
    ds_read_b64_tr_b16 v[84:85], v155 offset:36864
    ds_read_b64_tr_b16 v[86:87], v155 offset:37376
    v_mul_f32 v19, v19, v163
    v_rcp_f32 v164, v164
    v_mfma_f32_32x32x16_bf16 v[48:63], v[96:99], a[28:31], v[48:63]
    ds_read_b64_tr_b16 v[88:89], v154 offset:38912
    ds_read_b64_tr_b16 v[90:91], v154 offset:39424
    v_add_f32 v165, 1.0, v165
    v_exp_f32 v166, v166
    v_mul_f32 v167, s42, v23
    v_mfma_f32_32x32x16_bf16 v[64:79], v[100:103], a[28:31], v[64:79]
    v_add_u32 v148, 128, v148
    ds_read_b64_tr_b16 v[92:93], v155 offset:38912
    ds_read_b64_tr_b16 v[94:95], v155 offset:39424
    v_mul_f32 v20, v20, v164
    v_rcp_f32 v165, v165
    s_waitcnt lgkmcnt(8)
    v_mfma_f32_32x32x16_bf16 v[48:63], v[104:107], a[32:35], v[48:63]
    v_add_u32 v149, 128, v149
    ds_read_b64_tr_b16 v[96:97], v154 offset:40960
    ds_read_b64_tr_b16 v[98:99], v154 offset:41472
    v_add_f32 v166, 1.0, v166
    v_exp_f32 v167, v167
    v_mfma_f32_32x32x16_bf16 v[64:79], v[108:111], a[32:35], v[64:79]
    buffer_load_dwordx4 v148, s[8:11], s80 offen lds
    ds_read_b64_tr_b16 v[100:101], v155 offset:40960
    ds_read_b64_tr_b16 v[102:103], v155 offset:41472
    v_mul_f32 v160, s42, v24
    v_cvt_pk_bf16_f32 v169, v18, v19
    v_mfma_f32_32x32x16_bf16 v[48:63], v[112:115], a[36:39], v[48:63]
    ds_read_b64_tr_b16 v[104:105], v154 offset:43008
    ds_read_b64_tr_b16 v[106:107], v154 offset:43520
    v_mul_f32 v21, v21, v165
    v_rcp_f32 v166, v166
    v_add_f32 v167, 1.0, v167
    v_mfma_f32_32x32x16_bf16 v[64:79], v[116:119], a[36:39], v[64:79]
    buffer_load_dwordx4 v149, s[8:11], s80 offen offset:1024 lds
    ds_read_b64_tr_b16 v[108:109], v155 offset:43008
    ds_read_b64_tr_b16 v[110:111], v155 offset:43520
    v_exp_f32 v160, v160
    v_mul_f32 v161, s42, v25
    s_waitcnt lgkmcnt(8)
    v_mfma_f32_32x32x16_bf16 v[48:63], v[80:83], a[40:43], v[48:63]
    s_add_u32 m0, s92, 40960
    ds_read_b64_tr_b16 v[112:113], v154 offset:45056
    ds_read_b64_tr_b16 v[114:115], v154 offset:45568
    v_mul_f32 v22, v22, v166
    v_rcp_f32 v167, v167
    v_mfma_f32_32x32x16_bf16 v[64:79], v[84:87], a[40:43], v[64:79]
    buffer_load_dwordx4 v148, s[8:11], s81 offen lds
    ds_read_b64_tr_b16 v[116:117], v155 offset:45056
    ds_read_b64_tr_b16 v[118:119], v155 offset:45568
    v_add_f32 v160, 1.0, v160
    v_exp_f32 v161, v161
    v_mfma_f32_32x32x16_bf16 v[48:63], v[88:91], a[44:47], v[48:63]
    ds_read_b64_tr_b16 v[80:81], v154 offset:47104
    ds_read_b64_tr_b16 v[82:83], v154 offset:47616
    v_mul_f32 v162, s42, v26
    v_cvt_pk_bf16_f32 v170, v20, v21
    v_mul_f32 v23, v23, v167
    v_mfma_f32_32x32x16_bf16 v[64:79], v[92:95], a[44:47], v[64:79]
    buffer_load_dwordx4 v149, s[8:11], s81 offen offset:1024 lds
    ds_read_b64_tr_b16 v[84:85], v155 offset:47104
    ds_read_b64_tr_b16 v[86:87], v155 offset:47616
    v_rcp_f32 v160, v160
    v_add_f32 v161, 1.0, v161
    v_exp_f32 v162, v162
    s_waitcnt lgkmcnt(8)
    v_mfma_f32_32x32x16_bf16 v[48:63], v[96:99], a[48:51], v[48:63]
    s_barrier
    ds_read_b64_tr_b16 v[88:89], v154 offset:49152
    ds_read_b64_tr_b16 v[90:91], v154 offset:49664
    v_mul_f32 v163, s42, v27
    v_mul_f32 v24, v24, v160
    v_mfma_f32_32x32x16_bf16 v[64:79], v[100:103], a[48:51], v[64:79]
    s_add_u32 m0, s92, 49152
    ds_read_b64_tr_b16 v[92:93], v155 offset:49152
    ds_read_b64_tr_b16 v[94:95], v155 offset:49664
    v_rcp_f32 v161, v161
    v_add_f32 v162, 1.0, v162
    v_mfma_f32_32x32x16_bf16 v[48:63], v[104:107], a[52:55], v[48:63]
    ds_read_b64_tr_b16 v[96:97], v154 offset:51200
    ds_read_b64_tr_b16 v[98:99], v154 offset:51712
    v_exp_f32 v163, v163
    v_mul_f32 v164, s42, v28
    v_mfma_f32_32x32x16_bf16 v[64:79], v[108:111], a[52:55], v[64:79]
    buffer_load_dwordx4 v148, s[8:11], s82 offen lds
    ds_read_b64_tr_b16 v[100:101], v155 offset:51200
    ds_read_b64_tr_b16 v[102:103], v155 offset:51712
    v_cvt_pk_bf16_f32 v171, v22, v23
    buffer_store_dwordx4 v[168:171], v184, s[36:39], 0 offen offset:0 sc1
    v_mul_f32 v25, v25, v161
    s_waitcnt lgkmcnt(8)
    v_mfma_f32_32x32x16_bf16 v[48:63], v[112:115], a[56:59], v[48:63]
    buffer_load_dwordx4 v149, s[8:11], s82 offen offset:1024 lds
    ds_read_b64_tr_b16 v[104:105], v154 offset:53248
    ds_read_b64_tr_b16 v[106:107], v154 offset:53760
    v_rcp_f32 v162, v162
    v_add_f32 v163, 1.0, v163
    v_exp_f32 v164, v164
    v_mfma_f32_32x32x16_bf16 v[64:79], v[116:119], a[56:59], v[64:79]
    ds_read_b64_tr_b16 v[108:109], v155 offset:53248
    ds_read_b64_tr_b16 v[110:111], v155 offset:53760
    v_mul_f32 v165, s42, v29
    v_mul_f32 v26, v26, v162
    v_rcp_f32 v163, v163
    v_mfma_f32_32x32x16_bf16 v[48:63], v[80:83], a[60:63], v[48:63]
    s_add_u32 m0, s92, 57344
    ds_read_b64_tr_b16 v[112:113], v154 offset:55296
    ds_read_b64_tr_b16 v[114:115], v154 offset:55808
    v_add_f32 v164, 1.0, v164
    v_exp_f32 v165, v165
    v_mfma_f32_32x32x16_bf16 v[64:79], v[84:87], a[60:63], v[64:79]
    ds_read_b64_tr_b16 v[116:117], v155 offset:55296
    ds_read_b64_tr_b16 v[118:119], v155 offset:55808
    v_mul_f32 v166, s42, v30
    v_cvt_pk_bf16_f32 v172, v24, v25
    s_waitcnt lgkmcnt(8)
    v_mfma_f32_32x32x16_bf16 v[48:63], v[88:91], a[64:67], v[48:63]
    buffer_load_dwordx4 v148, s[8:11], s83 offen lds
    ds_read_b64_tr_b16 v[80:81], v154 offset:57344
    ds_read_b64_tr_b16 v[82:83], v154 offset:57856
    v_mul_f32 v27, v27, v163
    v_rcp_f32 v164, v164
    v_mfma_f32_32x32x16_bf16 v[64:79], v[92:95], a[64:67], v[64:79]
    buffer_load_dwordx4 v149, s[8:11], s83 offen offset:1024 lds
    ds_read_b64_tr_b16 v[84:85], v155 offset:57344
    ds_read_b64_tr_b16 v[86:87], v155 offset:57856
    v_add_f32 v165, 1.0, v165
    v_exp_f32 v166, v166
    v_mfma_f32_32x32x16_bf16 v[48:63], v[96:99], a[68:71], v[48:63]
    ds_read_b64_tr_b16 v[88:89], v154 offset:59392
    ds_read_b64_tr_b16 v[90:91], v154 offset:59904
    v_mul_f32 v167, s42, v31
    v_mul_f32 v28, v28, v164
    v_rcp_f32 v165, v165
    v_mfma_f32_32x32x16_bf16 v[64:79], v[100:103], a[68:71], v[64:79]
    s_add_u32 m0, s92, 81920
    ds_read_b64_tr_b16 v[92:93], v155 offset:59392
    ds_read_b64_tr_b16 v[94:95], v155 offset:59904
    v_add_f32 v166, 1.0, v166
    v_exp_f32 v167, v167
    s_waitcnt lgkmcnt(8)
    v_mfma_f32_32x32x16_bf16 v[48:63], v[104:107], a[72:75], v[48:63]
    ds_read_b64_tr_b16 v[96:97], v154 offset:61440
    ds_read_b64_tr_b16 v[98:99], v154 offset:61952
    v_cvt_pk_bf16_f32 v173, v26, v27
    v_mul_f32 v29, v29, v165
    v_mfma_f32_32x32x16_bf16 v[64:79], v[108:111], a[72:75], v[64:79]
    buffer_load_dwordx4 v148, s[8:11], s84 offen lds
    ds_read_b64_tr_b16 v[100:101], v155 offset:61440
    ds_read_b64_tr_b16 v[102:103], v155 offset:61952
    v_rcp_f32 v166, v166
    v_add_f32 v167, 1.0, v167
    v_mfma_f32_32x32x16_bf16 v[48:63], v[112:115], a[76:79], v[48:63]
    buffer_load_dwordx4 v149, s[8:11], s84 offen offset:1024 lds
    ds_read_b64_tr_b16 v[104:105], v154 offset:63488
    ds_read_b64_tr_b16 v[106:107], v154 offset:64000
    v_mul_f32 v30, v30, v166
    v_rcp_f32 v167, v167
    v_cvt_pk_bf16_f32 v174, v28, v29
    v_mfma_f32_32x32x16_bf16 v[64:79], v[116:119], a[76:79], v[64:79]
    ds_read_b64_tr_b16 v[108:109], v155 offset:63488
    ds_read_b64_tr_b16 v[110:111], v155 offset:64000
    v_mul_f32 v31, v31, v167
    v_cvt_pk_bf16_f32 v175, v30, v31
    s_waitcnt lgkmcnt(8)
    v_mfma_f32_32x32x16_bf16 v[48:63], v[80:83], a[80:83], v[48:63]
    s_waitcnt vmcnt(16)
    s_barrier
    ds_read_b64_tr_b16 v[112:113], v150 offset:0
    ds_read_b64_tr_b16 v[114:115], v150 offset:512
    buffer_store_dwordx4 v[172:175], v184, s[36:39], 0 offen offset:256 sc1
    v_add_u32 v184, 8192, v184
    v_mul_f32 v160, s42, v32
    v_mfma_f32_32x32x16_bf16 v[64:79], v[84:87], a[80:83], v[64:79]
    s_add_u32 m0, s92, 90112
    ds_read_b64_tr_b16 v[116:117], v151 offset:0
    ds_read_b64_tr_b16 v[118:119], v151 offset:512
    v_exp_f32 v160, v160
    v_mul_f32 v161, s42, v33
    v_add_f32 v160, 1.0, v160
    v_mfma_f32_32x32x16_bf16 v[48:63], v[88:91], a[84:87], v[48:63]
    ds_read_b64_tr_b16 v[80:81], v150 offset:2048
    ds_read_b64_tr_b16 v[82:83], v150 offset:2560
    v_exp_f32 v161, v161
    v_mul_f32 v162, s42, v34
    v_mfma_f32_32x32x16_bf16 v[64:79], v[92:95], a[84:87], v[64:79]
    buffer_load_dwordx4 v148, s[8:11], s85 offen lds
    ds_read_b64_tr_b16 v[84:85], v151 offset:2048
    ds_read_b64_tr_b16 v[86:87], v151 offset:2560
    v_rcp_f32 v160, v160
    v_add_f32 v161, 1.0, v161
    s_waitcnt lgkmcnt(8)
    v_mfma_f32_32x32x16_bf16 v[48:63], v[96:99], a[88:91], v[48:63]
    buffer_load_dwordx4 v149, s[8:11], s85 offen offset:1024 lds
    ds_read_b64_tr_b16 v[88:89], v150 offset:4096
    ds_read_b64_tr_b16 v[90:91], v150 offset:4608
    v_exp_f32 v162, v162
    v_mul_f32 v163, s42, v35
    v_mfma_f32_32x32x16_bf16 v[64:79], v[100:103], a[88:91], v[64:79]
    ds_read_b64_tr_b16 v[92:93], v151 offset:4096
    ds_read_b64_tr_b16 v[94:95], v151 offset:4608
    v_mul_f32 v32, v32, v160
    v_rcp_f32 v161, v161
    v_add_f32 v162, 1.0, v162
    v_mfma_f32_32x32x16_bf16 v[48:63], v[104:107], a[92:95], v[48:63]
    s_add_u32 m0, s92, 98304
    ds_read_b64_tr_b16 v[96:97], v150 offset:6144
    ds_read_b64_tr_b16 v[98:99], v150 offset:6656
    v_exp_f32 v163, v163
    v_mul_f32 v164, s42, v36
    v_mfma_f32_32x32x16_bf16 v[64:79], v[108:111], a[92:95], v[64:79]
    ds_read_b64_tr_b16 v[100:101], v151 offset:6144
    ds_read_b64_tr_b16 v[102:103], v151 offset:6656
    v_mul_f32 v33, v33, v161
    v_rcp_f32 v162, v162
    s_waitcnt lgkmcnt(8)
    v_mfma_f32_32x32x16_bf16 v[48:63], v[112:115], a[96:99], v[48:63]
    buffer_load_dwordx4 v148, s[8:11], s86 offen lds
    ds_read_b64_tr_b16 v[104:105], v150 offset:8192
    ds_read_b64_tr_b16 v[106:107], v150 offset:8704
    v_add_f32 v163, 1.0, v163
    v_exp_f32 v164, v164
    v_mfma_f32_32x32x16_bf16 v[64:79], v[116:119], a[96:99], v[64:79]
    buffer_load_dwordx4 v149, s[8:11], s86 offen offset:1024 lds
    ds_read_b64_tr_b16 v[108:109], v151 offset:8192
    ds_read_b64_tr_b16 v[110:111], v151 offset:8704
    v_mul_f32 v165, s42, v37
    v_mul_f32 v34, v34, v162
    v_rcp_f32 v163, v163
    v_mfma_f32_32x32x16_bf16 v[48:63], v[80:83], a[100:103], v[48:63]
    ds_read_b64_tr_b16 v[112:113], v150 offset:10240
    ds_read_b64_tr_b16 v[114:115], v150 offset:10752
    v_add_f32 v164, 1.0, v164
    v_exp_f32 v165, v165
    v_mul_f32 v166, s42, v38
    v_mfma_f32_32x32x16_bf16 v[64:79], v[84:87], a[100:103], v[64:79]
    s_add_u32 m0, s92, 106496
    ds_read_b64_tr_b16 v[116:117], v151 offset:10240
    ds_read_b64_tr_b16 v[118:119], v151 offset:10752
    v_cvt_pk_bf16_f32 v176, v32, v33
    v_mul_f32 v35, v35, v163
    s_waitcnt lgkmcnt(8)
    v_mfma_f32_32x32x16_bf16 v[48:63], v[88:91], a[104:107], v[48:63]
    ds_read_b64_tr_b16 v[80:81], v150 offset:12288
    ds_read_b64_tr_b16 v[82:83], v150 offset:12800
    v_rcp_f32 v164, v164
    v_add_f32 v165, 1.0, v165
    v_mfma_f32_32x32x16_bf16 v[64:79], v[92:95], a[104:107], v[64:79]
    buffer_load_dwordx4 v148, s[8:11], s87 offen lds
    ds_read_b64_tr_b16 v[84:85], v151 offset:12288
    ds_read_b64_tr_b16 v[86:87], v151 offset:12800
    v_exp_f32 v166, v166
    v_mul_f32 v167, s42, v39
    v_mfma_f32_32x32x16_bf16 v[48:63], v[96:99], a[108:111], v[48:63]
    buffer_load_dwordx4 v149, s[8:11], s87 offen offset:1024 lds
    ds_read_b64_tr_b16 v[88:89], v150 offset:14336
    ds_read_b64_tr_b16 v[90:91], v150 offset:14848
    v_mul_f32 v36, v36, v164
    v_rcp_f32 v165, v165
    v_add_f32 v166, 1.0, v166
    v_mfma_f32_32x32x16_bf16 v[64:79], v[100:103], a[108:111], v[64:79]
    ds_read_b64_tr_b16 v[92:93], v151 offset:14336
    ds_read_b64_tr_b16 v[94:95], v151 offset:14848
    v_exp_f32 v167, v167
    v_mul_f32 v160, s42, v40
    s_waitcnt lgkmcnt(8)
    v_mfma_f32_32x32x16_bf16 v[48:63], v[104:107], a[112:115], v[48:63]
    s_waitcnt vmcnt(18)
    s_barrier
    ds_read_b64_tr_b16 v[96:97], v150 offset:16384
    ds_read_b64_tr_b16 v[98:99], v150 offset:16896
    v_cvt_pk_bf16_f32 v177, v34, v35
    v_mul_f32 v37, v37, v165
    v_rcp_f32 v166, v166
    v_mfma_f32_32x32x16_bf16 v[64:79], v[108:111], a[112:115], v[64:79]
    buffer_load_dword v13, v159, s[12:15], 0 offen sc1
    s_add_u32 m0, s92, 114688
    ds_read_b64_tr_b16 v[100:101], v151 offset:16384
    ds_read_b64_tr_b16 v[102:103], v151 offset:16896
    v_add_f32 v167, 1.0, v167
    v_exp_f32 v160, v160
    v_mfma_f32_32x32x16_bf16 v[48:63], v[112:115], a[116:119], v[48:63]
    ds_read_b64_tr_b16 v[104:105], v150 offset:18432
    ds_read_b64_tr_b16 v[106:107], v150 offset:18944
    v_mul_f32 v161, s42, v41
    v_mul_f32 v38, v38, v166
    v_rcp_f32 v167, v167
    v_mfma_f32_32x32x16_bf16 v[64:79], v[116:119], a[116:119], v[64:79]
    ds_read_b64_tr_b16 v[108:109], v151 offset:18432
    ds_read_b64_tr_b16 v[110:111], v151 offset:18944
    v_add_f32 v160, 1.0, v160
    v_exp_f32 v161, v161
    s_waitcnt lgkmcnt(8)
    v_mfma_f32_32x32x16_bf16 v[48:63], v[80:83], a[120:123], v[48:63]
    buffer_load_dwordx4 v148, s[8:11], s88 offen lds
    ds_read_b64_tr_b16 v[112:113], v150 offset:20480
    ds_read_b64_tr_b16 v[114:115], v150 offset:20992
    v_mul_f32 v162, s42, v42
    v_cvt_pk_bf16_f32 v178, v36, v37
    v_mfma_f32_32x32x16_bf16 v[64:79], v[84:87], a[120:123], v[64:79]
    ds_read_b64_tr_b16 v[116:117], v151 offset:20480
    ds_read_b64_tr_b16 v[118:119], v151 offset:20992
    v_mul_f32 v39, v39, v167
    v_rcp_f32 v160, v160
    v_add_f32 v161, 1.0, v161
    v_mfma_f32_32x32x16_bf16 v[48:63], v[88:91], a[124:127], v[48:63]
    buffer_load_dwordx4 v149, s[8:11], s88 offen offset:1024 lds
    ds_read_b64_tr_b16 v[80:81], v150 offset:22528
    ds_read_b64_tr_b16 v[82:83], v150 offset:23040
    v_exp_f32 v162, v162
    v_mul_f32 v163, s42, v43
    v_mfma_f32_32x32x16_bf16 v[64:79], v[92:95], a[124:127], v[64:79]
    ds_read_b64_tr_b16 v[84:85], v151 offset:22528
    ds_read_b64_tr_b16 v[86:87], v151 offset:23040
    v_mul_f32 v40, v40, v160
    v_rcp_f32 v161, v161
    s_waitcnt lgkmcnt(8)
    v_mfma_f32_32x32x16_bf16 v[48:63], v[96:99], a[128:131], v[48:63]
    ds_read_b64_tr_b16 v[88:89], v150 offset:24576
    ds_read_b64_tr_b16 v[90:91], v150 offset:25088
    v_add_f32 v162, 1.0, v162
    v_exp_f32 v163, v163
    v_mul_f32 v164, s42, v44
    v_mfma_f32_32x32x16_bf16 v[64:79], v[100:103], a[128:131], v[64:79]
    s_add_u32 m0, s92, 122880
    ds_read_b64_tr_b16 v[92:93], v151 offset:24576
    ds_read_b64_tr_b16 v[94:95], v151 offset:25088
    v_cvt_pk_bf16_f32 v179, v38, v39
    buffer_store_dwordx4 v[176:179], v184, s[36:39], 0 offen offset:0 sc1
    v_mfma_f32_32x32x16_bf16 v[48:63], v[104:107], a[132:135], v[48:63]
    ds_read_b64_tr_b16 v[96:97], v150 offset:26624
    ds_read_b64_tr_b16 v[98:99], v150 offset:27136
    v_mul_f32 v41, v41, v161
    v_rcp_f32 v162, v162
    v_add_f32 v163, 1.0, v163
    v_mfma_f32_32x32x16_bf16 v[64:79], v[108:111], a[132:135], v[64:79]
    buffer_load_dwordx4 v148, s[8:11], s89 offen lds
    ds_read_b64_tr_b16 v[100:101], v151 offset:26624
    ds_read_b64_tr_b16 v[102:103], v151 offset:27136
    v_exp_f32 v164, v164
    s_waitcnt lgkmcnt(8)
    v_mfma_f32_32x32x16_bf16 v[48:63], v[112:115], a[136:139], v[48:63]
    ds_read_b64_tr_b16 v[104:105], v150 offset:28672
    ds_read_b64_tr_b16 v[106:107], v150 offset:29184
    v_mul_f32 v165, s42, v45
    v_mul_f32 v42, v42, v162
    v_rcp_f32 v163, v163
    v_mfma_f32_32x32x16_bf16 v[64:79], v[116:119], a[136:139], v[64:79]
    ds_read_b64_tr_b16 v[108:109], v151 offset:28672
    ds_read_b64_tr_b16 v[110:111], v151 offset:29184
    s_lshl_b32 s79, s73, 7
    s_add_u32 s79, s79, s76
    s_lshl_b32 s79, s79, 2
    s_add_u32 s79, s79, s72
    s_lshl_b32 s79, s79, 7
    s_add_u32 s79, s79, 327680
    v_mov_b32 v254, s79
    v_add_f32 v164, 1.0, v164
    v_exp_f32 v165, v165
    v_mfma_f32_32x32x16_bf16 v[48:63], v[80:83], a[140:143], v[48:63]
    buffer_load_dwordx4 v149, s[8:11], s89 offen offset:1024 lds
    ds_read_b64_tr_b16 v[112:113], v150 offset:30720
    ds_read_b64_tr_b16 v[114:115], v150 offset:31232
    v_mul_f32 v166, s42, v46
    v_cvt_pk_bf16_f32 v180, v40, v41
    v_mul_f32 v43, v43, v163
    v_mfma_f32_32x32x16_bf16 v[64:79], v[84:87], a[140:143], v[64:79]
    ds_read_b64_tr_b16 v[116:117], v151 offset:30720
    ds_read_b64_tr_b16 v[118:119], v151 offset:31232
    v_rcp_f32 v164, v164
    v_add_f32 v165, 1.0, v165
    s_waitcnt lgkmcnt(8)
    v_mfma_f32_32x32x16_bf16 v[48:63], v[88:91], a[144:147], v[48:63]
    s_waitcnt vmcnt(20)
    s_barrier
    ds_read_b64_tr_b16 v[80:81], v150 offset:32768
    ds_read_b64_tr_b16 v[82:83], v150 offset:33280
    v_exp_f32 v166, v166
    v_mul_f32 v167, s42, v47
    v_mfma_f32_32x32x16_bf16 v[64:79], v[92:95], a[144:147], v[64:79]
    s_waitcnt vmcnt(5)
    v_cmp_ne_u32 vcc, s78, v13
    s_nop 0
    s_cmp_eq_u64 vcc, 0
    s_cbranch_scc0 L_pk_retry_1
L_pk_ok_2:
    ds_read_b64_tr_b16 v[84:85], v151 offset:32768
    ds_read_b64_tr_b16 v[86:87], v151 offset:33280
    v_mul_f32 v44, v44, v164
    v_rcp_f32 v165, v165
    v_mfma_f32_32x32x16_bf16 v[48:63], v[96:99], a[148:151], v[48:63]
    ds_read_b64_tr_b16 v[88:89], v150 offset:34816
    ds_read_b64_tr_b16 v[90:91], v150 offset:35328
    v_add_f32 v166, 1.0, v166
    v_exp_f32 v167, v167
    v_cvt_pk_bf16_f32 v181, v42, v43
    v_mfma_f32_32x32x16_bf16 v[64:79], v[100:103], a[148:151], v[64:79]
    buffer_load_dwordx4 a[160:163], v2, s[32:35], s40 offen offset:0 sc1
    ds_read_b64_tr_b16 v[92:93], v151 offset:34816
    ds_read_b64_tr_b16 v[94:95], v151 offset:35328
    v_mul_f32 v45, v45, v165
    v_rcp_f32 v166, v166
    s_waitcnt lgkmcnt(8)
    v_mfma_f32_32x32x16_bf16 v[48:63], v[104:107], a[152:155], v[48:63]
    ds_read_b64_tr_b16 v[96:97], v150 offset:36864
    ds_read_b64_tr_b16 v[98:99], v150 offset:37376
    v_add_f32 v167, 1.0, v167
    v_mul_f32 v46, v46, v166
    v_rcp_f32 v167, v167
    v_mfma_f32_32x32x16_bf16 v[64:79], v[108:111], a[152:155], v[64:79]
    buffer_load_dwordx4 a[164:167], v2, s[32:35], s40 offen offset:1024 sc1
    ds_read_b64_tr_b16 v[100:101], v151 offset:36864
    ds_read_b64_tr_b16 v[102:103], v151 offset:37376
    v_cvt_pk_bf16_f32 v182, v44, v45
    v_mul_f32 v47, v47, v167
    v_cvt_pk_bf16_f32 v183, v46, v47
    buffer_store_dwordx4 v[180:183], v184, s[36:39], 0 offen offset:256 sc1
    v_add_u32 v184, 8192, v184
    v_mfma_f32_32x32x16_bf16 v[48:63], v[112:115], a[156:159], v[48:63]
    ds_read_b64_tr_b16 v[104:105], v150 offset:38912
    ds_read_b64_tr_b16 v[106:107], v150 offset:39424
    v_mfma_f32_32x32x16_bf16 v[64:79], v[116:119], a[156:159], v[64:79]
    ds_read_b64_tr_b16 v[108:109], v151 offset:38912
    ds_read_b64_tr_b16 v[110:111], v151 offset:39424
    s_waitcnt lgkmcnt(8)
    v_mfma_f32_32x32x16_bf16 v[16:31], v[80:83], a[0:3], 0
    buffer_load_dwordx4 a[168:171], v2, s[32:35], s40 offen offset:2048 sc1
    ds_read_b64_tr_b16 v[112:113], v150 offset:40960
    ds_read_b64_tr_b16 v[114:115], v150 offset:41472
    v_mfma_f32_32x32x16_bf16 v[32:47], v[84:87], a[0:3], 0
    ds_read_b64_tr_b16 v[116:117], v151 offset:40960
    ds_read_b64_tr_b16 v[118:119], v151 offset:41472
    v_mul_f32 v160, s42, v48
    v_exp_f32 v160, v160
    v_mul_f32 v161, s42, v49
    v_mfma_f32_32x32x16_bf16 v[16:31], v[88:91], a[4:7], v[16:31]
    buffer_load_dwordx4 a[172:175], v2, s[32:35], s40 offen offset:3072 sc1
    ds_read_b64_tr_b16 v[80:81], v150 offset:43008
    ds_read_b64_tr_b16 v[82:83], v150 offset:43520
    v_add_f32 v160, 1.0, v160
    v_exp_f32 v161, v161
    v_mfma_f32_32x32x16_bf16 v[32:47], v[92:95], a[4:7], v[32:47]
    ds_read_b64_tr_b16 v[84:85], v151 offset:43008
    ds_read_b64_tr_b16 v[86:87], v151 offset:43520
    v_mul_f32 v162, s42, v50
    v_rcp_f32 v160, v160
    s_waitcnt lgkmcnt(8)
    v_mfma_f32_32x32x16_bf16 v[16:31], v[96:99], a[8:11], v[16:31]
    ds_read_b64_tr_b16 v[88:89], v150 offset:45056
    ds_read_b64_tr_b16 v[90:91], v150 offset:45568
    v_add_f32 v161, 1.0, v161
    v_exp_f32 v162, v162
    v_mul_f32 v163, s42, v51
    v_mfma_f32_32x32x16_bf16 v[32:47], v[100:103], a[8:11], v[32:47]
    buffer_load_dwordx4 a[176:179], v3, s[32:35], s40 offen offset:0 sc1
    ds_read_b64_tr_b16 v[92:93], v151 offset:45056
    ds_read_b64_tr_b16 v[94:95], v151 offset:45568
    v_mul_f32 v48, v48, v160
    v_rcp_f32 v161, v161
    v_mfma_f32_32x32x16_bf16 v[16:31], v[104:107], a[12:15], v[16:31]
    ds_read_b64_tr_b16 v[96:97], v150 offset:47104
    ds_read_b64_tr_b16 v[98:99], v150 offset:47616
    v_add_f32 v162, 1.0, v162
    v_exp_f32 v163, v163
    v_mul_f32 v164, s42, v52
    v_mfma_f32_32x32x16_bf16 v[32:47], v[108:111], a[12:15], v[32:47]
    buffer_load_dwordx4 a[180:183], v2, s[32:35], s41 offen offset:0 sc1
    ds_read_b64_tr_b16 v[100:101], v151 offset:47104
    ds_read_b64_tr_b16 v[102:103], v151 offset:47616
    v_mul_f32 v49, v49, v161
    s_waitcnt lgkmcnt(8)
    v_mfma_f32_32x32x16_bf16 v[16:31], v[112:115], a[16:19], v[16:31]
    s_barrier
    ds_read_b64_tr_b16 v[104:105], v150 offset:49152
    ds_read_b64_tr_b16 v[106:107], v150 offset:49664
    v_rcp_f32 v162, v162
    v_add_f32 v163, 1.0, v163
    v_mfma_f32_32x32x16_bf16 v[32:47], v[116:119], a[16:19], v[32:47]
    ds_read_b64_tr_b16 v[108:109], v151 offset:49152
    ds_read_b64_tr_b16 v[110:111], v151 offset:49664
    v_exp_f32 v164, v164
    v_mul_f32 v165, s42, v53
    v_mul_f32 v50, v50, v162
    v_mfma_f32_32x32x16_bf16 v[16:31], v[80:83], a[20:23], v[16:31]
    buffer_load_dwordx4 a[184:187], v2, s[32:35], s41 offen offset:1024 sc1
    ds_read_b64_tr_b16 v[112:113], v150 offset:51200
    ds_read_b64_tr_b16 v[114:115], v150 offset:51712
    v_rcp_f32 v163, v163
    v_add_f32 v164, 1.0, v164
    v_mfma_f32_32x32x16_bf16 v[32:47], v[84:87], a[20:23], v[32:47]
    ds_read_b64_tr_b16 v[116:117], v151 offset:51200
    ds_read_b64_tr_b16 v[118:119], v151 offset:51712
    v_exp_f32 v165, v165
    v_mul_f32 v166, s42, v54
    s_waitcnt lgkmcnt(8)
    v_mfma_f32_32x32x16_bf16 v[16:31], v[88:91], a[24:27], v[16:31]
    buffer_load_dwordx4 a[188:191], v2, s[32:35], s41 offen offset:2048 sc1
    ds_read_b64_tr_b16 v[80:81], v150 offset:53248
    ds_read_b64_tr_b16 v[82:83], v150 offset:53760
    v_cvt_pk_bf16_f32 v168, v48, v49
    v_mul_f32 v51, v51, v163
    v_mfma_f32_32x32x16_bf16 v[32:47], v[92:95], a[24:27], v[32:47]
    ds_read_b64_tr_b16 v[84:85], v151 offset:53248
    ds_read_b64_tr_b16 v[86:87], v151 offset:53760
    v_rcp_f32 v164, v164
    v_add_f32 v165, 1.0, v165
    v_mfma_f32_32x32x16_bf16 v[16:31], v[96:99], a[28:31], v[16:31]
    ds_read_b64_tr_b16 v[88:89], v150 offset:55296
    ds_read_b64_tr_b16 v[90:91], v150 offset:55808
    v_exp_f32 v166, v166
    v_mul_f32 v167, s42, v55
    v_mul_f32 v52, v52, v164
    v_mfma_f32_32x32x16_bf16 v[32:47], v[100:103], a[28:31], v[32:47]
    buffer_load_dwordx4 a[192:195], v2, s[32:35], s41 offen offset:3072 sc1
    ds_read_b64_tr_b16 v[92:93], v151 offset:55296
    ds_read_b64_tr_b16 v[94:95], v151 offset:55808
    v_rcp_f32 v165, v165
    s_waitcnt lgkmcnt(8)
    v_mfma_f32_32x32x16_bf16 v[16:31], v[104:107], a[32:35], v[16:31]
    ds_read_b64_tr_b16 v[96:97], v150 offset:57344
    ds_read_b64_tr_b16 v[98:99], v150 offset:57856
    v_add_f32 v166, 1.0, v166
    v_exp_f32 v167, v167
    v_mul_f32 v160, s42, v56
    v_mfma_f32_32x32x16_bf16 v[32:47], v[108:111], a[32:35], v[32:47]
    buffer_load_dwordx4 a[196:199], v3, s[32:35], s41 offen offset:0 sc1
    ds_read_b64_tr_b16 v[100:101], v151 offset:57344
    ds_read_b64_tr_b16 v[102:103], v151 offset:57856
    v_cvt_pk_bf16_f32 v169, v50, v51
    v_mul_f32 v53, v53, v165
    v_mfma_f32_32x32x16_bf16 v[16:31], v[112:115], a[36:39], v[16:31]
    ds_read_b64_tr_b16 v[104:105], v150 offset:59392
    ds_read_b64_tr_b16 v[106:107], v150 offset:59904
    v_rcp_f32 v166, v166
    v_add_f32 v167, 1.0, v167
    v_mfma_f32_32x32x16_bf16 v[32:47], v[116:119], a[36:39], v[32:47]
    ds_read_b64_tr_b16 v[108:109], v151 offset:59392
    ds_read_b64_tr_b16 v[110:111], v151 offset:59904
    v_exp_f32 v160, v160
    v_mul_f32 v161, s42, v57
    s_waitcnt lgkmcnt(8)
    v_mfma_f32_32x32x16_bf16 v[16:31], v[80:83], a[40:43], v[16:31]
    buffer_load_dwordx4 a[200:203], v2, s[32:35], s46 offen offset:0 sc1
    ds_read_b64_tr_b16 v[112:113], v150 offset:61440
    ds_read_b64_tr_b16 v[114:115], v150 offset:61952
    v_mul_f32 v54, v54, v166
    v_rcp_f32 v167, v167
    v_mfma_f32_32x32x16_bf16 v[32:47], v[84:87], a[40:43], v[32:47]
    ds_read_b64_tr_b16 v[116:117], v151 offset:61440
    ds_read_b64_tr_b16 v[118:119], v151 offset:61952
    v_add_f32 v160, 1.0, v160
    v_exp_f32 v161, v161
    v_mul_f32 v162, s42, v58
    v_mfma_f32_32x32x16_bf16 v[16:31], v[88:91], a[44:47], v[16:31]
    buffer_load_dwordx4 a[204:207], v2, s[32:35], s46 offen offset:1024 sc1
    ds_read_b64_tr_b16 v[80:81], v150 offset:63488
    ds_read_b64_tr_b16 v[82:83], v150 offset:64000
    v_cvt_pk_bf16_f32 v170, v52, v53
    v_mul_f32 v55, v55, v167
    v_mfma_f32_32x32x16_bf16 v[32:47], v[92:95], a[44:47], v[32:47]
    ds_read_b64_tr_b16 v[84:85], v151 offset:63488
    ds_read_b64_tr_b16 v[86:87], v151 offset:64000
    v_rcp_f32 v160, v160
    v_add_f32 v161, 1.0, v161
    v_exp_f32 v162, v162
    s_waitcnt lgkmcnt(8)
    v_mfma_f32_32x32x16_bf16 v[16:31], v[96:99], a[48:51], v[16:31]
    s_barrier
    ds_read_b64_tr_b16 v[88:89], v154 offset:0
    ds_read_b64_tr_b16 v[90:91], v154 offset:512
    v_mul_f32 v163, s42, v59
    v_mul_f32 v56, v56, v160
    v_mfma_f32_32x32x16_bf16 v[32:47], v[100:103], a[48:51], v[32:47]
    buffer_load_dwordx4 a[208:211], v2, s[32:35], s46 offen offset:2048 sc1
    ds_read_b64_tr_b16 v[92:93], v155 offset:0
    ds_read_b64_tr_b16 v[94:95], v155 offset:512
    v_rcp_f32 v161, v161
    v_add_f32 v162, 1.0, v162
    v_mfma_f32_32x32x16_bf16 v[16:31], v[104:107], a[52:55], v[16:31]
    ds_read_b64_tr_b16 v[96:97], v154 offset:2048
    ds_read_b64_tr_b16 v[98:99], v154 offset:2560
    v_exp_f32 v163, v163
    v_mul_f32 v164, s42, v60
    v_mfma_f32_32x32x16_bf16 v[32:47], v[108:111], a[52:55], v[32:47]
    buffer_load_dwordx4 a[212:215], v2, s[32:35], s46 offen offset:3072 sc1
    ds_read_b64_tr_b16 v[100:101], v155 offset:2048
    ds_read_b64_tr_b16 v[102:103], v155 offset:2560
    v_cvt_pk_bf16_f32 v171, v54, v55
    buffer_store_dwordx4 v[168:171], v184, s[36:39], 0 offen offset:0 sc1
    v_mul_f32 v57, v57, v161
    s_waitcnt lgkmcnt(8)
    v_mfma_f32_32x32x16_bf16 v[16:31], v[112:115], a[56:59], v[16:31]
    ds_read_b64_tr_b16 v[104:105], v154 offset:4096
    ds_read_b64_tr_b16 v[106:107], v154 offset:4608
    v_rcp_f32 v162, v162
    v_add_f32 v163, 1.0, v163
    v_exp_f32 v164, v164
    v_mfma_f32_32x32x16_bf16 v[32:47], v[116:119], a[56:59], v[32:47]
    ds_read_b64_tr_b16 v[108:109], v155 offset:4096
    ds_read_b64_tr_b16 v[110:111], v155 offset:4608
    v_mul_f32 v165, s42, v61
    v_mul_f32 v58, v58, v162
    v_rcp_f32 v163, v163
    v_mfma_f32_32x32x16_bf16 v[16:31], v[80:83], a[60:63], v[16:31]
    buffer_load_dwordx4 a[216:219], v3, s[32:35], s46 offen offset:0 sc1
    ds_read_b64_tr_b16 v[112:113], v154 offset:6144
    ds_read_b64_tr_b16 v[114:115], v154 offset:6656
    v_add_f32 v164, 1.0, v164
    v_exp_f32 v165, v165
    v_mfma_f32_32x32x16_bf16 v[32:47], v[84:87], a[60:63], v[32:47]
    ds_read_b64_tr_b16 v[116:117], v155 offset:6144
    ds_read_b64_tr_b16 v[118:119], v155 offset:6656
    v_mul_f32 v166, s42, v62
    v_cvt_pk_bf16_f32 v172, v56, v57
    s_waitcnt lgkmcnt(8)
    v_mfma_f32_32x32x16_bf16 v[16:31], v[88:91], a[64:67], v[16:31]
    buffer_load_dwordx4 a[220:223], v2, s[32:35], s47 offen offset:0 sc1
    ds_read_b64_tr_b16 v[80:81], v154 offset:8192
    ds_read_b64_tr_b16 v[82:83], v154 offset:8704
    v_mul_f32 v59, v59, v163
    v_rcp_f32 v164, v164
    v_mfma_f32_32x32x16_bf16 v[32:47], v[92:95], a[64:67], v[32:47]
    ds_read_b64_tr_b16 v[84:85], v155 offset:8192
    ds_read_b64_tr_b16 v[86:87], v155 offset:8704
    v_add_f32 v165, 1.0, v165
    v_exp_f32 v166, v166
    v_mul_f32 v167, s42, v63
    v_mfma_f32_32x32x16_bf16 v[16:31], v[96:99], a[68:71], v[16:31]
    ds_read_b64_tr_b16 v[88:89], v154 offset:10240
    ds_read_b64_tr_b16 v[90:91], v154 offset:10752
    v_mul_f32 v60, v60, v164
    v_rcp_f32 v165, v165
    v_add_f32 v166, 1.0, v166
    v_mfma_f32_32x32x16_bf16 v[32:47], v[100:103], a[68:71], v[32:47]
    buffer_load_dwordx4 a[224:227], v2, s[32:35], s47 offen offset:1024 sc1
    ds_read_b64_tr_b16 v[92:93], v155 offset:10240
    ds_read_b64_tr_b16 v[94:95], v155 offset:10752
    v_exp_f32 v167, v167
    s_waitcnt lgkmcnt(8)
    v_mfma_f32_32x32x16_bf16 v[16:31], v[104:107], a[72:75], v[16:31]
    ds_read_b64_tr_b16 v[96:97], v154 offset:12288
    ds_read_b64_tr_b16 v[98:99], v154 offset:12800
    v_cvt_pk_bf16_f32 v173, v58, v59
    v_mul_f32 v61, v61, v165
    v_mfma_f32_32x32x16_bf16 v[32:47], v[108:111], a[72:75], v[32:47]
    buffer_load_dwordx4 a[228:231], v2, s[32:35], s47 offen offset:2048 sc1
    ds_read_b64_tr_b16 v[100:101], v155 offset:12288
    ds_read_b64_tr_b16 v[102:103], v155 offset:12800
    v_rcp_f32 v166, v166
    v_add_f32 v167, 1.0, v167
    v_mfma_f32_32x32x16_bf16 v[16:31], v[112:115], a[76:79], v[16:31]
    ds_read_b64_tr_b16 v[104:105], v154 offset:14336
    ds_read_b64_tr_b16 v[106:107], v154 offset:14848
    v_mul_f32 v62, v62, v166
    v_rcp_f32 v167, v167
    v_cvt_pk_bf16_f32 v174, v60, v61
    v_mfma_f32_32x32x16_bf16 v[32:47], v[116:119], a[76:79], v[32:47]
    ds_read_b64_tr_b16 v[108:109], v155 offset:14336
    ds_read_b64_tr_b16 v[110:111], v155 offset:14848
    v_mul_f32 v63, v63, v167
    v_cvt_pk_bf16_f32 v175, v62, v63
    s_waitcnt lgkmcnt(8)
    v_mfma_f32_32x32x16_bf16 v[16:31], v[80:83], a[80:83], v[16:31]
    buffer_load_dwordx4 a[232:235], v2, s[32:35], s47 offen offset:3072 sc1
    s_barrier
    ds_read_b64_tr_b16 v[112:113], v154 offset:16384
    ds_read_b64_tr_b16 v[114:115], v154 offset:16896
    buffer_store_dwordx4 v[172:175], v184, s[36:39], 0 offen offset:256 sc1
    v_add_u32 v184, 8192, v184
    v_mul_f32 v160, s42, v64
    v_mfma_f32_32x32x16_bf16 v[32:47], v[84:87], a[80:83], v[32:47]
    ds_read_b64_tr_b16 v[116:117], v155 offset:16384
    ds_read_b64_tr_b16 v[118:119], v155 offset:16896
    v_exp_f32 v160, v160
    v_mul_f32 v161, s42, v65
    v_add_f32 v160, 1.0, v160
    v_mfma_f32_32x32x16_bf16 v[16:31], v[88:91], a[84:87], v[16:31]
    buffer_load_dwordx4 a[236:239], v3, s[32:35], s47 offen offset:0 sc1
    ds_read_b64_tr_b16 v[80:81], v154 offset:18432
    ds_read_b64_tr_b16 v[82:83], v154 offset:18944
    v_exp_f32 v161, v161
    v_mul_f32 v162, s42, v66
    v_mfma_f32_32x32x16_bf16 v[32:47], v[92:95], a[84:87], v[32:47]
    ds_read_b64_tr_b16 v[84:85], v155 offset:18432
    ds_read_b64_tr_b16 v[86:87], v155 offset:18944
    v_rcp_f32 v160, v160
    v_add_f32 v161, 1.0, v161
    s_waitcnt lgkmcnt(8)
    v_mfma_f32_32x32x16_bf16 v[16:31], v[96:99], a[88:91], v[16:31]
    ds_read_b64_tr_b16 v[88:89], v154 offset:20480
    ds_read_b64_tr_b16 v[90:91], v154 offset:20992
    v_exp_f32 v162, v162
    v_mul_f32 v163, s42, v67
    v_mul_f32 v64, v64, v160
    v_mfma_f32_32x32x16_bf16 v[32:47], v[100:103], a[88:91], v[32:47]
    buffer_load_dwordx4 a[0:3], v2, s[32:35], s48 offen offset:0 sc1
    ds_read_b64_tr_b16 v[92:93], v155 offset:20480
    ds_read_b64_tr_b16 v[94:95], v155 offset:20992
    v_rcp_f32 v161, v161
    v_add_f32 v162, 1.0, v162
    v_mfma_f32_32x32x16_bf16 v[16:31], v[104:107], a[92:95], v[16:31]
    ds_read_b64_tr_b16 v[96:97], v154 offset:22528
    ds_read_b64_tr_b16 v[98:99], v154 offset:23040
    v_exp_f32 v163, v163
    v_mul_f32 v164, s42, v68
    v_mul_f32 v65, v65, v161
    v_mfma_f32_32x32x16_bf16 v[32:47], v[108:111], a[92:95], v[32:47]
    buffer_load_dwordx4 a[4:7], v2, s[32:35], s48 offen offset:1024 sc1
    ds_read_b64_tr_b16 v[100:101], v155 offset:22528
    ds_read_b64_tr_b16 v[102:103], v155 offset:23040
    v_rcp_f32 v162, v162
    s_waitcnt lgkmcnt(8)
    v_mfma_f32_32x32x16_bf16 v[16:31], v[112:115], a[96:99], v[16:31]
    ds_read_b64_tr_b16 v[104:105], v154 offset:24576
    ds_read_b64_tr_b16 v[106:107], v154 offset:25088
    v_add_f32 v163, 1.0, v163
    v_exp_f32 v164, v164
    v_mul_f32 v165, s42, v69
    v_mfma_f32_32x32x16_bf16 v[32:47], v[116:119], a[96:99], v[32:47]
    ds_read_b64_tr_b16 v[108:109], v155 offset:24576
    ds_read_b64_tr_b16 v[110:111], v155 offset:25088
    v_mul_f32 v66, v66, v162
    v_rcp_f32 v163, v163
    v_add_f32 v164, 1.0, v164
    v_mfma_f32_32x32x16_bf16 v[16:31], v[80:83], a[100:103], v[16:31]
    buffer_load_dwordx4 a[8:11], v2, s[32:35], s48 offen offset:2048 sc1
    ds_read_b64_tr_b16 v[112:113], v154 offset:26624
    ds_read_b64_tr_b16 v[114:115], v154 offset:27136
    v_exp_f32 v165, v165
    v_mul_f32 v166, s42, v70
    v_mfma_f32_32x32x16_bf16 v[32:47], v[84:87], a[100:103], v[32:47]
    ds_read_b64_tr_b16 v[116:117], v155 offset:26624
    ds_read_b64_tr_b16 v[118:119], v155 offset:27136
    v_cvt_pk_bf16_f32 v176, v64, v65
    v_mul_f32 v67, v67, v163
    s_waitcnt lgkmcnt(8)
    v_mfma_f32_32x32x16_bf16 v[16:31], v[88:91], a[104:107], v[16:31]
    buffer_load_dwordx4 a[12:15], v2, s[32:35], s48 offen offset:3072 sc1
    ds_read_b64_tr_b16 v[80:81], v154 offset:28672
    ds_read_b64_tr_b16 v[82:83], v154 offset:29184
    v_rcp_f32 v164, v164
    v_add_f32 v165, 1.0, v165
    v_mfma_f32_32x32x16_bf16 v[32:47], v[92:95], a[104:107], v[32:47]
    ds_read_b64_tr_b16 v[84:85], v155 offset:28672
    ds_read_b64_tr_b16 v[86:87], v155 offset:29184
    v_exp_f32 v166, v166
    v_mul_f32 v167, s42, v71
    v_mul_f32 v68, v68, v164
    v_mfma_f32_32x32x16_bf16 v[16:31], v[96:99], a[108:111], v[16:31]
    ds_read_b64_tr_b16 v[88:89], v154 offset:30720
    ds_read_b64_tr_b16 v[90:91], v154 offset:31232
    v_rcp_f32 v165, v165
    v_add_f32 v166, 1.0, v166
    v_mfma_f32_32x32x16_bf16 v[32:47], v[100:103], a[108:111], v[32:47]
    buffer_load_dwordx4 a[16:19], v3, s[32:35], s48 offen offset:0 sc1
    ds_read_b64_tr_b16 v[92:93], v155 offset:30720
    ds_read_b64_tr_b16 v[94:95], v155 offset:31232
    v_exp_f32 v167, v167
    v_mul_f32 v160, s42, v72
    s_waitcnt lgkmcnt(8)
    v_mfma_f32_32x32x16_bf16 v[16:31], v[104:107], a[112:115], v[16:31]
    s_waitcnt vmcnt(28)
    s_barrier
    ds_read_b64_tr_b16 v[96:97], v154 offset:32768
    ds_read_b64_tr_b16 v[98:99], v154 offset:33280
    v_cvt_pk_bf16_f32 v177, v66, v67
    v_mul_f32 v69, v69, v165
    v_rcp_f32 v166, v166
    v_mfma_f32_32x32x16_bf16 v[32:47], v[108:111], a[112:115], v[32:47]
    buffer_load_dwordx4 a[20:23], v2, s[32:35], s49 offen offset:0 sc1
    ds_read_b64_tr_b16 v[100:101], v155 offset:32768
    ds_read_b64_tr_b16 v[102:103], v155 offset:33280
    v_add_f32 v167, 1.0, v167
    v_exp_f32 v160, v160
    v_mfma_f32_32x32x16_bf16 v[16:31], v[112:115], a[116:119], v[16:31]
    ds_read_b64_tr_b16 v[104:105], v154 offset:34816
    ds_read_b64_tr_b16 v[106:107], v154 offset:35328
    v_mul_f32 v161, s42, v73
    v_mul_f32 v70, v70, v166
    v_rcp_f32 v167, v167
    v_mfma_f32_32x32x16_bf16 v[32:47], v[116:119], a[116:119], v[32:47]
    ds_read_b64_tr_b16 v[108:109], v155 offset:34816
    ds_read_b64_tr_b16 v[110:111], v155 offset:35328
    v_add_f32 v160, 1.0, v160
    v_exp_f32 v161, v161
    s_waitcnt lgkmcnt(8)
    v_mfma_f32_32x32x16_bf16 v[16:31], v[80:83], a[120:123], v[16:31]
    buffer_load_dwordx4 a[24:27], v2, s[32:35], s49 offen offset:1024 sc1
    ds_read_b64_tr_b16 v[112:113], v154 offset:36864
    ds_read_b64_tr_b16 v[114:115], v154 offset:37376
    v_mul_f32 v162, s42, v74
    v_cvt_pk_bf16_f32 v178, v68, v69
    v_mfma_f32_32x32x16_bf16 v[32:47], v[84:87], a[120:123], v[32:47]
    ds_read_b64_tr_b16 v[116:117], v155 offset:36864
    ds_read_b64_tr_b16 v[118:119], v155 offset:37376
    v_mul_f32 v71, v71, v167
    v_rcp_f32 v160, v160
    v_add_f32 v161, 1.0, v161
    v_mfma_f32_32x32x16_bf16 v[16:31], v[88:91], a[124:127], v[16:31]
    buffer_load_dwordx4 a[28:31], v2, s[32:35], s49 offen offset:2048 sc1
    ds_read_b64_tr_b16 v[80:81], v154 offset:38912
    ds_read_b64_tr_b16 v[82:83], v154 offset:39424
    v_exp_f32 v162, v162
    v_mul_f32 v163, s42, v75
    v_mfma_f32_32x32x16_bf16 v[32:47], v[92:95], a[124:127], v[32:47]
    ds_read_b64_tr_b16 v[84:85], v155 offset:38912
    ds_read_b64_tr_b16 v[86:87], v155 offset:39424
    v_mul_f32 v72, v72, v160
    v_rcp_f32 v161, v161
    s_waitcnt lgkmcnt(8)
    v_mfma_f32_32x32x16_bf16 v[16:31], v[96:99], a[128:131], v[16:31]
    ds_read_b64_tr_b16 v[88:89], v154 offset:40960
    ds_read_b64_tr_b16 v[90:91], v154 offset:41472
    v_add_f32 v162, 1.0, v162
    v_exp_f32 v163, v163
    v_mul_f32 v164, s42, v76
    v_mfma_f32_32x32x16_bf16 v[32:47], v[100:103], a[128:131], v[32:47]
    buffer_load_dwordx4 a[32:35], v2, s[32:35], s49 offen offset:3072 sc1
    ds_read_b64_tr_b16 v[92:93], v155 offset:40960
    ds_read_b64_tr_b16 v[94:95], v155 offset:41472
    v_cvt_pk_bf16_f32 v179, v70, v71
    buffer_store_dwordx4 v[176:179], v184, s[36:39], 0 offen offset:0 sc1
    v_mfma_f32_32x32x16_bf16 v[16:31], v[104:107], a[132:135], v[16:31]
    ds_read_b64_tr_b16 v[96:97], v154 offset:43008
    ds_read_b64_tr_b16 v[98:99], v154 offset:43520
    v_mul_f32 v73, v73, v161
    v_rcp_f32 v162, v162
    v_add_f32 v163, 1.0, v163
    v_mfma_f32_32x32x16_bf16 v[32:47], v[108:111], a[132:135], v[32:47]
    buffer_load_dwordx4 a[36:39], v3, s[32:35], s49 offen offset:0 sc1
    ds_read_b64_tr_b16 v[100:101], v155 offset:43008
    ds_read_b64_tr_b16 v[102:103], v155 offset:43520
    v_exp_f32 v164, v164
    s_waitcnt lgkmcnt(8)
    v_mfma_f32_32x32x16_bf16 v[16:31], v[112:115], a[136:139], v[16:31]
    ds_read_b64_tr_b16 v[104:105], v154 offset:45056
    ds_read_b64_tr_b16 v[106:107], v154 offset:45568
    v_mul_f32 v165, s42, v77
    v_mul_f32 v74, v74, v162
    v_rcp_f32 v163, v163
    v_mfma_f32_32x32x16_bf16 v[32:47], v[116:119], a[136:139], v[32:47]
    ds_read_b64_tr_b16 v[108:109], v155 offset:45056
    ds_read_b64_tr_b16 v[110:111], v155 offset:45568
    v_add_f32 v164, 1.0, v164
    v_exp_f32 v165, v165
    v_mul_f32 v166, s42, v78
    v_mfma_f32_32x32x16_bf16 v[16:31], v[80:83], a[140:143], v[16:31]
    buffer_load_dwordx4 a[40:43], v2, s[32:35], s50 offen offset:0 sc1
    ds_read_b64_tr_b16 v[112:113], v154 offset:47104
    ds_read_b64_tr_b16 v[114:115], v154 offset:47616
    v_cvt_pk_bf16_f32 v180, v72, v73
    v_mul_f32 v75, v75, v163
    v_mfma_f32_32x32x16_bf16 v[32:47], v[84:87], a[140:143], v[32:47]
    ds_read_b64_tr_b16 v[116:117], v155 offset:47104
    ds_read_b64_tr_b16 v[118:119], v155 offset:47616
    s_mov_b32 s64, 0x30000
    s_mov_b32 s65, 0x0
    s_waitcnt vmcnt(13)
    buffer_store_dword v253, v254, s[12:15], s64 offen
    buffer_store_dword v253, v254, s[12:15], s65 offen sc1
    v_rcp_f32 v164, v164
    v_add_f32 v165, 1.0, v165
    s_waitcnt lgkmcnt(8)
    v_mfma_f32_32x32x16_bf16 v[16:31], v[88:91], a[144:147], v[16:31]
    buffer_load_dwordx4 a[44:47], v2, s[32:35], s50 offen offset:1024 sc1
    v_exp_f32 v166, v166
    v_mul_f32 v167, s42, v79
    v_mul_f32 v76, v76, v164
    v_mfma_f32_32x32x16_bf16 v[32:47], v[92:95], a[144:147], v[32:47]
    v_rcp_f32 v165, v165
    v_add_f32 v166, 1.0, v166
    v_exp_f32 v167, v167
    v_mfma_f32_32x32x16_bf16 v[16:31], v[96:99], a[148:151], v[16:31]
    v_cvt_pk_bf16_f32 v181, v74, v75
    v_mul_f32 v77, v77, v165
    v_rcp_f32 v166, v166
    v_add_f32 v167, 1.0, v167
    v_mfma_f32_32x32x16_bf16 v[32:47], v[100:103], a[148:151], v[32:47]
    buffer_load_dwordx4 a[48:51], v2, s[32:35], s50 offen offset:2048 sc1
    v_mul_f32 v78, v78, v166
    v_rcp_f32 v167, v167
    s_waitcnt lgkmcnt(0)
    v_mfma_f32_32x32x16_bf16 v[16:31], v[104:107], a[152:155], v[16:31]
    v_cvt_pk_bf16_f32 v182, v76, v77
    v_mul_f32 v79, v79, v167
    v_cvt_pk_bf16_f32 v183, v78, v79
    buffer_store_dwordx4 v[180:183], v184, s[36:39], 0 offen offset:256 sc1
    v_add_u32 v184, 8192, v184
    v_mfma_f32_32x32x16_bf16 v[32:47], v[108:111], a[152:155], v[32:47]
    buffer_load_dwordx4 a[52:55], v2, s[32:35], s50 offen offset:3072 sc1
    v_mfma_f32_32x32x16_bf16 v[16:31], v[112:115], a[156:159], v[16:31]
    v_mfma_f32_32x32x16_bf16 v[32:47], v[116:119], a[156:159], v[32:47]
    buffer_load_dwordx4 a[56:59], v3, s[32:35], s50 offen offset:0 sc1
    s_nop 9
    v_mul_f32 v160, s42, v16
    v_exp_f32 v160, v160
    v_mul_f32 v161, s42, v17
    v_add_f32 v160, 1.0, v160
    v_exp_f32 v161, v161
    v_mul_f32 v162, s42, v18
    v_rcp_f32 v160, v160
    v_add_f32 v161, 1.0, v161
    v_exp_f32 v162, v162
    v_mul_f32 v163, s42, v19
    v_mul_f32 v16, v16, v160
    v_rcp_f32 v161, v161
    v_add_f32 v162, 1.0, v162
    v_exp_f32 v163, v163
    v_mul_f32 v164, s42, v20
    v_mul_f32 v17, v17, v161
    v_rcp_f32 v162, v162
    v_add_f32 v163, 1.0, v163
    v_exp_f32 v164, v164
    v_mul_f32 v165, s42, v21
    v_mul_f32 v18, v18, v162
    v_rcp_f32 v163, v163
    v_add_f32 v164, 1.0, v164
    v_exp_f32 v165, v165
    v_mul_f32 v166, s42, v22
    v_cvt_pk_bf16_f32 v168, v16, v17
    v_mul_f32 v19, v19, v163
    v_rcp_f32 v164, v164
    v_add_f32 v165, 1.0, v165
    v_exp_f32 v166, v166
    v_mul_f32 v167, s42, v23
    v_mul_f32 v20, v20, v164
    v_rcp_f32 v165, v165
    v_add_f32 v166, 1.0, v166
    v_exp_f32 v167, v167
    v_mul_f32 v160, s42, v24
    v_cvt_pk_bf16_f32 v169, v18, v19
    v_mul_f32 v21, v21, v165
    v_rcp_f32 v166, v166
    v_add_f32 v167, 1.0, v167
    v_exp_f32 v160, v160
    v_mul_f32 v161, s42, v25
    v_mul_f32 v22, v22, v166
    v_rcp_f32 v167, v167
    v_add_f32 v160, 1.0, v160
    v_exp_f32 v161, v161
    v_mul_f32 v162, s42, v26
    v_cvt_pk_bf16_f32 v170, v20, v21
    v_mul_f32 v23, v23, v167
    v_rcp_f32 v160, v160
    v_add_f32 v161, 1.0, v161
    v_exp_f32 v162, v162
    v_mul_f32 v163, s42, v27
    v_mul_f32 v24, v24, v160
    v_rcp_f32 v161, v161
    v_add_f32 v162, 1.0, v162
    v_exp_f32 v163, v163
    v_mul_f32 v164, s42, v28
    v_cvt_pk_bf16_f32 v171, v22, v23
    buffer_store_dwordx4 v[168:171], v184, s[36:39], 0 offen offset:0 sc1
    s_and_b32 s98, s76, 0x63
    s_lshl_b32 s99, s72, 3
    s_add_u32 s98, s98, s99
    s_lshl_b32 s98, s98, 9
    s_add_u32 s98, s98, 393216
    v_bfe_u32 v4, v1, 2, 1
    v_lshlrev_b32 v4, 11, v4
    v_and_b32 v5, 3, v1
    v_lshl_add_u32 v4, v5, 7, v4
    v_add_u32 v4, s98, v4
    s_mov_b32 s64, 0x30000
    buffer_load_dword v5, v4, s[12:15], s64 offen sc1
    v_mul_f32 v25, v25, v161
    v_rcp_f32 v162, v162
    v_add_f32 v163, 1.0, v163
    v_exp_f32 v164, v164
    v_mul_f32 v165, s42, v29
    v_mul_f32 v26, v26, v162
    v_rcp_f32 v163, v163
    v_add_f32 v164, 1.0, v164
    v_exp_f32 v165, v165
    v_mul_f32 v166, s42, v30
    v_cvt_pk_bf16_f32 v172, v24, v25
    v_mul_f32 v27, v27, v163
    v_rcp_f32 v164, v164
    v_add_f32 v165, 1.0, v165
    v_exp_f32 v166, v166
    v_mul_f32 v167, s42, v31
    v_mul_f32 v28, v28, v164
    v_rcp_f32 v165, v165
    v_add_f32 v166, 1.0, v166
    v_exp_f32 v167, v167
    v_cvt_pk_bf16_f32 v173, v26, v27
    v_mul_f32 v29, v29, v165
    v_rcp_f32 v166, v166
    v_add_f32 v167, 1.0, v167
    v_mul_f32 v30, v30, v166
    v_rcp_f32 v167, v167
    v_cvt_pk_bf16_f32 v174, v28, v29
    v_mul_f32 v31, v31, v167
    v_cvt_pk_bf16_f32 v175, v30, v31
    buffer_store_dwordx4 v[172:175], v184, s[36:39], 0 offen offset:256 sc1
    v_add_u32 v184, 8192, v184
    v_mul_f32 v160, s42, v32
    v_exp_f32 v160, v160
    v_mul_f32 v161, s42, v33
    v_add_f32 v160, 1.0, v160
    v_exp_f32 v161, v161
    v_mul_f32 v162, s42, v34
    v_rcp_f32 v160, v160
    v_add_f32 v161, 1.0, v161
    v_exp_f32 v162, v162
    v_mul_f32 v163, s42, v35
    v_mul_f32 v32, v32, v160
    v_rcp_f32 v161, v161
    v_add_f32 v162, 1.0, v162
    v_exp_f32 v163, v163
    v_mul_f32 v164, s42, v36
    v_mul_f32 v33, v33, v161
    v_rcp_f32 v162, v162
    v_add_f32 v163, 1.0, v163
    v_exp_f32 v164, v164
    v_mul_f32 v165, s42, v37
    v_mul_f32 v34, v34, v162
    v_rcp_f32 v163, v163
    v_add_f32 v164, 1.0, v164
    v_exp_f32 v165, v165
    v_mul_f32 v166, s42, v38
    v_cvt_pk_bf16_f32 v176, v32, v33
    v_mul_f32 v35, v35, v163
    v_rcp_f32 v164, v164
    v_add_f32 v165, 1.0, v165
    v_exp_f32 v166, v166
    v_mul_f32 v167, s42, v39
    v_mul_f32 v36, v36, v164
    v_rcp_f32 v165, v165
    v_add_f32 v166, 1.0, v166
    v_exp_f32 v167, v167
    v_mul_f32 v160, s42, v40
    v_cvt_pk_bf16_f32 v177, v34, v35
    v_mul_f32 v37, v37, v165
    v_rcp_f32 v166, v166
    v_add_f32 v167, 1.0, v167
    v_exp_f32 v160, v160
    v_mul_f32 v161, s42, v41
    v_mul_f32 v38, v38, v166
    v_rcp_f32 v167, v167
    v_add_f32 v160, 1.0, v160
    v_exp_f32 v161, v161
    v_mul_f32 v162, s42, v42
    v_cvt_pk_bf16_f32 v178, v36, v37
    v_mul_f32 v39, v39, v167
    v_rcp_f32 v160, v160
    v_add_f32 v161, 1.0, v161
    v_exp_f32 v162, v162
    v_mul_f32 v163, s42, v43
    v_mul_f32 v40, v40, v160
    v_rcp_f32 v161, v161
    v_add_f32 v162, 1.0, v162
    v_exp_f32 v163, v163
    v_mul_f32 v164, s42, v44
    v_cvt_pk_bf16_f32 v179, v38, v39
    buffer_store_dwordx4 v[176:179], v184, s[36:39], 0 offen offset:0 sc1
    v_mul_f32 v41, v41, v161
    v_rcp_f32 v162, v162
    v_add_f32 v163, 1.0, v163
    v_exp_f32 v164, v164
    v_mul_f32 v165, s42, v45
    v_mul_f32 v42, v42, v162
    v_rcp_f32 v163, v163
    v_add_f32 v164, 1.0, v164
    v_exp_f32 v165, v165
    v_mul_f32 v166, s42, v46
    v_cvt_pk_bf16_f32 v180, v40, v41
    v_mul_f32 v43, v43, v163
    v_rcp_f32 v164, v164
    v_add_f32 v165, 1.0, v165
    v_exp_f32 v166, v166
    v_mul_f32 v167, s42, v47
    v_mul_f32 v44, v44, v164
    v_rcp_f32 v165, v165
    v_add_f32 v166, 1.0, v166
    v_exp_f32 v167, v167
    v_cvt_pk_bf16_f32 v181, v42, v43
    v_mul_f32 v45, v45, v165
    v_rcp_f32 v166, v166
    v_add_f32 v167, 1.0, v167
    v_mul_f32 v46, v46, v166
    v_rcp_f32 v167, v167
    v_cvt_pk_bf16_f32 v182, v44, v45
    v_mul_f32 v47, v47, v167
    v_cvt_pk_bf16_f32 v183, v46, v47
    buffer_store_dwordx4 v[180:183], v184, s[36:39], 0 offen offset:256 sc1
    v_add_u32 v184, 8192, v184
    s_mov_b32 s64, 0xa0000
    s_mov_b32 s65, 0x20000
    s_waitcnt vmcnt(7)
    buffer_store_dword v253, v254, s[12:15], s64 offen
    buffer_store_dword v253, v254, s[12:15], s65 offen sc1
    s_waitcnt vmcnt(5)
    v_cmp_ne_u32 vcc, s78, v5
    s_nop 0
    s_cmp_eq_u64 vcc, 0
    s_cbranch_scc0 L_h10_retry_3
L_h10_ok_4:
    buffer_load_dwordx4 v[96:99], v3, s[36:39], s60 offen offset:0 sc1
    buffer_load_dwordx4 v[100:103], v3, s[36:39], s60 offen offset:1024 sc1
    buffer_load_dwordx4 v[104:107], v3, s[36:39], s60 offen offset:2048 sc1
    buffer_load_dwordx4 v[108:111], v3, s[36:39], s60 offen offset:3072 sc1
    buffer_load_dwordx4 v[112:115], v3, s[36:39], s61 offen offset:0 sc1
    buffer_load_dwordx4 v[116:119], v3, s[36:39], s61 offen offset:1024 sc1
    buffer_load_dwordx4 v[120:123], v3, s[36:39], s61 offen offset:2048 sc1
    buffer_load_dwordx4 v[124:127], v3, s[36:39], s61 offen offset:3072 sc1
    buffer_load_dwordx4 v[128:131], v3, s[36:39], s62 offen offset:0 sc1
    buffer_load_dwordx4 v[132:135], v3, s[36:39], s62 offen offset:1024 sc1
    buffer_load_dwordx4 v[136:139], v3, s[36:39], s62 offen offset:2048 sc1
    buffer_load_dwordx4 v[140:143], v3, s[36:39], s62 offen offset:3072 sc1
    s_waitcnt vmcnt(11)
    v_mfma_f32_16x16x32_bf16 v[16:19], a[160:163], v[96:99], 0
    buffer_load_dwordx4 v[144:147], v3, s[36:39], s63 offen offset:0 sc1
    v_mfma_f32_16x16x32_bf16 v[20:23], a[164:167], v[96:99], 0
    s_lshl_b32 s98, s74, 3
    s_add_u32 s98, s98, s72
    v_mfma_f32_16x16x32_bf16 v[24:27], a[168:171], v[96:99], 0
    buffer_load_dwordx4 a[60:63], v2, s[32:35], s51 offen offset:0 sc1
    s_lshl_b32 s98, s98, 4
    v_mfma_f32_16x16x32_bf16 v[28:31], a[172:175], v[96:99], 0
    s_mul_i32 s99, s75, 160
    s_mul_i32 s100, s72, 5376
    v_mfma_f32_16x16x32_bf16 v[32:35], a[176:179], v[96:99], 0
    s_mov_b32 s92, 0xffff0000
    s_waitcnt vmcnt(12)
    v_mfma_f32_16x16x32_bf16 v[36:39], a[160:163], v[100:103], 0
    buffer_load_dwordx4 v[148:151], v3, s[36:39], s63 offen offset:1024 sc1
    s_mov_b32 s64, 0x70000
    s_mov_b32 s65, 0x40000
    buffer_store_dword v253, v254, s[12:15], s64 offen
    buffer_store_dword v253, v254, s[12:15], s65 offen sc1
    v_mfma_f32_16x16x32_bf16 v[40:43], a[164:167], v[100:103], 0
    buffer_load_dwordx4 a[64:67], v2, s[32:35], s51 offen offset:1024 sc1
    s_mov_b32 s101, 81920
    v_mfma_f32_16x16x32_bf16 v[44:47], a[168:171], v[100:103], 0
    v_bfe_u32 v180, v1, 4, 1
    v_mfma_f32_16x16x32_bf16 v[48:51], a[172:175], v[100:103], 0
    v_and_b32 v181, 15, v1
    v_mfma_f32_16x16x32_bf16 v[52:55], a[176:179], v[100:103], 0
    s_waitcnt vmcnt(15)
    v_mfma_f32_16x16x32_bf16 v[56:59], a[160:163], v[104:107], 0
    buffer_load_dwordx4 v[152:155], v3, s[36:39], s63 offen offset:2048 sc1
    buffer_load_dwordx4 a[68:71], v2, s[32:35], s51 offen offset:2048 sc1
    v_mfma_f32_16x16x32_bf16 v[60:63], a[164:167], v[104:107], 0
    v_lshl_add_u32 v180, v180, 6, v181
    v_mfma_f32_16x16x32_bf16 v[64:67], a[168:171], v[104:107], 0
    v_add_u32 v180, s98, v180
    v_lshlrev_b32 v180, 4, v180
    v_mfma_f32_16x16x32_bf16 v[68:71], a[172:175], v[104:107], 0
    v_add_u32 v165, 65536, v180
    v_mfma_f32_16x16x32_bf16 v[72:75], a[176:179], v[104:107], 0
    buffer_load_dwordx4 a[72:75], v2, s[32:35], s51 offen offset:3072 sc1
    v_add_u32 v180, 0, v1
    s_waitcnt vmcnt(17)
    v_mfma_f32_16x16x32_bf16 v[76:79], a[160:163], v[108:111], 0
    buffer_load_dwordx4 v[156:159], v3, s[36:39], s63 offen offset:3072 sc1
    v_mul_u32_u24 v181, 3277, v180
    v_mfma_f32_16x16x32_bf16 v[80:83], a[164:167], v[108:111], 0
    v_lshrrev_b32 v181, 16, v181
    v_mul_u32_u24 v182, 20, v181
    v_mfma_f32_16x16x32_bf16 v[84:87], a[168:171], v[108:111], 0
    v_sub_u32 v182, v180, v182
    v_lshrrev_b32 v183, 2, v182
    v_mfma_f32_16x16x32_bf16 v[88:91], a[172:175], v[108:111], 0
    buffer_load_dwordx4 a[76:79], v3, s[32:35], s51 offen offset:0 sc1
    v_mfma_f32_16x16x32_bf16 v[92:95], a[176:179], v[108:111], 0
    v_mul_u32_u24 v7, 272, v183
    s_waitcnt vmcnt(18)
    v_mfma_f32_16x16x32_bf16 v[16:19], a[180:183], v[112:115], v[16:19]
    buffer_load_dwordx4 v[96:99], v3, s[36:39], s66 offen offset:0 sc1
    v_and_b32 v183, 3, v182
    v_mfma_f32_16x16x32_bf16 v[20:23], a[184:187], v[112:115], v[20:23]
    v_mul_u32_u24 v183, 1344, v183
    v_mfma_f32_16x16x32_bf16 v[24:27], a[188:191], v[112:115], v[24:27]
    buffer_load_dwordx4 a[80:83], v2, s[32:35], s52 offen offset:0 sc1
    v_add3_u32 v7, v7, v183, s100
    v_mfma_f32_16x16x32_bf16 v[28:31], a[192:195], v[112:115], v[28:31]
    v_lshl_add_u32 v7, v181, 4, v7
    v_mfma_f32_16x16x32_bf16 v[32:35], a[196:199], v[112:115], v[32:35]
    v_lshlrev_b32 v160, 2, v181
    v_add_u32 v181, s98, v181
    s_waitcnt vmcnt(19)
    v_mfma_f32_16x16x32_bf16 v[36:39], a[180:183], v[116:119], v[36:39]
    buffer_load_dwordx4 v[100:103], v3, s[36:39], s66 offen offset:1024 sc1
    v_lshl_add_u32 v182, v182, 3, s99
    v_mfma_f32_16x16x32_bf16 v[40:43], a[184:187], v[116:119], v[40:43]
    buffer_load_dwordx4 a[84:87], v2, s[32:35], s52 offen offset:1024 sc1
    v_mul_u32_u24 v180, 1280, v181
    v_mfma_f32_16x16x32_bf16 v[44:47], a[188:191], v[116:119], v[44:47]
    v_add_u32 v180, v180, v182
    v_lshlrev_b32 v12, 1, v180
    v_mfma_f32_16x16x32_bf16 v[48:51], a[192:195], v[116:119], v[48:51]
    v_add_u32 v180, 64, v1
    v_mfma_f32_16x16x32_bf16 v[52:55], a[196:199], v[116:119], v[52:55]
    v_mul_u32_u24 v181, 3277, v180
    s_waitcnt vmcnt(20)
    v_mfma_f32_16x16x32_bf16 v[56:59], a[180:183], v[120:123], v[56:59]
    buffer_load_dwordx4 v[104:107], v3, s[36:39], s66 offen offset:2048 sc1
    buffer_load_dwordx4 a[88:91], v2, s[32:35], s52 offen offset:2048 sc1
    v_lshrrev_b32 v181, 16, v181
    v_mfma_f32_16x16x32_bf16 v[60:63], a[184:187], v[120:123], v[60:63]
    v_mul_u32_u24 v182, 20, v181
    v_sub_u32 v182, v180, v182
    v_mfma_f32_16x16x32_bf16 v[64:67], a[188:191], v[120:123], v[64:67]
    v_lshrrev_b32 v183, 2, v182
    v_mfma_f32_16x16x32_bf16 v[68:71], a[192:195], v[120:123], v[68:71]
    v_mul_u32_u24 v8, 272, v183
    v_mfma_f32_16x16x32_bf16 v[72:75], a[196:199], v[120:123], v[72:75]
    buffer_load_dwordx4 a[92:95], v2, s[32:35], s52 offen offset:3072 sc1
    s_waitcnt vmcnt(22)
    v_mfma_f32_16x16x32_bf16 v[76:79], a[180:183], v[124:127], v[76:79]
    buffer_load_dwordx4 v[108:111], v3, s[36:39], s66 offen offset:3072 sc1
    v_and_b32 v183, 3, v182
    v_mul_u32_u24 v183, 1344, v183
    v_mfma_f32_16x16x32_bf16 v[80:83], a[184:187], v[124:127], v[80:83]
    v_add3_u32 v8, v8, v183, s100
    v_mfma_f32_16x16x32_bf16 v[84:87], a[188:191], v[124:127], v[84:87]
    v_lshl_add_u32 v8, v181, 4, v8
    v_mfma_f32_16x16x32_bf16 v[88:91], a[192:195], v[124:127], v[88:91]
    buffer_load_dwordx4 a[96:99], v3, s[32:35], s52 offen offset:0 sc1
    v_lshlrev_b32 v161, 2, v181
    v_mfma_f32_16x16x32_bf16 v[92:95], a[196:199], v[124:127], v[92:95]
    v_add_u32 v181, s98, v181
    s_waitcnt vmcnt(23)
    v_mfma_f32_16x16x32_bf16 v[16:19], a[200:203], v[128:131], v[16:19]
    buffer_load_dwordx4 v[112:115], v3, s[36:39], s67 offen offset:0 sc1
    v_lshl_add_u32 v182, v182, 3, s99
    v_mfma_f32_16x16x32_bf16 v[20:23], a[204:207], v[128:131], v[20:23]
    v_mul_u32_u24 v180, 1280, v181
    v_mfma_f32_16x16x32_bf16 v[24:27], a[208:211], v[128:131], v[24:27]
    buffer_load_dwordx4 a[100:103], v2, s[32:35], s53 offen offset:0 sc1
    v_add_u32 v180, v180, v182
    v_lshlrev_b32 v13, 1, v180
    v_mfma_f32_16x16x32_bf16 v[28:31], a[212:215], v[128:131], v[28:31]
    s_mov_b32 s64, 0xa0000
    buffer_load_dword v5, v4, s[12:15], s64 offen sc1
    v_add_u32 v180, 128, v1
    v_mfma_f32_16x16x32_bf16 v[32:35], a[216:219], v[128:131], v[32:35]
    v_mul_u32_u24 v181, 3277, v180
    s_waitcnt vmcnt(25)
    v_mfma_f32_16x16x32_bf16 v[36:39], a[200:203], v[132:135], v[36:39]
    buffer_load_dwordx4 v[116:119], v3, s[36:39], s67 offen offset:1024 sc1
    v_lshrrev_b32 v181, 16, v181
    v_mfma_f32_16x16x32_bf16 v[40:43], a[204:207], v[132:135], v[40:43]
    buffer_load_dwordx4 a[104:107], v2, s[32:35], s53 offen offset:1024 sc1
    v_mul_u32_u24 v182, 20, v181
    v_mfma_f32_16x16x32_bf16 v[44:47], a[208:211], v[132:135], v[44:47]
    v_sub_u32 v182, v180, v182
    v_lshrrev_b32 v183, 2, v182
    v_mfma_f32_16x16x32_bf16 v[48:51], a[212:215], v[132:135], v[48:51]
    v_mul_u32_u24 v9, 272, v183
    v_mfma_f32_16x16x32_bf16 v[52:55], a[216:219], v[132:135], v[52:55]
    v_and_b32 v183, 3, v182
    s_waitcnt vmcnt(26)
    v_mfma_f32_16x16x32_bf16 v[56:59], a[200:203], v[136:139], v[56:59]
    buffer_load_dwordx4 v[120:123], v3, s[36:39], s67 offen offset:2048 sc1
    buffer_load_dwordx4 a[108:111], v2, s[32:35], s53 offen offset:2048 sc1
    v_mul_u32_u24 v183, 1344, v183
    v_mfma_f32_16x16x32_bf16 v[60:63], a[204:207], v[136:139], v[60:63]
    v_add3_u32 v9, v9, v183, s100
    v_mfma_f32_16x16x32_bf16 v[64:67], a[208:211], v[136:139], v[64:67]
    v_lshl_add_u32 v9, v181, 4, v9
    v_mfma_f32_16x16x32_bf16 v[68:71], a[212:215], v[136:139], v[68:71]
    v_lshlrev_b32 v162, 2, v181
    v_add_u32 v181, s98, v181
    v_mfma_f32_16x16x32_bf16 v[72:75], a[216:219], v[136:139], v[72:75]
    buffer_load_dwordx4 a[112:115], v2, s[32:35], s53 offen offset:3072 sc1
    v_lshl_add_u32 v182, v182, 3, s99
    s_waitcnt vmcnt(28)
    v_mfma_f32_16x16x32_bf16 v[76:79], a[200:203], v[140:143], v[76:79]
    buffer_load_dwordx4 v[124:127], v3, s[36:39], s67 offen offset:3072 sc1
    v_mul_u32_u24 v180, 1280, v181
    v_mfma_f32_16x16x32_bf16 v[80:83], a[204:207], v[140:143], v[80:83]
    v_add_u32 v180, v180, v182
    v_lshlrev_b32 v14, 1, v180
    v_mfma_f32_16x16x32_bf16 v[84:87], a[208:211], v[140:143], v[84:87]
    v_add_u32 v180, 192, v1
    v_mfma_f32_16x16x32_bf16 v[88:91], a[212:215], v[140:143], v[88:91]
    buffer_load_dwordx4 a[116:119], v3, s[32:35], s53 offen offset:0 sc1
    v_mfma_f32_16x16x32_bf16 v[92:95], a[216:219], v[140:143], v[92:95]
    v_mul_u32_u24 v181, 3277, v180
    s_waitcnt vmcnt(29)
    v_mfma_f32_16x16x32_bf16 v[16:19], a[220:223], v[144:147], v[16:19]
    s_waitcnt vmcnt(7)
    v_cmp_ne_u32 vcc, s78, v5
    s_nop 0
    s_cmp_eq_u64 vcc, 0
    s_cbranch_scc0 L_h11_retry_5
L_h11_ok_6:
    buffer_load_dwordx4 v[128:131], v3, s[36:39], s68 offen offset:0 sc1
    v_lshrrev_b32 v181, 16, v181
    v_mfma_f32_16x16x32_bf16 v[20:23], a[224:227], v[144:147], v[20:23]
    v_mul_u32_u24 v182, 20, v181
    v_sub_u32 v182, v180, v182
    v_mfma_f32_16x16x32_bf16 v[24:27], a[228:231], v[144:147], v[24:27]
    buffer_load_dwordx4 a[120:123], v2, s[32:35], s58 offen offset:0 sc1
    v_lshrrev_b32 v183, 2, v182
    v_mfma_f32_16x16x32_bf16 v[28:31], a[232:235], v[144:147], v[28:31]
    v_mul_u32_u24 v10, 272, v183
    v_mfma_f32_16x16x32_bf16 v[32:35], a[236:239], v[144:147], v[32:35]
    v_and_b32 v183, 3, v182
    v_mfma_f32_16x16x32_bf16 v[36:39], a[220:223], v[148:151], v[36:39]
    buffer_load_dwordx4 v[132:135], v3, s[36:39], s68 offen offset:1024 sc1
    v_mul_u32_u24 v183, 1344, v183
    v_mfma_f32_16x16x32_bf16 v[40:43], a[224:227], v[148:151], v[40:43]
    buffer_load_dwordx4 a[124:127], v2, s[32:35], s58 offen offset:1024 sc1
    v_add3_u32 v10, v10, v183, s100
    v_mfma_f32_16x16x32_bf16 v[44:47], a[228:231], v[148:151], v[44:47]
    v_lshl_add_u32 v10, v181, 4, v10
    v_mfma_f32_16x16x32_bf16 v[48:51], a[232:235], v[148:151], v[48:51]
    v_lshlrev_b32 v163, 2, v181
    v_add_u32 v181, s98, v181
    v_mfma_f32_16x16x32_bf16 v[52:55], a[236:239], v[148:151], v[52:55]
    v_lshl_add_u32 v182, v182, 3, s99
    v_mfma_f32_16x16x32_bf16 v[56:59], a[220:223], v[152:155], v[56:59]
    buffer_load_dwordx4 v[136:139], v3, s[36:39], s68 offen offset:2048 sc1
    buffer_load_dwordx4 a[128:131], v2, s[32:35], s58 offen offset:2048 sc1
    v_mul_u32_u24 v180, 1280, v181
    v_mfma_f32_16x16x32_bf16 v[60:63], a[224:227], v[152:155], v[60:63]
    v_add_u32 v180, v180, v182
    v_lshlrev_b32 v15, 1, v180
    v_mfma_f32_16x16x32_bf16 v[64:67], a[228:231], v[152:155], v[64:67]
    v_add_u32 v180, 256, v1
    v_mfma_f32_16x16x32_bf16 v[68:71], a[232:235], v[152:155], v[68:71]
    v_mul_u32_u24 v181, 3277, v180
    v_mfma_f32_16x16x32_bf16 v[72:75], a[236:239], v[152:155], v[72:75]
    buffer_load_dwordx4 a[132:135], v2, s[32:35], s58 offen offset:3072 sc1
    v_lshrrev_b32 v181, 16, v181
    v_mfma_f32_16x16x32_bf16 v[76:79], a[220:223], v[156:159], v[76:79]
    buffer_load_dwordx4 v[140:143], v3, s[36:39], s68 offen offset:3072 sc1
    v_mul_u32_u24 v182, 20, v181
    v_mfma_f32_16x16x32_bf16 v[80:83], a[224:227], v[156:159], v[80:83]
    v_sub_u32 v182, v180, v182
    v_lshrrev_b32 v183, 2, v182
    v_mfma_f32_16x16x32_bf16 v[84:87], a[228:231], v[156:159], v[84:87]
    v_mul_u32_u24 v11, 272, v183
    v_mfma_f32_16x16x32_bf16 v[88:91], a[232:235], v[156:159], v[88:91]
    buffer_load_dwordx4 a[136:139], v3, s[32:35], s58 offen offset:0 sc1
    v_and_b32 v183, 3, v182
    v_mfma_f32_16x16x32_bf16 v[92:95], a[236:239], v[156:159], v[92:95]
    s_barrier
    v_mul_u32_u24 v183, 1344, v183
    v_mfma_f32_16x16x32_bf16 v[16:19], a[0:3], v[96:99], v[16:19]
    buffer_load_dwordx4 v[144:147], v3, s[36:39], s69 offen offset:0 sc1
    v_add3_u32 v11, v11, v183, s100
    v_mfma_f32_16x16x32_bf16 v[20:23], a[4:7], v[96:99], v[20:23]
    v_lshl_add_u32 v11, v181, 4, v11
    v_mfma_f32_16x16x32_bf16 v[24:27], a[8:11], v[96:99], v[24:27]
    buffer_load_dwordx4 a[140:143], v2, s[32:35], s59 offen offset:0 sc1
    v_lshlrev_b32 v164, 2, v181
    v_mfma_f32_16x16x32_bf16 v[28:31], a[12:15], v[96:99], v[28:31]
    s_mov_b32 s64, 0x70000
    buffer_load_dword v5, v4, s[12:15], s64 offen sc1
    v_add_u32 v181, s98, v181
    v_mfma_f32_16x16x32_bf16 v[32:35], a[16:19], v[96:99], v[32:35]
    v_lshl_add_u32 v182, v182, 3, s99
    v_mfma_f32_16x16x32_bf16 v[36:39], a[0:3], v[100:103], v[36:39]
    buffer_load_dwordx4 v[148:151], v3, s[36:39], s69 offen offset:1024 sc1
    v_mul_u32_u24 v180, 1280, v181
    v_mfma_f32_16x16x32_bf16 v[40:43], a[4:7], v[100:103], v[40:43]
    buffer_load_dwordx4 a[144:147], v2, s[32:35], s59 offen offset:1024 sc1
    v_add_u32 v180, v180, v182
    v_mfma_f32_16x16x32_bf16 v[44:47], a[8:11], v[100:103], v[44:47]
    v_lshlrev_b32 v0, 1, v180
    s_mul_i32 s98, s72, 21504
    v_mfma_f32_16x16x32_bf16 v[48:51], a[12:15], v[100:103], v[48:51]
    v_lshrrev_b32 v6, 4, v1
    v_mfma_f32_16x16x32_bf16 v[52:55], a[16:19], v[100:103], v[52:55]
    v_mul_u32_u24 v6, 1344, v6
    v_mfma_f32_16x16x32_bf16 v[56:59], a[0:3], v[104:107], v[56:59]
    buffer_load_dwordx4 v[152:155], v3, s[36:39], s69 offen offset:2048 sc1
    buffer_load_dwordx4 a[148:151], v2, s[32:35], s59 offen offset:2048 sc1
    v_and_b32 v181, 15, v1
    v_mfma_f32_16x16x32_bf16 v[60:63], a[4:7], v[104:107], v[60:63]
    v_lshl_add_u32 v6, v181, 4, v6
    v_mfma_f32_16x16x32_bf16 v[64:67], a[8:11], v[104:107], v[64:67]
    v_add_u32 v6, s98, v6
    s_lshl_b32 s98, s76, 2
    v_mfma_f32_16x16x32_bf16 v[68:71], a[12:15], v[104:107], v[68:71]
    s_add_u32 s98, s98, s72
    s_mul_i32 s98, s98, 5120
    v_mfma_f32_16x16x32_bf16 v[72:75], a[16:19], v[104:107], v[72:75]
    buffer_load_dwordx4 a[152:155], v2, s[32:35], s59 offen offset:3072 sc1
    s_add_u32 s90, s98, 0x1280000
    v_mfma_f32_16x16x32_bf16 v[76:79], a[0:3], v[108:111], v[76:79]
    buffer_load_dwordx4 v[156:159], v3, s[36:39], s69 offen offset:3072 sc1
    s_add_u32 s91, s98, 0x1000000
    v_mfma_f32_16x16x32_bf16 v[80:83], a[4:7], v[108:111], v[80:83]
    s_lshl_b32 s79, s73, 7
    s_add_u32 s79, s79, s76
    v_mfma_f32_16x16x32_bf16 v[84:87], a[8:11], v[108:111], v[84:87]
    s_lshl_b32 s79, s79, 2
    s_add_u32 s79, s79, s72
    v_mfma_f32_16x16x32_bf16 v[88:91], a[12:15], v[108:111], v[88:91]
    buffer_load_dwordx4 a[156:159], v3, s[32:35], s59 offen offset:0 sc1
    s_lshl_b32 s79, s79, 7
    s_add_u32 s79, s79, 917504
    v_mov_b32 v252, s79
    v_mfma_f32_16x16x32_bf16 v[92:95], a[16:19], v[108:111], v[92:95]
    v_mfma_f32_16x16x32_bf16 v[16:19], a[20:23], v[112:115], v[16:19]
    s_waitcnt vmcnt(7)
    v_cmp_ne_u32 vcc, s78, v5
    s_nop 0
    s_cmp_eq_u64 vcc, 0
    s_cbranch_scc0 L_h12_retry_7
L_h12_ok_8:
    buffer_load_dwordx4 v[96:99], v3, s[36:39], s70 offen offset:0 sc1
    v_mfma_f32_16x16x32_bf16 v[20:23], a[24:27], v[112:115], v[20:23]
    v_mfma_f32_16x16x32_bf16 v[24:27], a[28:31], v[112:115], v[24:27]
    v_mfma_f32_16x16x32_bf16 v[28:31], a[32:35], v[112:115], v[28:31]
    buffer_load_dwordx3 v[166:168], v165, s[12:15], 0 offen sc1
    v_mfma_f32_16x16x32_bf16 v[32:35], a[36:39], v[112:115], v[32:35]
    v_mfma_f32_16x16x32_bf16 v[36:39], a[20:23], v[116:119], v[36:39]
    buffer_load_dwordx4 v[100:103], v3, s[36:39], s70 offen offset:1024 sc1
    v_mfma_f32_16x16x32_bf16 v[40:43], a[24:27], v[116:119], v[40:43]
    v_mfma_f32_16x16x32_bf16 v[44:47], a[28:31], v[116:119], v[44:47]
    v_mfma_f32_16x16x32_bf16 v[48:51], a[32:35], v[116:119], v[48:51]
    v_mfma_f32_16x16x32_bf16 v[52:55], a[36:39], v[116:119], v[52:55]
    v_mfma_f32_16x16x32_bf16 v[56:59], a[20:23], v[120:123], v[56:59]
    buffer_load_dwordx4 v[104:107], v3, s[36:39], s70 offen offset:2048 sc1
    v_mfma_f32_16x16x32_bf16 v[60:63], a[24:27], v[120:123], v[60:63]
    v_mfma_f32_16x16x32_bf16 v[64:67], a[28:31], v[120:123], v[64:67]
    v_mfma_f32_16x16x32_bf16 v[68:71], a[32:35], v[120:123], v[68:71]
    v_mfma_f32_16x16x32_bf16 v[72:75], a[36:39], v[120:123], v[72:75]
    v_mfma_f32_16x16x32_bf16 v[76:79], a[20:23], v[124:127], v[76:79]
    buffer_load_dwordx4 v[108:111], v3, s[36:39], s70 offen offset:3072 sc1
    v_mfma_f32_16x16x32_bf16 v[80:83], a[24:27], v[124:127], v[80:83]
    v_mfma_f32_16x16x32_bf16 v[84:87], a[28:31], v[124:127], v[84:87]
    v_mfma_f32_16x16x32_bf16 v[88:91], a[32:35], v[124:127], v[88:91]
    v_mfma_f32_16x16x32_bf16 v[92:95], a[36:39], v[124:127], v[92:95]
    v_mfma_f32_16x16x32_bf16 v[16:19], a[40:43], v[128:131], v[16:19]
    buffer_load_dwordx4 v[112:115], v3, s[36:39], s71 offen offset:0 sc1
    v_mfma_f32_16x16x32_bf16 v[20:23], a[44:47], v[128:131], v[20:23]
    v_mfma_f32_16x16x32_bf16 v[24:27], a[48:51], v[128:131], v[24:27]
    v_mfma_f32_16x16x32_bf16 v[28:31], a[52:55], v[128:131], v[28:31]
    v_mfma_f32_16x16x32_bf16 v[32:35], a[56:59], v[128:131], v[32:35]
    v_mfma_f32_16x16x32_bf16 v[36:39], a[40:43], v[132:135], v[36:39]
    buffer_load_dwordx4 v[116:119], v3, s[36:39], s71 offen offset:1024 sc1
    v_mfma_f32_16x16x32_bf16 v[40:43], a[44:47], v[132:135], v[40:43]
    v_mfma_f32_16x16x32_bf16 v[44:47], a[48:51], v[132:135], v[44:47]
    v_mfma_f32_16x16x32_bf16 v[48:51], a[52:55], v[132:135], v[48:51]
    v_mfma_f32_16x16x32_bf16 v[52:55], a[56:59], v[132:135], v[52:55]
    v_mfma_f32_16x16x32_bf16 v[56:59], a[40:43], v[136:139], v[56:59]
    buffer_load_dwordx4 v[120:123], v3, s[36:39], s71 offen offset:2048 sc1
    v_mfma_f32_16x16x32_bf16 v[60:63], a[44:47], v[136:139], v[60:63]
    v_mfma_f32_16x16x32_bf16 v[64:67], a[48:51], v[136:139], v[64:67]
    v_mfma_f32_16x16x32_bf16 v[68:71], a[52:55], v[136:139], v[68:71]
    v_mfma_f32_16x16x32_bf16 v[72:75], a[56:59], v[136:139], v[72:75]
    v_mfma_f32_16x16x32_bf16 v[76:79], a[40:43], v[140:143], v[76:79]
    buffer_load_dwordx4 v[124:127], v3, s[36:39], s71 offen offset:3072 sc1
    v_mfma_f32_16x16x32_bf16 v[80:83], a[44:47], v[140:143], v[80:83]
    v_mfma_f32_16x16x32_bf16 v[84:87], a[48:51], v[140:143], v[84:87]
    v_mfma_f32_16x16x32_bf16 v[88:91], a[52:55], v[140:143], v[88:91]
    v_mfma_f32_16x16x32_bf16 v[92:95], a[56:59], v[140:143], v[92:95]
    v_mfma_f32_16x16x32_bf16 v[16:19], a[60:63], v[144:147], v[16:19]
    buffer_load_dwordx4 v[128:131], v3, s[36:39], s44 offen offset:0 sc1
    v_mfma_f32_16x16x32_bf16 v[20:23], a[64:67], v[144:147], v[20:23]
    v_xor_b32 v4, 65536, v252
    v_mfma_f32_16x16x32_bf16 v[24:27], a[68:71], v[144:147], v[24:27]
    v_mfma_f32_16x16x32_bf16 v[28:31], a[72:75], v[144:147], v[28:31]
    v_mfma_f32_16x16x32_bf16 v[32:35], a[76:79], v[144:147], v[32:35]
    buffer_load_dwordx4 v[132:135], v3, s[36:39], s44 offen offset:1024 sc1
    s_waitcnt vmcnt(17)
    v_mfma_f32_16x16x32_bf16 v[36:39], a[60:63], v[148:151], v[36:39]
    v_mfma_f32_16x16x32_bf16 v[40:43], a[64:67], v[148:151], v[40:43]
    v_mfma_f32_16x16x32_bf16 v[44:47], a[68:71], v[148:151], v[44:47]
    v_mfma_f32_16x16x32_bf16 v[48:51], a[72:75], v[148:151], v[48:51]
    buffer_load_dwordx4 v[136:139], v3, s[36:39], s44 offen offset:2048 sc1
    v_mfma_f32_16x16x32_bf16 v[52:55], a[76:79], v[148:151], v[52:55]
    s_waitcnt vmcnt(10)
    v_cmp_ne_u32 vcc, s78, v167
    s_nop 0
    s_cmp_eq_u64 vcc, 0
    s_cbranch_scc0 L_gt_retry_9
L_gt_ok_10:
    v_mfma_f32_16x16x32_bf16 v[56:59], a[60:63], v[152:155], v[56:59]
    ds_bpermute_b32 v217, v160, v168 offset:0
    v_mfma_f32_16x16x32_bf16 v[60:63], a[64:67], v[152:155], v[60:63]
    ds_bpermute_b32 v212, v160, v168 offset:64
    v_mfma_f32_16x16x32_bf16 v[64:67], a[68:71], v[152:155], v[64:67]
    buffer_load_dwordx4 v[140:143], v3, s[36:39], s44 offen offset:3072 sc1
    ds_bpermute_b32 v218, v161, v168 offset:0
    v_mfma_f32_16x16x32_bf16 v[68:71], a[72:75], v[152:155], v[68:71]
    ds_bpermute_b32 v213, v161, v168 offset:64
    v_mfma_f32_16x16x32_bf16 v[72:75], a[76:79], v[152:155], v[72:75]
    ds_bpermute_b32 v219, v162, v168 offset:0
    v_mfma_f32_16x16x32_bf16 v[76:79], a[60:63], v[156:159], v[76:79]
    ds_bpermute_b32 v214, v162, v168 offset:64
    v_mfma_f32_16x16x32_bf16 v[80:83], a[64:67], v[156:159], v[80:83]
    ds_bpermute_b32 v220, v163, v168 offset:0
    v_mfma_f32_16x16x32_bf16 v[84:87], a[68:71], v[156:159], v[84:87]
    ds_bpermute_b32 v215, v163, v168 offset:64
    v_mfma_f32_16x16x32_bf16 v[88:91], a[72:75], v[156:159], v[88:91]
    ds_bpermute_b32 v221, v164, v168 offset:0
    v_mfma_f32_16x16x32_bf16 v[92:95], a[76:79], v[156:159], v[92:95]
    ds_bpermute_b32 v216, v164, v168 offset:64
    v_mfma_f32_16x16x32_bf16 v[16:19], a[80:83], v[96:99], v[16:19]
    buffer_load_dwordx4 v[144:147], v3, s[36:39], s45 offen offset:0 sc1
    v_mfma_f32_16x16x32_bf16 v[20:23], a[84:87], v[96:99], v[20:23]
    v_mfma_f32_16x16x32_bf16 v[24:27], a[88:91], v[96:99], v[24:27]
    v_mfma_f32_16x16x32_bf16 v[28:31], a[92:95], v[96:99], v[28:31]
    buffer_load_dwordx4 v[148:151], v3, s[36:39], s45 offen offset:1024 sc1
    v_mfma_f32_16x16x32_bf16 v[32:35], a[96:99], v[96:99], v[32:35]
    s_waitcnt vmcnt(12)
    v_mfma_f32_16x16x32_bf16 v[36:39], a[80:83], v[100:103], v[36:39]
    v_mfma_f32_16x16x32_bf16 v[40:43], a[84:87], v[100:103], v[40:43]
    buffer_load_dwordx4 v[152:155], v3, s[36:39], s45 offen offset:2048 sc1
    v_mfma_f32_16x16x32_bf16 v[44:47], a[88:91], v[100:103], v[44:47]
    v_mfma_f32_16x16x32_bf16 v[48:51], a[92:95], v[100:103], v[48:51]
    v_mfma_f32_16x16x32_bf16 v[52:55], a[96:99], v[100:103], v[52:55]
    buffer_load_dwordx4 v[156:159], v3, s[36:39], s45 offen offset:3072 sc1
    s_waitcnt vmcnt(13)
    v_mfma_f32_16x16x32_bf16 v[56:59], a[80:83], v[104:107], v[56:59]
    v_mfma_f32_16x16x32_bf16 v[60:63], a[84:87], v[104:107], v[60:63]
    v_mfma_f32_16x16x32_bf16 v[64:67], a[88:91], v[104:107], v[64:67]
    v_mfma_f32_16x16x32_bf16 v[68:71], a[92:95], v[104:107], v[68:71]
    v_mfma_f32_16x16x32_bf16 v[72:75], a[96:99], v[104:107], v[72:75]
    s_waitcnt vmcnt(12)
    v_mfma_f32_16x16x32_bf16 v[76:79], a[80:83], v[108:111], v[76:79]
    v_mfma_f32_16x16x32_bf16 v[80:83], a[84:87], v[108:111], v[80:83]
    v_mfma_f32_16x16x32_bf16 v[84:87], a[88:91], v[108:111], v[84:87]
    v_mfma_f32_16x16x32_bf16 v[88:91], a[92:95], v[108:111], v[88:91]
    v_mfma_f32_16x16x32_bf16 v[92:95], a[96:99], v[108:111], v[92:95]
    s_waitcnt vmcnt(11)
    v_mfma_f32_16x16x32_bf16 v[16:19], a[100:103], v[112:115], v[16:19]
    buffer_load_dwordx4 v[96:99], v2, s[36:39], s60 offen offset:0 sc1
    v_mfma_f32_16x16x32_bf16 v[20:23], a[104:107], v[112:115], v[20:23]
    v_mfma_f32_16x16x32_bf16 v[24:27], a[108:111], v[112:115], v[24:27]
    v_mfma_f32_16x16x32_bf16 v[28:31], a[112:115], v[112:115], v[28:31]
    v_mfma_f32_16x16x32_bf16 v[32:35], a[116:119], v[112:115], v[32:35]
    s_waitcnt vmcnt(11)
    v_mfma_f32_16x16x32_bf16 v[36:39], a[100:103], v[116:119], v[36:39]
    buffer_load_dwordx4 v[100:103], v2, s[36:39], s60 offen offset:1024 sc1
    v_mfma_f32_16x16x32_bf16 v[40:43], a[104:107], v[116:119], v[40:43]
    v_mfma_f32_16x16x32_bf16 v[44:47], a[108:111], v[116:119], v[44:47]
    v_mfma_f32_16x16x32_bf16 v[48:51], a[112:115], v[116:119], v[48:51]
    v_mfma_f32_16x16x32_bf16 v[52:55], a[116:119], v[116:119], v[52:55]
    s_waitcnt vmcnt(11)
    v_mfma_f32_16x16x32_bf16 v[56:59], a[100:103], v[120:123], v[56:59]
    buffer_load_dwordx4 v[104:107], v2, s[36:39], s60 offen offset:2048 sc1
    v_mfma_f32_16x16x32_bf16 v[60:63], a[104:107], v[120:123], v[60:63]
    v_mfma_f32_16x16x32_bf16 v[64:67], a[108:111], v[120:123], v[64:67]
    v_mfma_f32_16x16x32_bf16 v[68:71], a[112:115], v[120:123], v[68:71]
    v_mfma_f32_16x16x32_bf16 v[72:75], a[116:119], v[120:123], v[72:75]
    s_waitcnt vmcnt(11)
    v_mfma_f32_16x16x32_bf16 v[76:79], a[100:103], v[124:127], v[76:79]
    buffer_load_dwordx4 v[108:111], v2, s[36:39], s60 offen offset:3072 sc1
    v_mfma_f32_16x16x32_bf16 v[80:83], a[104:107], v[124:127], v[80:83]
    v_mfma_f32_16x16x32_bf16 v[84:87], a[108:111], v[124:127], v[84:87]
    v_mfma_f32_16x16x32_bf16 v[88:91], a[112:115], v[124:127], v[88:91]
    v_mfma_f32_16x16x32_bf16 v[92:95], a[116:119], v[124:127], v[92:95]
    s_waitcnt vmcnt(11)
    v_mfma_f32_16x16x32_bf16 v[16:19], a[120:123], v[128:131], v[16:19]
    buffer_load_dwordx4 v[112:115], v2, s[36:39], s61 offen offset:0 sc1
    v_mfma_f32_16x16x32_bf16 v[20:23], a[124:127], v[128:131], v[20:23]
    s_waitcnt vmcnt(8)
    v_mfma_f32_16x16x32_bf16 v[16:19], a[140:143], v[144:147], v[16:19]
    v_mfma_f32_16x16x32_bf16 v[20:23], a[144:147], v[144:147], v[20:23]
    v_mfma_f32_16x16x32_bf16 v[24:27], a[128:131], v[128:131], v[24:27]
    v_mfma_f32_16x16x32_bf16 v[28:31], a[132:135], v[128:131], v[28:31]
    buffer_load_dwordx4 v[116:119], v2, s[36:39], s61 offen offset:1024 sc1
    v_mfma_f32_16x16x32_bf16 v[24:27], a[148:151], v[144:147], v[24:27]
    v_mfma_f32_16x16x32_bf16 v[28:31], a[152:155], v[144:147], v[28:31]
    v_mfma_f32_16x16x32_bf16 v[32:35], a[136:139], v[128:131], v[32:35]
    s_nop 0
    ds_write_b128 v6, v[16:19] offset:0
    v_mfma_f32_16x16x32_bf16 v[36:39], a[120:123], v[132:135], v[36:39]
    v_mfma_f32_16x16x32_bf16 v[32:35], a[156:159], v[144:147], v[32:35]
    buffer_load_dwordx4 v[120:123], v2, s[36:39], s61 offen offset:2048 sc1
    ds_write_b128 v6, v[20:23] offset:272
    s_waitcnt vmcnt(9)
    v_mfma_f32_16x16x32_bf16 v[36:39], a[140:143], v[148:151], v[36:39]
    v_mfma_f32_16x16x32_bf16 v[40:43], a[124:127], v[132:135], v[40:43]
    ds_write_b128 v6, v[24:27] offset:544
    v_mfma_f32_16x16x32_bf16 v[44:47], a[128:131], v[132:135], v[44:47]
    v_mfma_f32_16x16x32_bf16 v[40:43], a[144:147], v[148:151], v[40:43]
    ds_write_b128 v6, v[28:31] offset:816
    v_mfma_f32_16x16x32_bf16 v[44:47], a[148:151], v[148:151], v[44:47]
    buffer_load_dwordx4 v[124:127], v2, s[36:39], s61 offen offset:3072 sc1
    v_mfma_f32_16x16x32_bf16 v[48:51], a[132:135], v[132:135], v[48:51]
    ds_write_b128 v6, v[32:35] offset:1088
    v_mfma_f32_16x16x32_bf16 v[52:55], a[136:139], v[132:135], v[52:55]
    v_mfma_f32_16x16x32_bf16 v[48:51], a[152:155], v[148:151], v[48:51]
    ds_write_b128 v6, v[36:39] offset:5376
    v_mfma_f32_16x16x32_bf16 v[52:55], a[156:159], v[148:151], v[52:55]
    v_mfma_f32_16x16x32_bf16 v[56:59], a[120:123], v[136:139], v[56:59]
    buffer_load_dwordx4 v[128:131], v2, s[36:39], s62 offen offset:0 sc1
    ds_write_b128 v6, v[40:43] offset:5648
    v_mfma_f32_16x16x32_bf16 v[60:63], a[124:127], v[136:139], v[60:63]
    s_waitcnt vmcnt(10)
    v_mfma_f32_16x16x32_bf16 v[56:59], a[140:143], v[152:155], v[56:59]
    ds_write_b128 v6, v[44:47] offset:5920
    v_mfma_f32_16x16x32_bf16 v[60:63], a[144:147], v[152:155], v[60:63]
    v_mfma_f32_16x16x32_bf16 v[64:67], a[128:131], v[136:139], v[64:67]
    ds_write_b128 v6, v[48:51] offset:6192
    v_mfma_f32_16x16x32_bf16 v[68:71], a[132:135], v[136:139], v[68:71]
    buffer_load_dwordx4 v[132:135], v2, s[36:39], s62 offen offset:1024 sc1
    v_mfma_f32_16x16x32_bf16 v[64:67], a[148:151], v[152:155], v[64:67]
    ds_write_b128 v6, v[52:55] offset:6464
    v_mfma_f32_16x16x32_bf16 v[68:71], a[152:155], v[152:155], v[68:71]
    v_mfma_f32_16x16x32_bf16 v[72:75], a[136:139], v[136:139], v[72:75]
    ds_write_b128 v6, v[56:59] offset:10752
    v_mfma_f32_16x16x32_bf16 v[76:79], a[120:123], v[140:143], v[76:79]
    v_mfma_f32_16x16x32_bf16 v[72:75], a[156:159], v[152:155], v[72:75]
    ds_write_b128 v6, v[60:63] offset:11024
    s_waitcnt vmcnt(10)
    v_mfma_f32_16x16x32_bf16 v[76:79], a[140:143], v[156:159], v[76:79]
    buffer_load_dwordx4 v[136:139], v2, s[36:39], s62 offen offset:2048 sc1
    v_mfma_f32_16x16x32_bf16 v[80:83], a[124:127], v[140:143], v[80:83]
    ds_write_b128 v6, v[64:67] offset:11296
    v_mfma_f32_16x16x32_bf16 v[84:87], a[128:131], v[140:143], v[84:87]
    v_mfma_f32_16x16x32_bf16 v[80:83], a[144:147], v[156:159], v[80:83]
    ds_write_b128 v6, v[68:71] offset:11568
    v_mfma_f32_16x16x32_bf16 v[84:87], a[148:151], v[156:159], v[84:87]
    v_mfma_f32_16x16x32_bf16 v[88:91], a[132:135], v[140:143], v[88:91]
    ds_write_b128 v6, v[72:75] offset:11840
    v_mfma_f32_16x16x32_bf16 v[92:95], a[136:139], v[140:143], v[92:95]
    v_mfma_f32_16x16x32_bf16 v[88:91], a[152:155], v[156:159], v[88:91]
    ds_write_b128 v6, v[76:79] offset:16128
    v_mfma_f32_16x16x32_bf16 v[92:95], a[156:159], v[156:159], v[92:95]
    v_lshlrev_b32 v254, 3, v1
    s_waitcnt vmcnt(10)
    v_mfma_f32_16x16x32_bf16 v[16:19], a[160:163], v[96:99], 0
    buffer_load_dwordx4 v[144:147], v2, s[36:39], s63 offen offset:0 sc1
    ds_write_b128 v6, v[80:83] offset:16400
    v_mfma_f32_16x16x32_bf16 v[20:23], a[164:167], v[96:99], 0
    buffer_load_dwordx4 v[140:143], v2, s[36:39], s62 offen offset:3072 sc1
    v_mfma_f32_16x16x32_bf16 v[24:27], a[168:171], v[96:99], 0
    ds_write_b128 v6, v[84:87] offset:16672
    v_mfma_f32_16x16x32_bf16 v[28:31], a[172:175], v[96:99], 0
    v_mfma_f32_16x16x32_bf16 v[32:35], a[176:179], v[96:99], 0
    ds_write_b128 v6, v[88:91] offset:16944
    s_waitcnt vmcnt(11)
    v_mfma_f32_16x16x32_bf16 v[36:39], a[160:163], v[100:103], 0
    buffer_load_dwordx4 v[148:151], v2, s[36:39], s63 offen offset:1024 sc1
    v_mfma_f32_16x16x32_bf16 v[40:43], a[164:167], v[100:103], 0
    ds_write_b128 v6, v[92:95] offset:17216
    v_mfma_f32_16x16x32_bf16 v[44:47], a[168:171], v[100:103], 0
    v_mfma_f32_16x16x32_bf16 v[48:51], a[172:175], v[100:103], 0
    v_mfma_f32_16x16x32_bf16 v[52:55], a[176:179], v[100:103], 0
    s_waitcnt vmcnt(11)
    v_mfma_f32_16x16x32_bf16 v[56:59], a[160:163], v[104:107], 0
    buffer_load_dwordx4 v[152:155], v2, s[36:39], s63 offen offset:2048 sc1
    v_mfma_f32_16x16x32_bf16 v[60:63], a[164:167], v[104:107], 0
    v_mfma_f32_16x16x32_bf16 v[64:67], a[168:171], v[104:107], 0
    v_mfma_f32_16x16x32_bf16 v[68:71], a[172:175], v[104:107], 0
    v_mfma_f32_16x16x32_bf16 v[72:75], a[176:179], v[104:107], 0
    s_waitcnt vmcnt(11)
    v_mfma_f32_16x16x32_bf16 v[76:79], a[160:163], v[108:111], 0
    s_waitcnt lgkmcnt(0)
    s_barrier
    buffer_load_dwordx4 v[156:159], v2, s[36:39], s63 offen offset:3072 sc1
    ds_read_b128 v[160:163], v7 offset:0
    v_mfma_f32_16x16x32_bf16 v[80:83], a[164:167], v[108:111], 0
    ds_read_b128 v[164:167], v7 offset:21504
    v_mfma_f32_16x16x32_bf16 v[84:87], a[168:171], v[108:111], 0
    ds_read_b128 v[168:171], v7 offset:43008
    v_mfma_f32_16x16x32_bf16 v[88:91], a[172:175], v[108:111], 0
    ds_read_b128 v[172:175], v7 offset:64512
    v_mfma_f32_16x16x32_bf16 v[92:95], a[176:179], v[108:111], 0
    ds_read_b128 v[176:179], v8 offset:0
    s_waitcnt vmcnt(11)
    v_mfma_f32_16x16x32_bf16 v[16:19], a[180:183], v[112:115], v[16:19]
    buffer_load_dwordx4 v[96:99], v2, s[36:39], s66 offen offset:0 sc1
    ds_read_b128 v[180:183], v8 offset:21504
    v_mfma_f32_16x16x32_bf16 v[20:23], a[184:187], v[112:115], v[20:23]
    ds_read_b128 v[184:187], v8 offset:43008
    v_mfma_f32_16x16x32_bf16 v[24:27], a[188:191], v[112:115], v[24:27]
    ds_read_b128 v[188:191], v8 offset:64512
    v_mfma_f32_16x16x32_bf16 v[28:31], a[192:195], v[112:115], v[28:31]
    v_mfma_f32_16x16x32_bf16 v[32:35], a[196:199], v[112:115], v[32:35]
    s_waitcnt vmcnt(11)
    v_mfma_f32_16x16x32_bf16 v[36:39], a[180:183], v[116:119], v[36:39]
    buffer_load_dwordx4 v[100:103], v2, s[36:39], s66 offen offset:1024 sc1
    v_mfma_f32_16x16x32_bf16 v[40:43], a[184:187], v[116:119], v[40:43]
    v_mfma_f32_16x16x32_bf16 v[44:47], a[188:191], v[116:119], v[44:47]
    s_waitcnt lgkmcnt(6)
    v_add_f32 v192, v160, v164
    v_mfma_f32_16x16x32_bf16 v[48:51], a[192:195], v[116:119], v[48:51]
    v_add_f32 v193, v161, v165
    v_mfma_f32_16x16x32_bf16 v[52:55], a[196:199], v[116:119], v[52:55]
    v_add_f32 v194, v162, v166
    v_add_f32 v195, v163, v167
    s_waitcnt vmcnt(11)
    v_mfma_f32_16x16x32_bf16 v[56:59], a[180:183], v[120:123], v[56:59]
    s_waitcnt lgkmcnt(5)
    v_add_f32 v192, v192, v168
    v_add_f32 v193, v193, v169
    buffer_load_dwordx4 v[104:107], v2, s[36:39], s66 offen offset:2048 sc1
    v_mfma_f32_16x16x32_bf16 v[60:63], a[184:187], v[120:123], v[60:63]
    v_add_f32 v194, v194, v170
    v_add_f32 v195, v195, v171
    v_mfma_f32_16x16x32_bf16 v[64:67], a[188:191], v[120:123], v[64:67]
    s_waitcnt lgkmcnt(4)
    v_add_f32 v192, v192, v172
    v_add_f32 v193, v193, v173
    v_mfma_f32_16x16x32_bf16 v[68:71], a[192:195], v[120:123], v[68:71]
    v_add_f32 v194, v194, v174
    v_mfma_f32_16x16x32_bf16 v[72:75], a[196:199], v[120:123], v[72:75]
    v_add_f32 v195, v195, v175
    v_mul_f32 v192, v212, v192
    ds_read_b128 v[160:163], v9 offset:0
    s_waitcnt vmcnt(11)
    v_mfma_f32_16x16x32_bf16 v[76:79], a[180:183], v[124:127], v[76:79]
    v_mul_f32 v193, v212, v193
    v_mul_f32 v194, v212, v194
    ds_read_b128 v[164:167], v9 offset:21504
    buffer_load_dwordx4 v[108:111], v2, s[36:39], s66 offen offset:3072 sc1
    v_mfma_f32_16x16x32_bf16 v[80:83], a[184:187], v[124:127], v[80:83]
    v_mul_f32 v195, v212, v195
    ds_read_b128 v[168:171], v9 offset:43008
    v_cvt_pk_bf16_f32 v192, v192, v193
    v_mfma_f32_16x16x32_bf16 v[84:87], a[188:191], v[124:127], v[84:87]
    v_cvt_pk_bf16_f32 v193, v194, v195
    ds_read_b128 v[172:175], v9 offset:64512
    v_mfma_f32_16x16x32_bf16 v[88:91], a[192:195], v[124:127], v[88:91]
    v_mfma_f32_16x16x32_bf16 v[92:95], a[196:199], v[124:127], v[92:95]
    s_waitcnt vmcnt(11)
    v_mfma_f32_16x16x32_bf16 v[16:19], a[200:203], v[128:131], v[16:19]
    buffer_load_dwordx4 v[112:115], v2, s[36:39], s67 offen offset:0 sc1
    s_waitcnt lgkmcnt(6)
    v_add_f32 v196, v176, v180
    v_mfma_f32_16x16x32_bf16 v[20:23], a[204:207], v[128:131], v[20:23]
    v_add_f32 v197, v177, v181
    v_mfma_f32_16x16x32_bf16 v[24:27], a[208:211], v[128:131], v[24:27]
    v_add_f32 v198, v178, v182
    v_add_f32 v199, v179, v183
    v_mfma_f32_16x16x32_bf16 v[28:31], a[212:215], v[128:131], v[28:31]
    s_waitcnt lgkmcnt(5)
    v_add_f32 v196, v196, v184
    v_add_f32 v197, v197, v185
    v_mfma_f32_16x16x32_bf16 v[32:35], a[216:219], v[128:131], v[32:35]
    v_add_f32 v198, v198, v186
    v_add_f32 v199, v199, v187
    s_waitcnt vmcnt(11)
    v_mfma_f32_16x16x32_bf16 v[36:39], a[200:203], v[132:135], v[36:39]
    s_waitcnt lgkmcnt(4)
    v_add_f32 v196, v196, v188
    v_add_f32 v197, v197, v189
    buffer_load_dwordx4 v[116:119], v2, s[36:39], s67 offen offset:1024 sc1
    v_mfma_f32_16x16x32_bf16 v[40:43], a[204:207], v[132:135], v[40:43]
    v_add_f32 v198, v198, v190
    v_mfma_f32_16x16x32_bf16 v[44:47], a[208:211], v[132:135], v[44:47]
    v_add_f32 v199, v199, v191
    v_mul_f32 v196, v213, v196
    ds_read_b128 v[176:179], v10 offset:0
    v_mfma_f32_16x16x32_bf16 v[48:51], a[212:215], v[132:135], v[48:51]
    v_mul_f32 v197, v213, v197
    v_mul_f32 v198, v213, v198
    ds_read_b128 v[180:183], v10 offset:21504
    v_mfma_f32_16x16x32_bf16 v[52:55], a[216:219], v[132:135], v[52:55]
    v_mul_f32 v199, v213, v199
    ds_read_b128 v[184:187], v10 offset:43008
    v_cvt_pk_bf16_f32 v194, v196, v197
    s_waitcnt vmcnt(11)
    v_mfma_f32_16x16x32_bf16 v[56:59], a[200:203], v[136:139], v[56:59]
    v_cvt_pk_bf16_f32 v195, v198, v199
    ds_read_b128 v[188:191], v10 offset:64512
    buffer_store_dwordx4 v[192:195], v2, s[12:15], s90 offen offset:0 sc1
    buffer_load_dwordx4 v[120:123], v2, s[36:39], s67 offen offset:2048 sc1
    v_mfma_f32_16x16x32_bf16 v[60:63], a[204:207], v[136:139], v[60:63]
    v_mfma_f32_16x16x32_bf16 v[64:67], a[208:211], v[136:139], v[64:67]
    v_mfma_f32_16x16x32_bf16 v[68:71], a[212:215], v[136:139], v[68:71]
    s_waitcnt lgkmcnt(6)
    v_add_f32 v200, v160, v164
    v_mfma_f32_16x16x32_bf16 v[72:75], a[216:219], v[136:139], v[72:75]
    v_add_f32 v201, v161, v165
    s_waitcnt vmcnt(11)
    v_mfma_f32_16x16x32_bf16 v[76:79], a[200:203], v[140:143], v[76:79]
    v_add_f32 v202, v162, v166
    v_add_f32 v203, v163, v167
    buffer_load_dwordx4 v[124:127], v2, s[36:39], s67 offen offset:3072 sc1
    v_mfma_f32_16x16x32_bf16 v[80:83], a[204:207], v[140:143], v[80:83]
    s_waitcnt lgkmcnt(5)
    v_add_f32 v200, v200, v168
    v_add_f32 v201, v201, v169
    v_mfma_f32_16x16x32_bf16 v[84:87], a[208:211], v[140:143], v[84:87]
    v_add_f32 v202, v202, v170
    v_add_f32 v203, v203, v171
    v_mfma_f32_16x16x32_bf16 v[88:91], a[212:215], v[140:143], v[88:91]
    s_waitcnt lgkmcnt(4)
    v_add_f32 v200, v200, v172
    v_add_f32 v201, v201, v173
    v_mfma_f32_16x16x32_bf16 v[92:95], a[216:219], v[140:143], v[92:95]
    v_add_f32 v202, v202, v174
    v_mfma_f32_16x16x32_bf16 v[16:19], a[220:223], v[144:147], v[16:19]
    v_add_f32 v203, v203, v175
    v_mul_f32 v200, v214, v200
    ds_read_b128 v[160:163], v11 offset:0
    buffer_load_dwordx4 v[128:131], v2, s[36:39], s68 offen offset:0 sc1
    v_mfma_f32_16x16x32_bf16 v[20:23], a[224:227], v[144:147], v[20:23]
    v_mul_f32 v201, v214, v201
    v_mul_f32 v202, v214, v202
    ds_read_b128 v[164:167], v11 offset:21504
    v_mfma_f32_16x16x32_bf16 v[24:27], a[228:231], v[144:147], v[24:27]
    v_mul_f32 v203, v214, v203
    ds_read_b128 v[168:171], v11 offset:43008
    v_cvt_pk_bf16_f32 v200, v200, v201
    v_mfma_f32_16x16x32_bf16 v[28:31], a[232:235], v[144:147], v[28:31]
    v_cvt_pk_bf16_f32 v201, v202, v203
    ds_read_b128 v[172:175], v11 offset:64512
    v_mfma_f32_16x16x32_bf16 v[32:35], a[236:239], v[144:147], v[32:35]
    s_waitcnt vmcnt(12)
    v_mfma_f32_16x16x32_bf16 v[36:39], a[220:223], v[148:151], v[36:39]
    buffer_load_dwordx4 v[132:135], v2, s[36:39], s68 offen offset:1024 sc1
    v_mfma_f32_16x16x32_bf16 v[40:43], a[224:227], v[148:151], v[40:43]
    s_waitcnt lgkmcnt(6)
    v_add_f32 v204, v176, v180
    v_mfma_f32_16x16x32_bf16 v[44:47], a[228:231], v[148:151], v[44:47]
    v_add_f32 v205, v177, v181
    v_mfma_f32_16x16x32_bf16 v[48:51], a[232:235], v[148:151], v[48:51]
    v_add_f32 v206, v178, v182
    v_add_f32 v207, v179, v183
    v_mfma_f32_16x16x32_bf16 v[52:55], a[236:239], v[148:151], v[52:55]
    s_waitcnt lgkmcnt(5)
    v_add_f32 v204, v204, v184
    v_add_f32 v205, v205, v185
    s_waitcnt vmcnt(12)
    v_mfma_f32_16x16x32_bf16 v[56:59], a[220:223], v[152:155], v[56:59]
    v_add_f32 v206, v206, v186
    v_add_f32 v207, v207, v187
    buffer_load_dwordx4 v[136:139], v2, s[36:39], s68 offen offset:2048 sc1
    v_mfma_f32_16x16x32_bf16 v[60:63], a[224:227], v[152:155], v[60:63]
    s_waitcnt lgkmcnt(4)
    v_add_f32 v204, v204, v188
    v_add_f32 v205, v205, v189
    v_mfma_f32_16x16x32_bf16 v[64:67], a[228:231], v[152:155], v[64:67]
    v_add_f32 v206, v206, v190
    v_mfma_f32_16x16x32_bf16 v[68:71], a[232:235], v[152:155], v[68:71]
    v_add_f32 v207, v207, v191
    v_mul_f32 v204, v215, v204
    v_mfma_f32_16x16x32_bf16 v[72:75], a[236:239], v[152:155], v[72:75]
    v_mul_f32 v205, v215, v205
    v_mul_f32 v206, v215, v206
    s_waitcnt vmcnt(12)
    v_mfma_f32_16x16x32_bf16 v[76:79], a[220:223], v[156:159], v[76:79]
    v_mul_f32 v207, v215, v207
    v_cvt_pk_bf16_f32 v202, v204, v205
    buffer_load_dwordx4 v[140:143], v2, s[36:39], s68 offen offset:3072 sc1
    v_mfma_f32_16x16x32_bf16 v[80:83], a[224:227], v[156:159], v[80:83]
    v_cvt_pk_bf16_f32 v203, v206, v207
    buffer_store_dwordx4 v[200:203], v2, s[12:15], s90 offen offset:1024 sc1
    v_mfma_f32_16x16x32_bf16 v[84:87], a[228:231], v[156:159], v[84:87]
    v_mfma_f32_16x16x32_bf16 v[88:91], a[232:235], v[156:159], v[88:91]
    v_mfma_f32_16x16x32_bf16 v[92:95], a[236:239], v[156:159], v[92:95]
    s_waitcnt lgkmcnt(2)
    v_add_f32 v208, v160, v164
    s_waitcnt vmcnt(13)
    v_mfma_f32_16x16x32_bf16 v[16:19], a[0:3], v[96:99], v[16:19]
    v_add_f32 v209, v161, v165
    buffer_load_dwordx4 v[144:147], v2, s[36:39], s69 offen offset:0 sc1
    v_mfma_f32_16x16x32_bf16 v[20:23], a[4:7], v[96:99], v[20:23]
    v_add_f32 v210, v162, v166
    v_add_f32 v211, v163, v167
    v_mfma_f32_16x16x32_bf16 v[24:27], a[8:11], v[96:99], v[24:27]
    s_waitcnt lgkmcnt(1)
    v_add_f32 v208, v208, v168
    v_add_f32 v209, v209, v169
    v_mfma_f32_16x16x32_bf16 v[28:31], a[12:15], v[96:99], v[28:31]
    v_add_f32 v210, v210, v170
    v_add_f32 v211, v211, v171
    v_mfma_f32_16x16x32_bf16 v[32:35], a[16:19], v[96:99], v[32:35]
    s_waitcnt lgkmcnt(0)
    v_add_f32 v208, v208, v172
    v_add_f32 v209, v209, v173
    s_waitcnt vmcnt(13)
    v_mfma_f32_16x16x32_bf16 v[36:39], a[0:3], v[100:103], v[36:39]
    v_add_f32 v210, v210, v174
    buffer_load_dwordx4 v[148:151], v2, s[36:39], s69 offen offset:1024 sc1
    v_mfma_f32_16x16x32_bf16 v[40:43], a[4:7], v[100:103], v[40:43]
    v_add_f32 v211, v211, v175
    v_mul_f32 v208, v216, v208
    v_mfma_f32_16x16x32_bf16 v[44:47], a[8:11], v[100:103], v[44:47]
    v_mul_f32 v209, v216, v209
    v_mul_f32 v210, v216, v210
    v_mfma_f32_16x16x32_bf16 v[48:51], a[12:15], v[100:103], v[48:51]
    v_mul_f32 v211, v216, v211
    v_cvt_pk_bf16_f32 v208, v208, v209
    v_mfma_f32_16x16x32_bf16 v[52:55], a[16:19], v[100:103], v[52:55]
    v_cvt_pk_bf16_f32 v209, v210, v211
    buffer_store_dwordx2 v[208:209], v254, s[12:15], s90 offen offset:2048 sc1
    s_waitcnt vmcnt(14)
    v_mfma_f32_16x16x32_bf16 v[56:59], a[0:3], v[104:107], v[56:59]
    buffer_load_dwordx4 v[152:155], v2, s[36:39], s69 offen offset:2048 sc1
    v_mfma_f32_16x16x32_bf16 v[60:63], a[4:7], v[104:107], v[60:63]
    v_mfma_f32_16x16x32_bf16 v[64:67], a[8:11], v[104:107], v[64:67]
    v_mfma_f32_16x16x32_bf16 v[68:71], a[12:15], v[104:107], v[68:71]
    v_mfma_f32_16x16x32_bf16 v[72:75], a[16:19], v[104:107], v[72:75]
    s_waitcnt vmcnt(14)
    v_mfma_f32_16x16x32_bf16 v[76:79], a[0:3], v[108:111], v[76:79]
    buffer_load_dwordx4 v[156:159], v2, s[36:39], s69 offen offset:3072 sc1
    v_mfma_f32_16x16x32_bf16 v[80:83], a[4:7], v[108:111], v[80:83]
    v_mfma_f32_16x16x32_bf16 v[84:87], a[8:11], v[108:111], v[84:87]
    v_mfma_f32_16x16x32_bf16 v[88:91], a[12:15], v[108:111], v[88:91]
    v_mfma_f32_16x16x32_bf16 v[92:95], a[16:19], v[108:111], v[92:95]
    s_waitcnt vmcnt(14)
    v_mfma_f32_16x16x32_bf16 v[16:19], a[20:23], v[112:115], v[16:19]
    buffer_load_dwordx4 v[96:99], v2, s[36:39], s70 offen offset:0 sc1
    v_mfma_f32_16x16x32_bf16 v[20:23], a[24:27], v[112:115], v[20:23]
    v_mfma_f32_16x16x32_bf16 v[24:27], a[28:31], v[112:115], v[24:27]
    v_mfma_f32_16x16x32_bf16 v[28:31], a[32:35], v[112:115], v[28:31]
    v_mfma_f32_16x16x32_bf16 v[32:35], a[36:39], v[112:115], v[32:35]
    s_waitcnt vmcnt(14)
    v_mfma_f32_16x16x32_bf16 v[36:39], a[20:23], v[116:119], v[36:39]
    buffer_load_dwordx4 v[100:103], v2, s[36:39], s70 offen offset:1024 sc1
    v_mfma_f32_16x16x32_bf16 v[40:43], a[24:27], v[116:119], v[40:43]
    v_mfma_f32_16x16x32_bf16 v[44:47], a[28:31], v[116:119], v[44:47]
    v_mfma_f32_16x16x32_bf16 v[48:51], a[32:35], v[116:119], v[48:51]
    v_mfma_f32_16x16x32_bf16 v[52:55], a[36:39], v[116:119], v[52:55]
    s_waitcnt vmcnt(13)
    v_mfma_f32_16x16x32_bf16 v[56:59], a[20:23], v[120:123], v[56:59]
    buffer_load_dwordx4 v[104:107], v2, s[36:39], s70 offen offset:2048 sc1
    v_mfma_f32_16x16x32_bf16 v[60:63], a[24:27], v[120:123], v[60:63]
    s_barrier
    v_mfma_f32_16x16x32_bf16 v[64:67], a[28:31], v[120:123], v[64:67]
    v_mfma_f32_16x16x32_bf16 v[68:71], a[32:35], v[120:123], v[68:71]
    s_or_b32 s64, s72, s76
    s_cselect_b32 s26, 0, 0x1700000
    v_mfma_f32_16x16x32_bf16 v[72:75], a[36:39], v[120:123], v[72:75]
    v_lshlrev_b32 v190, 9, v1
    v_mov_b32 v191, 0
    s_waitcnt vmcnt(13)
    v_mfma_f32_16x16x32_bf16 v[76:79], a[20:23], v[124:127], v[76:79]
    buffer_load_dwordx4 v[108:111], v2, s[36:39], s70 offen offset:3072 sc1
    v_mfma_f32_16x16x32_bf16 v[80:83], a[24:27], v[124:127], v[80:83]
    s_mov_b32 s64, 786432
    buffer_load_dword v186, v190, s[24:27], s64 offen sc1
    s_mov_b32 s64, 819200
    buffer_load_dword v187, v190, s[24:27], s64 offen sc1
    s_mov_b32 s64, 327680
    buffer_load_dword v188, v190, s[24:27], s64 offen sc1
    s_mov_b32 s64, 360448
    buffer_load_dword v189, v190, s[24:27], s64 offen sc1
    v_mfma_f32_16x16x32_bf16 v[84:87], a[28:31], v[124:127], v[84:87]
    v_mfma_f32_16x16x32_bf16 v[88:91], a[32:35], v[124:127], v[88:91]
    v_mfma_f32_16x16x32_bf16 v[92:95], a[36:39], v[124:127], v[92:95]
    s_waitcnt vmcnt(17)
    v_mfma_f32_16x16x32_bf16 v[16:19], a[40:43], v[128:131], v[16:19]
    buffer_load_dwordx4 v[112:115], v2, s[36:39], s71 offen offset:0 sc1
    v_mfma_f32_16x16x32_bf16 v[20:23], a[44:47], v[128:131], v[20:23]
    v_mfma_f32_16x16x32_bf16 v[24:27], a[48:51], v[128:131], v[24:27]
    v_mfma_f32_16x16x32_bf16 v[28:31], a[52:55], v[128:131], v[28:31]
    v_mfma_f32_16x16x32_bf16 v[32:35], a[56:59], v[128:131], v[32:35]
    s_waitcnt vmcnt(17)
    v_mfma_f32_16x16x32_bf16 v[36:39], a[40:43], v[132:135], v[36:39]
    buffer_load_dwordx4 v[116:119], v2, s[36:39], s71 offen offset:1024 sc1
    v_mfma_f32_16x16x32_bf16 v[40:43], a[44:47], v[132:135], v[40:43]
    v_mfma_f32_16x16x32_bf16 v[44:47], a[48:51], v[132:135], v[44:47]
    v_mfma_f32_16x16x32_bf16 v[48:51], a[52:55], v[132:135], v[48:51]
    v_mfma_f32_16x16x32_bf16 v[52:55], a[56:59], v[132:135], v[52:55]
    s_waitcnt vmcnt(17)
    v_mfma_f32_16x16x32_bf16 v[56:59], a[40:43], v[136:139], v[56:59]
    buffer_load_dwordx4 v[120:123], v2, s[36:39], s71 offen offset:2048 sc1
    v_mfma_f32_16x16x32_bf16 v[60:63], a[44:47], v[136:139], v[60:63]
    v_mfma_f32_16x16x32_bf16 v[64:67], a[48:51], v[136:139], v[64:67]
    v_mfma_f32_16x16x32_bf16 v[68:71], a[52:55], v[136:139], v[68:71]
    v_mfma_f32_16x16x32_bf16 v[72:75], a[56:59], v[136:139], v[72:75]
    s_waitcnt vmcnt(17)
    v_mfma_f32_16x16x32_bf16 v[76:79], a[40:43], v[140:143], v[76:79]
    buffer_load_dwordx4 v[124:127], v2, s[36:39], s71 offen offset:3072 sc1
    v_mfma_f32_16x16x32_bf16 v[80:83], a[44:47], v[140:143], v[80:83]
    v_mfma_f32_16x16x32_bf16 v[84:87], a[48:51], v[140:143], v[84:87]
    v_mfma_f32_16x16x32_bf16 v[88:91], a[52:55], v[140:143], v[88:91]
    v_mfma_f32_16x16x32_bf16 v[92:95], a[56:59], v[140:143], v[92:95]
    s_waitcnt vmcnt(16)
    v_mfma_f32_16x16x32_bf16 v[16:19], a[60:63], v[144:147], v[16:19]
    buffer_load_dwordx4 v[128:131], v2, s[36:39], s44 offen offset:0 sc1
    v_mfma_f32_16x16x32_bf16 v[20:23], a[64:67], v[144:147], v[20:23]
    v_mfma_f32_16x16x32_bf16 v[24:27], a[68:71], v[144:147], v[24:27]
    v_mfma_f32_16x16x32_bf16 v[28:31], a[72:75], v[144:147], v[28:31]
    v_mfma_f32_16x16x32_bf16 v[32:35], a[76:79], v[144:147], v[32:35]
    buffer_load_dwordx4 v[132:135], v2, s[36:39], s44 offen offset:1024 sc1
    s_waitcnt vmcnt(17)
    v_mfma_f32_16x16x32_bf16 v[36:39], a[60:63], v[148:151], v[36:39]
    v_mfma_f32_16x16x32_bf16 v[40:43], a[64:67], v[148:151], v[40:43]
    v_mfma_f32_16x16x32_bf16 v[44:47], a[68:71], v[148:151], v[44:47]
    v_mfma_f32_16x16x32_bf16 v[48:51], a[72:75], v[148:151], v[48:51]
    buffer_load_dwordx4 v[136:139], v2, s[36:39], s44 offen offset:2048 sc1
    v_mfma_f32_16x16x32_bf16 v[52:55], a[76:79], v[148:151], v[52:55]
    s_waitcnt vmcnt(17)
    buffer_store_dword v253, v252, s[12:15], 0 offen sc1
    s_waitcnt vmcnt(17)
    v_mfma_f32_16x16x32_bf16 v[56:59], a[60:63], v[152:155], v[56:59]
    v_mfma_f32_16x16x32_bf16 v[60:63], a[64:67], v[152:155], v[60:63]
    v_mfma_f32_16x16x32_bf16 v[64:67], a[68:71], v[152:155], v[64:67]
    buffer_load_dwordx4 v[140:143], v2, s[36:39], s44 offen offset:3072 sc1
    v_mfma_f32_16x16x32_bf16 v[68:71], a[72:75], v[152:155], v[68:71]
    v_mfma_f32_16x16x32_bf16 v[72:75], a[76:79], v[152:155], v[72:75]
    s_waitcnt vmcnt(17)
    v_mfma_f32_16x16x32_bf16 v[76:79], a[60:63], v[156:159], v[76:79]
    v_mfma_f32_16x16x32_bf16 v[80:83], a[64:67], v[156:159], v[80:83]
    v_mfma_f32_16x16x32_bf16 v[84:87], a[68:71], v[156:159], v[84:87]
    v_mfma_f32_16x16x32_bf16 v[88:91], a[72:75], v[156:159], v[88:91]
    v_mfma_f32_16x16x32_bf16 v[92:95], a[76:79], v[156:159], v[92:95]
    s_waitcnt vmcnt(16)
    v_mfma_f32_16x16x32_bf16 v[16:19], a[80:83], v[96:99], v[16:19]
    buffer_load_dwordx4 v[144:147], v2, s[36:39], s45 offen offset:0 sc1
    v_mfma_f32_16x16x32_bf16 v[20:23], a[84:87], v[96:99], v[20:23]
    v_mfma_f32_16x16x32_bf16 v[24:27], a[88:91], v[96:99], v[24:27]
    v_mfma_f32_16x16x32_bf16 v[28:31], a[92:95], v[96:99], v[28:31]
    buffer_load_dwordx4 v[148:151], v2, s[36:39], s45 offen offset:1024 sc1
    v_mfma_f32_16x16x32_bf16 v[32:35], a[96:99], v[96:99], v[32:35]
    s_waitcnt vmcnt(17)
    v_mfma_f32_16x16x32_bf16 v[36:39], a[80:83], v[100:103], v[36:39]
    v_mfma_f32_16x16x32_bf16 v[40:43], a[84:87], v[100:103], v[40:43]
    buffer_load_dwordx4 v[152:155], v2, s[36:39], s45 offen offset:2048 sc1
    v_mfma_f32_16x16x32_bf16 v[44:47], a[88:91], v[100:103], v[44:47]
    v_mfma_f32_16x16x32_bf16 v[48:51], a[92:95], v[100:103], v[48:51]
    v_mfma_f32_16x16x32_bf16 v[52:55], a[96:99], v[100:103], v[52:55]
    buffer_load_dwordx4 v[156:159], v2, s[36:39], s45 offen offset:3072 sc1
    s_waitcnt vmcnt(16)
    v_xor_b32 v184, s78, v186
    s_waitcnt vmcnt(15)
    v_xor_b32 v185, s78, v187
    v_or_b32 v184, v184, v185
    s_waitcnt vmcnt(14)
    v_xor_b32 v185, s78, v188
    v_or_b32 v184, v184, v185
    s_waitcnt vmcnt(13)
    v_xor_b32 v185, s78, v189
    v_or_b32 v184, v184, v185
    v_cmp_ne_u32 vcc, 0, v184
    s_nop 0
    s_cmp_eq_u64 vcc, 0
    s_cselect_b32 s64, 0, s26
    s_cmp_eq_u32 s64, 0
    s_cbranch_scc0 L_up_retry_11
L_up_ok_12:
    buffer_store_dword v253, v191, s[24:27], 0 offen sc1
    v_mfma_f32_16x16x32_bf16 v[56:59], a[80:83], v[104:107], v[56:59]
    v_mfma_f32_16x16x32_bf16 v[60:63], a[84:87], v[104:107], v[60:63]
    v_mfma_f32_16x16x32_bf16 v[64:67], a[88:91], v[104:107], v[64:67]
    v_mfma_f32_16x16x32_bf16 v[68:71], a[92:95], v[104:107], v[68:71]
    v_mfma_f32_16x16x32_bf16 v[72:75], a[96:99], v[104:107], v[72:75]
    v_mfma_f32_16x16x32_bf16 v[76:79], a[80:83], v[108:111], v[76:79]
    v_mfma_f32_16x16x32_bf16 v[80:83], a[84:87], v[108:111], v[80:83]
    v_mfma_f32_16x16x32_bf16 v[84:87], a[88:91], v[108:111], v[84:87]
    v_mfma_f32_16x16x32_bf16 v[88:91], a[92:95], v[108:111], v[88:91]
    v_mfma_f32_16x16x32_bf16 v[92:95], a[96:99], v[108:111], v[92:95]
    s_waitcnt vmcnt(13)
    v_mfma_f32_16x16x32_bf16 v[16:19], a[100:103], v[112:115], v[16:19]
    v_mfma_f32_16x16x32_bf16 v[20:23], a[104:107], v[112:115], v[20:23]
    v_mfma_f32_16x16x32_bf16 v[24:27], a[108:111], v[112:115], v[24:27]
    v_mfma_f32_16x16x32_bf16 v[28:31], a[112:115], v[112:115], v[28:31]
    v_mfma_f32_16x16x32_bf16 v[32:35], a[116:119], v[112:115], v[32:35]
    s_waitcnt vmcnt(12)
    v_mfma_f32_16x16x32_bf16 v[36:39], a[100:103], v[116:119], v[36:39]
    v_mfma_f32_16x16x32_bf16 v[40:43], a[104:107], v[116:119], v[40:43]
    v_mfma_f32_16x16x32_bf16 v[44:47], a[108:111], v[116:119], v[44:47]
    v_mfma_f32_16x16x32_bf16 v[48:51], a[112:115], v[116:119], v[48:51]
    v_mfma_f32_16x16x32_bf16 v[52:55], a[116:119], v[116:119], v[52:55]
    s_waitcnt vmcnt(11)
    v_mfma_f32_16x16x32_bf16 v[56:59], a[100:103], v[120:123], v[56:59]
    v_mfma_f32_16x16x32_bf16 v[60:63], a[104:107], v[120:123], v[60:63]
    v_mfma_f32_16x16x32_bf16 v[64:67], a[108:111], v[120:123], v[64:67]
    v_mfma_f32_16x16x32_bf16 v[68:71], a[112:115], v[120:123], v[68:71]
    v_mfma_f32_16x16x32_bf16 v[72:75], a[116:119], v[120:123], v[72:75]
    s_waitcnt vmcnt(10)
    v_mfma_f32_16x16x32_bf16 v[76:79], a[100:103], v[124:127], v[76:79]
    v_mfma_f32_16x16x32_bf16 v[80:83], a[104:107], v[124:127], v[80:83]
    v_mfma_f32_16x16x32_bf16 v[84:87], a[108:111], v[124:127], v[84:87]
    v_mfma_f32_16x16x32_bf16 v[88:91], a[112:115], v[124:127], v[88:91]
    v_mfma_f32_16x16x32_bf16 v[92:95], a[116:119], v[124:127], v[92:95]
    s_waitcnt vmcnt(9)
    v_mfma_f32_16x16x32_bf16 v[16:19], a[120:123], v[128:131], v[16:19]
    v_mfma_f32_16x16x32_bf16 v[20:23], a[124:127], v[128:131], v[20:23]
    s_waitcnt vmcnt(4)
    v_mfma_f32_16x16x32_bf16 v[16:19], a[140:143], v[144:147], v[16:19]
    v_mfma_f32_16x16x32_bf16 v[20:23], a[144:147], v[144:147], v[20:23]
    v_mfma_f32_16x16x32_bf16 v[24:27], a[128:131], v[128:131], v[24:27]
    v_mfma_f32_16x16x32_bf16 v[28:31], a[132:135], v[128:131], v[28:31]
    v_mfma_f32_16x16x32_bf16 v[24:27], a[148:151], v[144:147], v[24:27]
    v_mfma_f32_16x16x32_bf16 v[28:31], a[152:155], v[144:147], v[28:31]
    v_mfma_f32_16x16x32_bf16 v[32:35], a[136:139], v[128:131], v[32:35]
    s_nop 1
    ds_write_b128 v6, v[16:19] offset:0
    v_mfma_f32_16x16x32_bf16 v[36:39], a[120:123], v[132:135], v[36:39]
    buffer_load_dword v5, v4, s[12:15], 0 offen sc1
    v_mfma_f32_16x16x32_bf16 v[32:35], a[156:159], v[144:147], v[32:35]
    ds_write_b128 v6, v[20:23] offset:272
    s_waitcnt vmcnt(4)
    v_mfma_f32_16x16x32_bf16 v[36:39], a[140:143], v[148:151], v[36:39]
    v_mfma_f32_16x16x32_bf16 v[40:43], a[124:127], v[132:135], v[40:43]
    ds_write_b128 v6, v[24:27] offset:544
    v_mfma_f32_16x16x32_bf16 v[44:47], a[128:131], v[132:135], v[44:47]
    v_mfma_f32_16x16x32_bf16 v[40:43], a[144:147], v[148:151], v[40:43]
    ds_write_b128 v6, v[28:31] offset:816
    v_mfma_f32_16x16x32_bf16 v[44:47], a[148:151], v[148:151], v[44:47]
    v_mfma_f32_16x16x32_bf16 v[48:51], a[132:135], v[132:135], v[48:51]
    ds_write_b128 v6, v[32:35] offset:1088
    v_mfma_f32_16x16x32_bf16 v[52:55], a[136:139], v[132:135], v[52:55]
    v_mfma_f32_16x16x32_bf16 v[48:51], a[152:155], v[148:151], v[48:51]
    ds_write_b128 v6, v[36:39] offset:5376
    v_mfma_f32_16x16x32_bf16 v[52:55], a[156:159], v[148:151], v[52:55]
    v_mfma_f32_16x16x32_bf16 v[56:59], a[120:123], v[136:139], v[56:59]
    ds_write_b128 v6, v[40:43] offset:5648
    v_mfma_f32_16x16x32_bf16 v[60:63], a[124:127], v[136:139], v[60:63]
    s_waitcnt vmcnt(3)
    v_mfma_f32_16x16x32_bf16 v[56:59], a[140:143], v[152:155], v[56:59]
    ds_write_b128 v6, v[44:47] offset:5920
    v_mfma_f32_16x16x32_bf16 v[60:63], a[144:147], v[152:155], v[60:63]
    v_mfma_f32_16x16x32_bf16 v[64:67], a[128:131], v[136:139], v[64:67]
    ds_write_b128 v6, v[48:51] offset:6192
    v_mfma_f32_16x16x32_bf16 v[68:71], a[132:135], v[136:139], v[68:71]
    v_mfma_f32_16x16x32_bf16 v[64:67], a[148:151], v[152:155], v[64:67]
    ds_write_b128 v6, v[52:55] offset:6464
    v_mfma_f32_16x16x32_bf16 v[68:71], a[152:155], v[152:155], v[68:71]
    v_mfma_f32_16x16x32_bf16 v[72:75], a[136:139], v[136:139], v[72:75]
    ds_write_b128 v6, v[56:59] offset:10752
    v_mfma_f32_16x16x32_bf16 v[76:79], a[120:123], v[140:143], v[76:79]
    v_mfma_f32_16x16x32_bf16 v[72:75], a[156:159], v[152:155], v[72:75]
    ds_write_b128 v6, v[60:63] offset:11024
    s_waitcnt vmcnt(2)
    v_mfma_f32_16x16x32_bf16 v[76:79], a[140:143], v[156:159], v[76:79]
    v_mfma_f32_16x16x32_bf16 v[80:83], a[124:127], v[140:143], v[80:83]
    ds_write_b128 v6, v[64:67] offset:11296
    v_mfma_f32_16x16x32_bf16 v[84:87], a[128:131], v[140:143], v[84:87]
    v_mfma_f32_16x16x32_bf16 v[80:83], a[144:147], v[156:159], v[80:83]
    ds_write_b128 v6, v[68:71] offset:11568
    v_mfma_f32_16x16x32_bf16 v[84:87], a[148:151], v[156:159], v[84:87]
    v_mfma_f32_16x16x32_bf16 v[88:91], a[132:135], v[140:143], v[88:91]
    ds_write_b128 v6, v[72:75] offset:11840
    v_mfma_f32_16x16x32_bf16 v[92:95], a[136:139], v[140:143], v[92:95]
    v_mfma_f32_16x16x32_bf16 v[88:91], a[152:155], v[156:159], v[88:91]
    ds_write_b128 v6, v[76:79] offset:16128
    v_mfma_f32_16x16x32_bf16 v[92:95], a[156:159], v[156:159], v[92:95]
    ds_write_b128 v6, v[80:83] offset:16400
    s_nop 0
    ds_write_b128 v6, v[84:87] offset:16672
    s_nop 2
    ds_write_b128 v6, v[88:91] offset:16944
    s_nop 0
    ds_write_b128 v6, v[92:95] offset:17216
    s_waitcnt vmcnt(0)
    v_cmp_ne_u32 vcc, s78, v5
    s_nop 0
    s_cmp_eq_u64 vcc, 0
    s_cbranch_scc0 L_xf_retry_13
L_xf_ok_14:
    buffer_load_dwordx4 v[170:173], v2, s[12:15], s91 offen offset:0 sc1
    buffer_load_dwordx4 v[174:177], v2, s[12:15], s91 offen offset:1024 sc1
    buffer_load_dwordx2 v[178:179], v254, s[12:15], s91 offen offset:2048 sc1
    s_waitcnt lgkmcnt(0)
    s_barrier
    ds_read_b128 v[16:19], v7 offset:0
    ds_read_b128 v[20:23], v7 offset:21504
    ds_read_b128 v[24:27], v7 offset:43008
    ds_read_b128 v[28:31], v7 offset:64512
    ds_read_b128 v[32:35], v8 offset:0
    ds_read_b128 v[36:39], v8 offset:21504
    ds_read_b128 v[40:43], v8 offset:43008
    ds_read_b128 v[44:47], v8 offset:64512
    ds_read_b128 v[48:51], v9 offset:0
    ds_read_b128 v[52:55], v9 offset:21504
    ds_read_b128 v[56:59], v9 offset:43008
    ds_read_b128 v[60:63], v9 offset:64512
    ds_read_b128 v[64:67], v10 offset:0
    ds_read_b128 v[68:71], v10 offset:21504
    ds_read_b128 v[72:75], v10 offset:43008
    ds_read_b128 v[76:79], v10 offset:64512
    ds_read_b128 v[80:83], v11 offset:0
    ds_read_b128 v[84:87], v11 offset:21504
    ds_read_b128 v[88:91], v11 offset:43008
    ds_read_b128 v[92:95], v11 offset:64512
    s_waitcnt lgkmcnt(15)
    v_pk_add_f32 v[192:193], v[16:17], v[20:21]
    v_pk_add_f32 v[194:195], v[18:19], v[22:23]
    v_pk_add_f32 v[192:193], v[192:193], v[24:25]
    v_pk_add_f32 v[194:195], v[194:195], v[26:27]
    v_pk_add_f32 v[192:193], v[192:193], v[28:29]
    v_pk_add_f32 v[194:195], v[194:195], v[30:31]
    s_waitcnt lgkmcnt(14)
    v_pk_add_f32 v[196:197], v[32:33], v[36:37]
    v_pk_add_f32 v[198:199], v[34:35], v[38:39]
    s_waitcnt lgkmcnt(13)
    v_pk_add_f32 v[196:197], v[196:197], v[40:41]
    v_pk_add_f32 v[198:199], v[198:199], v[42:43]
    s_waitcnt lgkmcnt(12)
    v_pk_add_f32 v[196:197], v[196:197], v[44:45]
    v_pk_add_f32 v[198:199], v[198:199], v[46:47]
    s_waitcnt lgkmcnt(10)
    v_pk_add_f32 v[200:201], v[48:49], v[52:53]
    v_pk_add_f32 v[202:203], v[50:51], v[54:55]
    s_waitcnt lgkmcnt(9)
    v_pk_add_f32 v[200:201], v[200:201], v[56:57]
    v_pk_add_f32 v[202:203], v[202:203], v[58:59]
    s_waitcnt lgkmcnt(8)
    v_pk_add_f32 v[200:201], v[200:201], v[60:61]
    v_pk_add_f32 v[202:203], v[202:203], v[62:63]
    s_waitcnt lgkmcnt(6)
    v_pk_add_f32 v[204:205], v[64:65], v[68:69]
    v_pk_add_f32 v[206:207], v[66:67], v[70:71]
    s_waitcnt lgkmcnt(5)
    v_pk_add_f32 v[204:205], v[204:205], v[72:73]
    v_pk_add_f32 v[206:207], v[206:207], v[74:75]
    s_waitcnt lgkmcnt(4)
    v_pk_add_f32 v[204:205], v[204:205], v[76:77]
    v_pk_add_f32 v[206:207], v[206:207], v[78:79]
    s_waitcnt lgkmcnt(2)
    v_pk_add_f32 v[208:209], v[80:81], v[84:85]
    v_pk_add_f32 v[210:211], v[82:83], v[86:87]
    s_waitcnt lgkmcnt(1)
    v_pk_add_f32 v[208:209], v[208:209], v[88:89]
    v_pk_add_f32 v[210:211], v[210:211], v[90:91]
    s_waitcnt lgkmcnt(0)
    v_pk_add_f32 v[208:209], v[208:209], v[92:93]
    v_pk_add_f32 v[210:211], v[210:211], v[94:95]
    s_waitcnt vmcnt(2)
    v_lshlrev_b32 v160, 16, v170
    v_and_b32 v161, s92, v170
    v_lshlrev_b32 v162, 16, v171
    v_and_b32 v163, s92, v171
    v_pk_fma_f32 v[160:161], v[216:217], v[192:193], v[160:161] op_sel:[1,0,0] op_sel_hi:[1,1,1]
    v_pk_fma_f32 v[162:163], v[216:217], v[194:195], v[162:163] op_sel:[1,0,0] op_sel_hi:[1,1,1]
    buffer_store_dwordx4 v[160:163], v12, s[28:31], 0 offen nt
    v_lshlrev_b32 v164, 16, v172
    v_and_b32 v165, s92, v172
    v_lshlrev_b32 v166, 16, v173
    v_and_b32 v167, s92, v173
    v_pk_fma_f32 v[164:165], v[218:219], v[196:197], v[164:165] op_sel:[0,0,0] op_sel_hi:[0,1,1]
    v_pk_fma_f32 v[166:167], v[218:219], v[198:199], v[166:167] op_sel:[0,0,0] op_sel_hi:[0,1,1]
    buffer_store_dwordx4 v[164:167], v13, s[28:31], 0 offen nt
    s_waitcnt vmcnt(3)
    v_lshlrev_b32 v168, 16, v174
    v_and_b32 v169, s92, v174
    v_lshlrev_b32 v170, 16, v175
    v_and_b32 v171, s92, v175
    v_pk_fma_f32 v[168:169], v[218:219], v[200:201], v[168:169] op_sel:[1,0,0] op_sel_hi:[1,1,1]
    v_pk_fma_f32 v[170:171], v[218:219], v[202:203], v[170:171] op_sel:[1,0,0] op_sel_hi:[1,1,1]
    buffer_store_dwordx4 v[168:171], v14, s[28:31], 0 offen nt
    v_lshlrev_b32 v172, 16, v176
    v_and_b32 v173, s92, v176
    v_lshlrev_b32 v174, 16, v177
    v_and_b32 v175, s92, v177
    v_pk_fma_f32 v[172:173], v[220:221], v[204:205], v[172:173] op_sel:[0,0,0] op_sel_hi:[0,1,1]
    v_pk_fma_f32 v[174:175], v[220:221], v[206:207], v[174:175] op_sel:[0,0,0] op_sel_hi:[0,1,1]
    buffer_store_dwordx4 v[172:175], v15, s[28:31], 0 offen nt
    s_waitcnt vmcnt(4)
    v_lshlrev_b32 v176, 16, v178
    v_and_b32 v177, s92, v178
    v_lshlrev_b32 v178, 16, v179
    v_and_b32 v179, s92, v179
    v_pk_fma_f32 v[176:177], v[220:221], v[208:209], v[176:177] op_sel:[1,0,0] op_sel_hi:[1,1,1]
    v_pk_fma_f32 v[178:179], v[220:221], v[210:211], v[178:179] op_sel:[1,0,0] op_sel_hi:[1,1,1]
    buffer_store_dwordx4 v[176:179], v0, s[28:31], 0 offen nt
    s_endpgm
L_ssm2:
    s_sub_u32 s98, s80, 1024
    s_add_u32 s82, s80, 256
    s_min_u32 s82, s82, s98
    s_sub_u32 s98, s80, 896
    s_add_u32 s83, s80, 384
    s_min_u32 s83, s83, s98
    s_sub_u32 s98, s80, 768
    s_add_u32 s84, s80, 512
    s_min_u32 s84, s84, s98
    s_sub_u32 s98, s80, 640
    s_add_u32 s85, s80, 640
    s_min_u32 s85, s85, s98
    s_sub_u32 s98, s80, 512
    s_add_u32 s86, s80, 768
    s_min_u32 s86, s86, s98
    s_sub_u32 s98, s80, 384
    s_add_u32 s87, s80, 896
    s_min_u32 s87, s87, s98
    s_sub_u32 s98, s80, 256
    s_add_u32 s88, s80, 1024
    s_min_u32 s88, s88, s98
    s_sub_u32 s98, s80, 128
    s_add_u32 s89, s80, 1152
    s_min_u32 s89, s89, s98
    s_lshl_b32 s98, s73, 7
    s_add_u32 s98, s98, s76
    s_lshl_b32 s98, s98, 2
    s_add_u32 s98, s98, s72
    s_lshl_b32 s98, s98, 7
    s_add_u32 s98, s98, 327680
    v_mov_b32 v250, s98
    s_add_u32 s99, s98, 0x20000
    v_writelane_b32 v250, s99, 1
    s_add_u32 s99, s98, 0x60000
    v_writelane_b32 v250, s99, 2
    s_add_u32 s99, s98, 0x90000
    v_writelane_b32 v250, s99, 3
    s_lshl_b32 s98, s75, 4
    s_add_u32 s98, s98, s74
    s_lshl_b32 s98, s98, 2
    s_add_u32 s98, s98, s72
    s_mul_i32 s98, s98, 384
    s_add_u32 s98, s98, 131072
    v_and_b32 v251, 3, v1
    v_mul_u32_u24 v251, 104, v251
    v_add_u32 v251, s98, v251
    v_cmp_gt_u32 vcc, 16, v1
    s_nop 1
    v_cndmask_b32 v250, v251, v250, vcc
    s_lshl_b32 s98, s74, 3
    s_add_u32 s98, s98, s75
    s_lshl_b32 s98, s98, 2
    s_add_u32 s98, s98, s72
    s_lshl_b32 s98, s98, 6
    s_add_u32 s98, s98, 65536
    v_mov_b32 v251, s98
    v_cmp_gt_u32 vcc, 20, v1
    s_nop 1
    v_cndmask_b32 v250, v251, v250, vcc
    s_mul_i32 s98, s74, 720896
    s_add_u32 s98, s98, 0x560000
    v_writelane_b32 v250, s98, 32
    s_add_u32 s98, s98, 327552
    v_writelane_b32 v250, s98, 33
    s_mul_i32 s98, s75, 450560
    s_add_u32 s98, s98, 0x16c000
    v_writelane_b32 v250, s98, 34
    s_add_u32 s98, s98, 204672
    v_writelane_b32 v250, s98, 35
    s_mul_i32 s98, s76, 20480
    s_add_u32 s98, s98, 0x1001000
    v_writelane_b32 v250, s98, 36
    s_add_u32 s98, s98, 2621440
    v_writelane_b32 v250, s98, 37
    buffer_load_dword v251, v250, s[12:15], 0 offen sc1
    s_mul_i32 s98, s74, 327680
    s_add_u32 s98, s98, 163840
    v_and_b32 v249, 1, v1
    v_mul_u32_u24 v249, 161280, v249
    v_add_u32 v249, s98, v249
    global_load_dword v241, v249, s[66:67]
    s_lshl_b32 s90, s72, 7
    s_add_u32 s90, s90, s76
    s_mov_b32 s24, s70
    s_mov_b32 s25, s71
    s_mov_b32 s16, s50
    s_mov_b32 s17, s51
    s_cmp_lt_u32 s90, 400
    s_cselect_b32 s26, 0x1700000, 0
    s_cselect_b32 s18, 819200, 0
    s_mov_b32 s27, 0x20000
    s_mov_b32 s19, 0x20000
    s_mul_i32 s99, s90, 6554
    s_lshr_b32 s99, s99, 16
    s_mul_i32 s100, s99, 10
    s_sub_u32 s100, s90, s100
    s_lshl_b32 s101, s100, 7
    s_mul_i32 s90, s99, 20480
    s_add_u32 s90, s90, s101
    s_mov_b32 s20, s52
    s_mov_b32 s21, s53
    s_mov_b32 s22, s18
    s_mov_b32 s23, 0x20000
    s_mul_i32 s101, s99, 52
    s_lshr_b32 s101, s101, 8
    s_mul_i32 s101, s101, 435
    s_add_u32 s99, s99, s101
    s_mul_i32 s101, s100, 20
    s_add_u32 s99, s99, s101
    s_lshl_b32 s99, s99, 10
    s_add_u32 s94, s99, 0x16c000
    s_add_u32 s95, s99, 0x16d400
    s_add_u32 s96, s99, 0x16e800
    s_add_u32 s97, s99, 0x16fc00
    v_lshrrev_b32 v8, 5, v1
    v_lshlrev_b32 v8, 11, v8
    v_and_b32 v9, 15, v1
    v_lshl_add_u32 v8, v9, 7, v8
    v_bfe_u32 v9, v1, 4, 1
    v_lshl_add_u32 v8, v9, 4, v8
    s_lshl_b32 s101, s72, 12
    s_add_u32 s101, s101, 147456
    v_add_u32 v217, s101, v8
    s_mov_b32 s93, s101
    v_lshrrev_b32 v8, 3, v1
    v_and_b32 v9, 7, v1
    v_mul_u32_u24 v8, 1280, v8
    v_lshl_add_u32 v218, v9, 4, v8
    s_mov_b32 m0, s93
    s_add_u32 s98, s90, 9216
    buffer_load_dwordx4 v218, s[16:19], s90 offen offset:0 nt lds
    buffer_load_dwordx4 v218, s[16:19], s98 offen offset:1024 nt lds
    s_add_u32 m0, s93, 2048
    s_nop 0
    buffer_load_dwordx4 v218, s[20:23], s90 offen offset:0 nt lds
    buffer_load_dwordx4 v218, s[20:23], s98 offen offset:1024 nt lds
    v_and_b32 v7, 15, v1
    v_bfe_u32 v8, v1, 1, 3
    v_xor_b32 v8, v8, v6
    v_lshlrev_b32 v8, 4, v8
    v_lshl_add_u32 v8, v7, 7, v8
    v_add_u32 v149, s91, v8
    v_xor_b32 v150, 64, v149
    v_add_u32 v151, 65536, v8
    v_xor_b32 v152, 64, v151
    v_add_u32 v153, 40960, v151
    v_add_u32 v154, 40960, v152
    s_mov_b32 s28, s66
    s_mov_b32 s29, s67
    s_mov_b32 s30, 0x500000
    s_mov_b32 s31, 0x20000
    s_mul_i32 s79, s75, 450560
    s_add_u32 s79, s79, 0x130000
    s_add_u32 s32, s70, s79
    s_addc_u32 s33, s71, 0
    s_mov_b32 s34, 0x6e000
    s_mov_b32 s35, 0x20000
    s_mul_i32 s79, s74, 720896
    s_add_u32 s79, s79, 0x500000
    s_add_u32 s36, s70, s79
    s_addc_u32 s37, s71, 0
    s_mov_b32 s38, 0xb0000
    s_mov_b32 s39, 0x20000
    v_min_u32 v5, 14, v1
    v_mul_u32_u24 v4, 11, v5
    v_lshrrev_b32 v4, 5, v4
    v_mul_u32_u24 v4, 7, v4
    s_mul_i32 s79, s75, 50
    v_add3_u32 v4, v5, v4, s79
    s_mul_i32 s79, s72, 10
    s_lshr_b32 s79, s79, 2
    v_add_u32 v4, s79, v4
    v_and_b32 v5, 127, v4
    v_lshrrev_b32 v4, 7, v4
    v_lshlrev_b32 v5, 9, v5
    v_lshl_add_u32 v159, v4, 7, v5
    v_add_u32 v159, 720896, v159
    s_lshl_b32 s79, s73, 7
    s_add_u32 s79, s79, s76
    s_lshl_b32 s79, s79, 2
    s_add_u32 s79, s79, s72
    s_lshl_b32 s79, s79, 7
    s_add_u32 s79, s79, 720896
    v_mov_b32 v254, s79
    s_lshl_b32 s79, s72, 11
    s_mul_i32 s101, s75, 40960
    s_add_u32 s79, s79, s101
    s_add_u32 s79, s79, 0x60000
    v_add_u32 v156, s79, v2
    s_and_b32 s79, s74, 3
    s_mul_i32 s79, s79, 3
    s_add_u32 s79, s79, s75
    s_sub_u32 s69, s79, 10
    s_min_u32 s69, s69, s79
    s_mul_i32 s53, s72, 10
    s_add_u32 s53, s53, 48
    s_add_u32 s58, s69, s53
    s_mul_i32 s40, s58, 5120
    s_lshl_b32 s58, s58, 13
    s_sub_u32 s79, s69, 9
    s_add_u32 s59, s69, 1
    s_min_u32 s59, s59, s79
    s_add_u32 s59, s59, s53
    s_mul_i32 s41, s59, 5120
    s_lshl_b32 s59, s59, 13
    s_sub_u32 s79, s69, 8
    s_add_u32 s60, s69, 2
    s_min_u32 s60, s60, s79
    s_add_u32 s60, s60, s53
    s_mul_i32 s46, s60, 5120
    s_lshl_b32 s60, s60, 13
    s_sub_u32 s79, s69, 7
    s_add_u32 s61, s69, 3
    s_min_u32 s61, s61, s79
    s_add_u32 s61, s61, s53
    s_mul_i32 s47, s61, 5120
    s_lshl_b32 s61, s61, 13
    s_sub_u32 s79, s69, 6
    s_add_u32 s62, s69, 4
    s_min_u32 s62, s62, s79
    s_add_u32 s62, s62, s53
    s_mul_i32 s48, s62, 5120
    s_lshl_b32 s62, s62, 13
    s_sub_u32 s79, s69, 5
    s_add_u32 s63, s69, 5
    s_min_u32 s63, s63, s79
    s_add_u32 s63, s63, s53
    s_mul_i32 s49, s63, 5120
    s_lshl_b32 s63, s63, 13
    s_sub_u32 s79, s69, 4
    s_add_u32 s66, s69, 6
    s_min_u32 s66, s66, s79
    s_add_u32 s66, s66, s53
    s_mul_i32 s50, s66, 5120
    s_lshl_b32 s66, s66, 13
    s_sub_u32 s79, s69, 3
    s_add_u32 s67, s69, 7
    s_min_u32 s67, s67, s79
    s_add_u32 s67, s67, s53
    s_mul_i32 s51, s67, 5120
    s_lshl_b32 s67, s67, 13
    s_sub_u32 s79, s69, 2
    s_add_u32 s68, s69, 8
    s_min_u32 s68, s68, s79
    s_add_u32 s68, s68, s53
    s_mul_i32 s52, s68, 5120
    s_lshl_b32 s68, s68, 13
    s_sub_u32 s79, s69, 1
    s_add_u32 s69, s69, 9
    s_min_u32 s69, s69, s79
    s_add_u32 s69, s69, s53
    s_mul_i32 s53, s69, 5120
    s_lshl_b32 s69, s69, 13
    s_lshl_b32 s100, s72, 2
    v_add_u32 v6, s100, v6
    v_lshlrev_b32 v180, 3, v6
    v_cvt_f32_u32 v180, v180
    v_lshlrev_b32 v6, 3, v6
    v_lshlrev_b32 v11, 5, v7
    v_add_u32 v11, 158720, v11
    v_lshlrev_b32 v10, 5, v155
    v_add_u32 v10, 158720, v10
    v_mul_u32_u24 v8, 144, v7
    v_add_u32 v6, v6, v8
    v_add_u32 v6, 147456, v6
    v_lshlrev_b32 v7, 3, v7
    v_add_u32 v7, 147456, v7
    v_mul_u32_u24 v8, 144, v155
    v_add_u32 v8, 147456, v8
    s_mul_i32 s100, s75, 24576
    s_mul_i32 s77, s72, 64
    s_add_u32 s100, s100, s77
    s_add_u32 s100, s100, 131072
    v_lshlrev_b32 v9, 4, v155
    v_add_u32 v9, s100, v9
    s_mul_i32 s77, s74, 1536
    v_mul_u32_u24 v181, 640, v216
    v_cvt_f32_u32 v181, v181
    s_add_u32 m0, s92, 20480
    s_nop 0
    buffer_load_dwordx4 v144, s[8:11], s81 offen offset:0 lds
    buffer_load_dwordx4 v145, s[8:11], s81 offen offset:1024 lds
    buffer_load_dwordx4 v146, s[8:11], s81 offen offset:2048 lds
    buffer_load_dwordx4 v147, s[8:11], s81 offen offset:3072 lds
    s_add_u32 m0, s92, 24576
    s_nop 0
    buffer_load_dwordx4 v148, s[8:11], s81 offen lds
    s_waitcnt vmcnt(18)
    s_barrier
    ds_read_b128 a[56:59], v149 offset:0
    ds_read_b128 a[60:63], v149 offset:2048
    ds_read_b128 a[0:3], v151 offset:0
    s_add_u32 m0, s91, 8192
    ds_read_b128 a[4:7], v151 offset:10240
    buffer_load_dwordx4 v140, s[4:7], s82 offen offset:0 lds
    ds_read_b128 a[8:11], v151 offset:2048
    buffer_load_dwordx4 v141, s[4:7], s82 offen offset:1024 lds
    ds_read_b128 a[12:15], v151 offset:12288
    buffer_load_dwordx4 v142, s[4:7], s82 offen offset:2048 lds
    ds_read_b128 a[16:19], v151 offset:4096
    buffer_load_dwordx4 v143, s[4:7], s82 offen offset:3072 lds
    ds_read_b128 a[20:23], v151 offset:14336
    ds_read_b128 a[24:27], v151 offset:6144
    s_add_u32 m0, s92, 40960
    ds_read_b128 a[28:31], v151 offset:16384
    buffer_load_dwordx4 v144, s[8:11], s82 offen offset:0 lds
    ds_read_b128 a[32:35], v151 offset:8192
    buffer_load_dwordx4 v145, s[8:11], s82 offen offset:1024 lds
    s_waitcnt lgkmcnt(0)
    v_mfma_f32_16x16x32_bf16 v[16:19], a[56:59], a[0:3], 0
    ds_read_b128 a[36:39], v151 offset:18432
    buffer_load_dwordx4 v146, s[8:11], s82 offen offset:2048 lds
    ds_read_b128 a[64:67], v150 offset:0
    v_mfma_f32_16x16x32_bf16 v[20:23], a[60:63], a[0:3], 0
    ds_read_b128 a[68:71], v150 offset:2048
    ds_read_b128 a[40:43], v152 offset:0
    v_mfma_f32_16x16x32_bf16 v[24:27], a[56:59], a[4:7], 0
    buffer_load_dwordx4 v147, s[8:11], s82 offen offset:3072 lds
    s_mul_i32 s78, s78, 1664525
    v_mfma_f32_16x16x32_bf16 v[28:31], a[60:63], a[4:7], 0
    ds_read_b128 a[44:47], v152 offset:10240
    s_add_u32 m0, s92, 45056
    v_mfma_f32_16x16x32_bf16 v[32:35], a[56:59], a[8:11], 0
    ds_read_b128 a[48:51], v152 offset:2048
    s_add_u32 s78, s78, 1013904223
    v_mfma_f32_16x16x32_bf16 v[36:39], a[60:63], a[8:11], 0
    buffer_load_dwordx4 v148, s[8:11], s82 offen lds
    v_mov_b32 v253, s78
    v_mfma_f32_16x16x32_bf16 v[40:43], a[56:59], a[12:15], 0
    ds_read_b128 a[52:55], v152 offset:12288
    s_add_u32 m0, s91, 12288
    s_waitcnt vmcnt(24)
    v_lshlrev_b32 v162, 16, v162
    v_mfma_f32_16x16x32_bf16 v[44:47], a[60:63], a[12:15], 0
    ds_read_b128 a[0:3], v152 offset:4096
    v_mul_f32 v162, 0x3fb8aa3b, v162
    v_mfma_f32_16x16x32_bf16 v[48:51], a[56:59], a[16:19], 0
    buffer_load_dwordx4 v140, s[4:7], s83 offen offset:0 lds
    ds_read_b128 a[4:7], v152 offset:14336
    v_exp_f32 v162, v162
    v_mfma_f32_16x16x32_bf16 v[52:55], a[60:63], a[16:19], 0
    buffer_load_dwordx4 v141, s[4:7], s83 offen offset:1024 lds
    v_lshlrev_b32 v160, 16, v160
    v_mfma_f32_16x16x32_bf16 v[56:59], a[56:59], a[20:23], 0
    ds_read_b128 a[8:11], v152 offset:6144
    v_cvt_pk_bf16_f32 v162, v162, v162
    v_mfma_f32_16x16x32_bf16 v[60:63], a[60:63], a[20:23], 0
    buffer_load_dwordx4 v142, s[4:7], s83 offen offset:2048 lds
    ds_read_b128 a[12:15], v152 offset:16384
    v_lshlrev_b32 v161, 16, v161
    v_mfma_f32_16x16x32_bf16 v[64:67], a[56:59], a[24:27], 0
    buffer_load_dwordx4 v143, s[4:7], s83 offen offset:3072 lds
    v_lshlrev_b32 v162, 16, v162
    v_mul_f32 v170, v162, v160
    v_mfma_f32_16x16x32_bf16 v[68:71], a[60:63], a[24:27], 0
    ds_read_b128 a[16:19], v152 offset:8192
    v_mul_f32 v171, v162, v161
    v_mfma_f32_16x16x32_bf16 v[72:75], a[56:59], a[28:31], 0
    s_add_u32 m0, s92, 61440
    ds_read_b128 a[20:23], v152 offset:18432
    v_mul_f32 v170, 0x3fb8aa3b, v170
    v_mfma_f32_16x16x32_bf16 v[76:79], a[60:63], a[28:31], 0
    buffer_load_dwordx4 v144, s[8:11], s83 offen offset:0 lds
    v_mul_f32 v171, 0.15915494, v171
    s_waitcnt lgkmcnt(8)
    v_mfma_f32_16x16x32_bf16 v[80:83], a[56:59], a[32:35], 0
    v_exp_f32 v182, v170
    v_mfma_f32_16x16x32_bf16 v[84:87], a[60:63], a[32:35], 0
    buffer_load_dwordx4 v145, s[8:11], s83 offen offset:1024 lds
    v_rndne_f32 v183, v171
    v_mfma_f32_16x16x32_bf16 v[88:91], a[56:59], a[36:39], 0
    buffer_load_dwordx4 v146, s[8:11], s83 offen offset:2048 lds
    v_sub_f32 v183, v171, v183
    v_mfma_f32_16x16x32_bf16 v[92:95], a[60:63], a[36:39], 0
    v_cos_f32 v164, v183
    v_mfma_f32_16x16x32_bf16 v[16:19], a[64:67], a[40:43], v[16:19]
    buffer_load_dwordx4 v147, s[8:11], s83 offen offset:3072 lds
    v_sin_f32 v165, v183
    v_mfma_f32_16x16x32_bf16 v[20:23], a[68:71], a[40:43], v[20:23]
    s_add_u32 m0, s92, 65536
    v_mul_f32 v164, v182, v164
    v_mfma_f32_16x16x32_bf16 v[24:27], a[64:67], a[44:47], v[24:27]
    v_mul_f32 v165, v182, v165
    v_mul_f32 v184, v160, v160
    v_mfma_f32_16x16x32_bf16 v[28:31], a[68:71], a[44:47], v[28:31]
    buffer_load_dwordx4 v148, s[8:11], s83 offen lds
    s_waitcnt lgkmcnt(4)
    v_mfma_f32_16x16x32_bf16 v[32:35], a[64:67], a[48:51], v[32:35]
    v_fmac_f32 v184, v161, v161
    v_mfma_f32_16x16x32_bf16 v[36:39], a[68:71], a[48:51], v[36:39]
    v_rcp_f32 v184, v184
    v_mfma_f32_16x16x32_bf16 v[40:43], a[64:67], a[52:55], v[40:43]
    s_waitcnt vmcnt(18) lgkmcnt(0)
    s_barrier
    ds_read_b128 a[56:59], v149 offset:4096
    v_add_f32 v163, -1.0, v164
    v_mfma_f32_16x16x32_bf16 v[44:47], a[68:71], a[52:55], v[44:47]
    ds_read_b128 a[60:63], v149 offset:6144
    ds_read_b128 a[24:27], v151 offset:20480
    v_mul_f32 v182, v164, v164
    v_mfma_f32_16x16x32_bf16 v[48:51], a[64:67], a[0:3], v[48:51]
    s_add_u32 m0, s91, 0
    v_mul_f32 v183, v164, v165
    v_mfma_f32_16x16x32_bf16 v[52:55], a[68:71], a[0:3], v[52:55]
    ds_read_b128 a[28:31], v151 offset:30720
    v_mul_f32 v166, v163, v160
    v_add_f32 v184, v184, v184
    v_mfma_f32_16x16x32_bf16 v[56:59], a[64:67], a[4:7], v[56:59]
    ds_read_b128 a[32:35], v151 offset:22528
    buffer_load_dwordx4 v140, s[4:7], s84 offen offset:0 lds
    v_fmac_f32 v166, v165, v161
    v_mfma_f32_16x16x32_bf16 v[60:63], a[68:71], a[4:7], v[60:63]
    v_mul_f32 v167, v165, v160
    v_mfma_f32_16x16x32_bf16 v[64:67], a[64:67], a[8:11], v[64:67]
    ds_read_b128 a[36:39], v151 offset:32768
    buffer_load_dwordx4 v141, s[4:7], s84 offen offset:1024 lds
    v_fma_f32 v167, -v163, v161, v167
    v_mfma_f32_16x16x32_bf16 v[68:71], a[68:71], a[8:11], v[68:71]
    ds_read_b128 a[40:43], v151 offset:24576
    v_mul_f32 v166, v166, v184
    v_mul_f32 v167, v167, v184
    v_mfma_f32_16x16x32_bf16 v[72:75], a[64:67], a[12:15], v[72:75]
    buffer_load_dwordx4 v142, s[4:7], s84 offen offset:2048 lds
    ds_read_b128 a[44:47], v151 offset:34816
    v_fma_f32 v182, -v165, v165, v182
    v_mfma_f32_16x16x32_bf16 v[76:79], a[68:71], a[12:15], v[76:79]
    v_add_f32 v183, v183, v183
    v_mul_f32 v168, v182, v182
    v_mfma_f32_16x16x32_bf16 v[80:83], a[64:67], a[16:19], v[80:83]
    ds_read_b128 a[48:51], v151 offset:26624
    buffer_load_dwordx4 v143, s[4:7], s84 offen offset:3072 lds
    v_mfma_f32_16x16x32_bf16 v[84:87], a[68:71], a[16:19], v[84:87]
    ds_read_b128 a[52:55], v151 offset:36864
    v_mul_f32 v169, v182, v183
    v_fma_f32 v168, -v183, v183, v168
    v_mfma_f32_16x16x32_bf16 v[88:91], a[64:67], a[20:23], v[88:91]
    s_add_u32 m0, s92, 0
    v_add_f32 v169, v169, v169
    v_mfma_f32_16x16x32_bf16 v[92:95], a[68:71], a[20:23], v[92:95]
    ds_read_b128 a[0:3], v151 offset:28672
    v_mul_f32 v182, 0x41000000, v170
    s_waitcnt lgkmcnt(5)
    v_mfma_f32_16x16x32_bf16 v[16:19], a[56:59], a[24:27], v[16:19]
    ds_read_b128 a[4:7], v151 offset:38912
    buffer_load_dwordx4 v144, s[8:11], s84 offen offset:0 lds
    ds_read_b128 a[64:67], v150 offset:4096
    v_mul_f32 v136, 0x41000000, v171
    v_mfma_f32_16x16x32_bf16 v[20:23], a[60:63], a[24:27], v[20:23]
    ds_read_b128 a[68:71], v150 offset:6144
    ds_read_b128 a[8:11], v152 offset:20480
    ds_read_b128 a[240:243], v217 offset:0
    v_exp_f32 v182, v182
    v_mfma_f32_16x16x32_bf16 v[24:27], a[56:59], a[28:31], v[24:27]
    buffer_load_dwordx4 v145, s[8:11], s84 offen offset:1024 lds
    ds_read_b128 a[244:247], v217 offset:32
    v_mfma_f32_16x16x32_bf16 v[28:31], a[60:63], a[28:31], v[28:31]
    ds_read_b128 a[12:15], v152 offset:30720
    ds_read_b128 a[248:251], v217 offset:64
    v_rndne_f32 v183, v136
    v_sub_f32 v183, v136, v183
    v_mfma_f32_16x16x32_bf16 v[32:35], a[56:59], a[32:35], v[32:35]
    ds_read_b128 a[16:19], v152 offset:22528
    buffer_load_dwordx4 v146, s[8:11], s84 offen offset:2048 lds
    ds_read_b128 a[252:255], v217 offset:96
    v_cos_f32 v136, v183
    v_mfma_f32_16x16x32_bf16 v[36:39], a[60:63], a[32:35], v[36:39]
    v_sin_f32 v137, v183
    v_mfma_f32_16x16x32_bf16 v[40:43], a[56:59], a[36:39], v[40:43]
    ds_read_b128 a[20:23], v152 offset:32768
    buffer_load_dwordx4 v147, s[8:11], s84 offen offset:3072 lds
    v_mfma_f32_16x16x32_bf16 v[44:47], a[60:63], a[36:39], v[44:47]
    ds_read_b128 a[24:27], v152 offset:24576
    v_mul_f32 v136, v182, v136
    s_waitcnt lgkmcnt(13)
    v_mfma_f32_16x16x32_bf16 v[48:51], a[56:59], a[40:43], v[48:51]
    s_add_u32 m0, s92, 4096
    ds_read_b128 a[28:31], v152 offset:34816
    v_mul_f32 v137, v182, v137
    v_mfma_f32_16x16x32_bf16 v[52:55], a[60:63], a[40:43], v[52:55]
    v_mul_f32 v182, 0x43000000, v170
    v_mfma_f32_16x16x32_bf16 v[56:59], a[56:59], a[44:47], v[56:59]
    ds_read_b128 a[32:35], v152 offset:26624
    buffer_load_dwordx4 v148, s[8:11], s84 offen lds
    v_mul_f32 v138, 0x43000000, v171
    v_mfma_f32_16x16x32_bf16 v[60:63], a[60:63], a[44:47], v[60:63]
    ds_read_b128 a[36:39], v152 offset:36864
    v_exp_f32 v182, v182
    v_mfma_f32_16x16x32_bf16 v[64:67], a[56:59], a[48:51], v[64:67]
    s_waitcnt lgkmcnt(10)
    buffer_store_dwordx4 a[240:243], v2, s[24:27], s94 offen sc1
    v_rndne_f32 v183, v138
    v_mfma_f32_16x16x32_bf16 v[68:71], a[60:63], a[48:51], v[68:71]
    ds_read_b128 a[40:43], v152 offset:28672
    s_waitcnt lgkmcnt(10)
    buffer_store_dwordx4 a[244:247], v2, s[24:27], s95 offen sc1
    v_sub_f32 v183, v138, v183
    v_mfma_f32_16x16x32_bf16 v[72:75], a[56:59], a[52:55], v[72:75]
    ds_read_b128 a[44:47], v152 offset:38912
    s_waitcnt lgkmcnt(9)
    buffer_store_dwordx4 a[248:251], v2, s[24:27], s96 offen sc1
    v_cos_f32 v138, v183
    v_mfma_f32_16x16x32_bf16 v[76:79], a[60:63], a[52:55], v[76:79]
    s_waitcnt lgkmcnt(7)
    buffer_store_dwordx4 a[252:255], v2, s[24:27], s97 offen sc1
    v_sin_f32 v139, v183
    v_mfma_f32_16x16x32_bf16 v[80:83], a[56:59], a[0:3], v[80:83]
    v_mul_f32 v138, v182, v138
    v_mul_f32 v139, v182, v139
    v_mfma_f32_16x16x32_bf16 v[84:87], a[60:63], a[0:3], v[84:87]
    v_mul_f32 v182, v181, v170
    v_mul_f32 v214, v181, v171
    v_mfma_f32_16x16x32_bf16 v[88:91], a[56:59], a[4:7], v[88:91]
    v_exp_f32 v182, v182
    v_mfma_f32_16x16x32_bf16 v[92:95], a[60:63], a[4:7], v[92:95]
    v_rndne_f32 v183, v214
    v_sub_f32 v183, v214, v183
    v_mfma_f32_16x16x32_bf16 v[16:19], a[64:67], a[8:11], v[16:19]
    v_cos_f32 v214, v183
    v_mfma_f32_16x16x32_bf16 v[20:23], a[68:71], a[8:11], v[20:23]
    v_sin_f32 v215, v183
    v_mfma_f32_16x16x32_bf16 v[24:27], a[64:67], a[12:15], v[24:27]
    v_mul_f32 v214, v182, v214
    v_mul_f32 v215, v182, v215
    v_mfma_f32_16x16x32_bf16 v[28:31], a[68:71], a[12:15], v[28:31]
    s_waitcnt lgkmcnt(4)
    v_mfma_f32_16x16x32_bf16 v[32:35], a[64:67], a[16:19], v[32:35]
    v_mfma_f32_16x16x32_bf16 v[36:39], a[68:71], a[16:19], v[36:39]
    v_mfma_f32_16x16x32_bf16 v[40:43], a[64:67], a[20:23], v[40:43]
    s_waitcnt vmcnt(22) lgkmcnt(0)
    s_barrier
    ds_read_b128 a[56:59], v149 offset:8192
    v_mfma_f32_16x16x32_bf16 v[44:47], a[68:71], a[20:23], v[44:47]
    ds_read_b128 a[60:63], v149 offset:10240
    ds_read_b128 a[48:51], v153 offset:0
    v_mfma_f32_16x16x32_bf16 v[48:51], a[64:67], a[24:27], v[48:51]
    s_add_u32 m0, s91, 4096
    v_mfma_f32_16x16x32_bf16 v[52:55], a[68:71], a[24:27], v[52:55]
    ds_read_b128 a[52:55], v153 offset:10240
    ds_write_b128 v10, v[164:167]
    ds_write_b128 v10, v[168:171] offset:16
    v_mfma_f32_16x16x32_bf16 v[56:59], a[64:67], a[28:31], v[56:59]
    ds_read_b128 a[0:3], v153 offset:2048
    buffer_load_dwordx4 v140, s[4:7], s85 offen offset:0 lds
    v_mfma_f32_16x16x32_bf16 v[60:63], a[68:71], a[28:31], v[60:63]
    v_mfma_f32_16x16x32_bf16 v[64:67], a[64:67], a[32:35], v[64:67]
    ds_read_b128 a[4:7], v153 offset:12288
    buffer_load_dwordx4 v141, s[4:7], s85 offen offset:1024 lds
    v_mfma_f32_16x16x32_bf16 v[68:71], a[68:71], a[32:35], v[68:71]
    ds_read_b128 a[8:11], v153 offset:4096
    v_mfma_f32_16x16x32_bf16 v[72:75], a[64:67], a[36:39], v[72:75]
    buffer_load_dwordx4 v142, s[4:7], s85 offen offset:2048 lds
    ds_read_b128 a[12:15], v153 offset:14336
    v_mfma_f32_16x16x32_bf16 v[76:79], a[68:71], a[36:39], v[76:79]
    v_mfma_f32_16x16x32_bf16 v[80:83], a[64:67], a[40:43], v[80:83]
    ds_read_b128 a[16:19], v153 offset:6144
    buffer_load_dwordx4 v143, s[4:7], s85 offen offset:3072 lds
    v_mfma_f32_16x16x32_bf16 v[84:87], a[68:71], a[40:43], v[84:87]
    ds_read_b128 a[20:23], v153 offset:16384
    v_mfma_f32_16x16x32_bf16 v[88:91], a[64:67], a[44:47], v[88:91]
    s_add_u32 m0, s92, 20480
    v_mfma_f32_16x16x32_bf16 v[92:95], a[68:71], a[44:47], v[92:95]
    ds_read_b128 a[24:27], v153 offset:8192
    s_waitcnt lgkmcnt(5)
    v_mfma_f32_16x16x32_bf16 v[16:19], a[56:59], a[48:51], v[16:19]
    ds_read_b128 a[28:31], v153 offset:18432
    buffer_load_dwordx4 v144, s[8:11], s85 offen offset:0 lds
    ds_read_b128 a[64:67], v150 offset:8192
    v_mfma_f32_16x16x32_bf16 v[20:23], a[60:63], a[48:51], v[20:23]
    ds_read_b128 a[68:71], v150 offset:10240
    ds_read_b128 a[32:35], v154 offset:0
    v_mfma_f32_16x16x32_bf16 v[24:27], a[56:59], a[52:55], v[24:27]
    buffer_load_dwordx4 v145, s[8:11], s85 offen offset:1024 lds
    v_mfma_f32_16x16x32_bf16 v[28:31], a[60:63], a[52:55], v[28:31]
    ds_read_b128 a[36:39], v154 offset:10240
    v_mfma_f32_16x16x32_bf16 v[32:35], a[56:59], a[0:3], v[32:35]
    ds_read_b128 a[40:43], v154 offset:2048
    buffer_load_dwordx4 v146, s[8:11], s85 offen offset:2048 lds
    v_mfma_f32_16x16x32_bf16 v[36:39], a[60:63], a[0:3], v[36:39]
    v_mfma_f32_16x16x32_bf16 v[40:43], a[56:59], a[4:7], v[40:43]
    ds_read_b128 a[44:47], v154 offset:12288
    buffer_load_dwordx4 v147, s[8:11], s85 offen offset:3072 lds
    v_mfma_f32_16x16x32_bf16 v[44:47], a[60:63], a[4:7], v[44:47]
    ds_read_b128 a[48:51], v154 offset:4096
    s_waitcnt lgkmcnt(9)
    v_mfma_f32_16x16x32_bf16 v[48:51], a[56:59], a[8:11], v[48:51]
    s_add_u32 m0, s92, 24576
    ds_read_b128 a[52:55], v154 offset:14336
    v_mfma_f32_16x16x32_bf16 v[52:55], a[60:63], a[8:11], v[52:55]
    v_mfma_f32_16x16x32_bf16 v[56:59], a[56:59], a[12:15], v[56:59]
    ds_read_b128 a[0:3], v154 offset:6144
    buffer_load_dwordx4 v148, s[8:11], s85 offen lds
    v_mfma_f32_16x16x32_bf16 v[60:63], a[60:63], a[12:15], v[60:63]
    ds_read_b128 a[4:7], v154 offset:16384
    v_mfma_f32_16x16x32_bf16 v[64:67], a[56:59], a[16:19], v[64:67]
    v_mfma_f32_16x16x32_bf16 v[68:71], a[60:63], a[16:19], v[68:71]
    ds_read_b128 a[8:11], v154 offset:8192
    v_mfma_f32_16x16x32_bf16 v[72:75], a[56:59], a[20:23], v[72:75]
    ds_read_b128 a[12:15], v154 offset:18432
    v_mfma_f32_16x16x32_bf16 v[76:79], a[60:63], a[20:23], v[76:79]
    s_waitcnt lgkmcnt(8)
    v_mfma_f32_16x16x32_bf16 v[80:83], a[56:59], a[24:27], v[80:83]
    v_mfma_f32_16x16x32_bf16 v[84:87], a[60:63], a[24:27], v[84:87]
    v_mfma_f32_16x16x32_bf16 v[88:91], a[56:59], a[28:31], v[88:91]
    v_mfma_f32_16x16x32_bf16 v[92:95], a[60:63], a[28:31], v[92:95]
    v_mfma_f32_16x16x32_bf16 v[16:19], a[64:67], a[32:35], v[16:19]
    v_mfma_f32_16x16x32_bf16 v[20:23], a[68:71], a[32:35], v[20:23]
    v_mfma_f32_16x16x32_bf16 v[24:27], a[64:67], a[36:39], v[24:27]
    v_mfma_f32_16x16x32_bf16 v[28:31], a[68:71], a[36:39], v[28:31]
    s_waitcnt lgkmcnt(4)
    v_mfma_f32_16x16x32_bf16 v[32:35], a[64:67], a[40:43], v[32:35]
    v_mfma_f32_16x16x32_bf16 v[36:39], a[68:71], a[40:43], v[36:39]
    v_mfma_f32_16x16x32_bf16 v[40:43], a[64:67], a[44:47], v[40:43]
    s_waitcnt vmcnt(22) lgkmcnt(0)
    s_barrier
    s_waitcnt vmcnt(9)
    buffer_store_dword v253, v254, s[24:27], 0 offen sc1
    ds_read_b128 a[56:59], v149 offset:12288
    v_mfma_f32_16x16x32_bf16 v[44:47], a[68:71], a[44:47], v[44:47]
    ds_read_b128 a[60:63], v149 offset:14336
    ds_read_b128 a[16:19], v153 offset:20480
    v_mfma_f32_16x16x32_bf16 v[48:51], a[64:67], a[48:51], v[48:51]
    s_add_u32 m0, s91, 8192
    v_mfma_f32_16x16x32_bf16 v[52:55], a[68:71], a[48:51], v[52:55]
    ds_read_b128 a[20:23], v153 offset:30720
    v_mfma_f32_16x16x32_bf16 v[56:59], a[64:67], a[52:55], v[56:59]
    ds_read_b128 a[24:27], v153 offset:22528
    buffer_load_dwordx4 v140, s[4:7], s86 offen offset:0 lds
    v_mfma_f32_16x16x32_bf16 v[60:63], a[68:71], a[52:55], v[60:63]
    v_mfma_f32_16x16x32_bf16 v[64:67], a[64:67], a[0:3], v[64:67]
    ds_read_b128 a[28:31], v153 offset:32768
    buffer_load_dwordx4 v141, s[4:7], s86 offen offset:1024 lds
    v_mfma_f32_16x16x32_bf16 v[68:71], a[68:71], a[0:3], v[68:71]
    ds_read_b128 a[32:35], v153 offset:24576
    v_mfma_f32_16x16x32_bf16 v[72:75], a[64:67], a[4:7], v[72:75]
    buffer_load_dwordx4 v142, s[4:7], s86 offen offset:2048 lds
    ds_read_b128 a[36:39], v153 offset:34816
    v_mfma_f32_16x16x32_bf16 v[76:79], a[68:71], a[4:7], v[76:79]
    v_mfma_f32_16x16x32_bf16 v[80:83], a[64:67], a[8:11], v[80:83]
    ds_read_b128 a[40:43], v153 offset:26624
    buffer_load_dwordx4 v143, s[4:7], s86 offen offset:3072 lds
    v_mfma_f32_16x16x32_bf16 v[84:87], a[68:71], a[8:11], v[84:87]
    ds_read_b128 a[44:47], v153 offset:36864
    v_mfma_f32_16x16x32_bf16 v[88:91], a[64:67], a[12:15], v[88:91]
    s_add_u32 m0, s92, 40960
    v_mfma_f32_16x16x32_bf16 v[92:95], a[68:71], a[12:15], v[92:95]
    ds_read_b128 a[48:51], v153 offset:28672
    s_waitcnt lgkmcnt(5)
    v_mfma_f32_16x16x32_bf16 v[16:19], a[56:59], a[16:19], v[16:19]
    ds_read_b128 a[52:55], v153 offset:38912
    buffer_load_dwordx4 v144, s[8:11], s86 offen offset:0 lds
    ds_read_b128 a[64:67], v150 offset:12288
    v_mfma_f32_16x16x32_bf16 v[20:23], a[60:63], a[16:19], v[20:23]
    ds_read_b128 a[68:71], v150 offset:14336
    ds_read_b128 a[0:3], v154 offset:20480
    v_mfma_f32_16x16x32_bf16 v[24:27], a[56:59], a[20:23], v[24:27]
    buffer_load_dwordx4 v145, s[8:11], s86 offen offset:1024 lds
    s_lshl_b32 s79, s73, 7
    v_mfma_f32_16x16x32_bf16 v[28:31], a[60:63], a[20:23], v[28:31]
    ds_read_b128 a[4:7], v154 offset:30720
    s_add_u32 s79, s79, s76
    v_mfma_f32_16x16x32_bf16 v[32:35], a[56:59], a[24:27], v[32:35]
    ds_read_b128 a[8:11], v154 offset:22528
    buffer_load_dwordx4 v146, s[8:11], s86 offen offset:2048 lds
    v_mfma_f32_16x16x32_bf16 v[36:39], a[60:63], a[24:27], v[36:39]
    s_lshl_b32 s79, s79, 2
    s_add_u32 s79, s79, s72
    v_mfma_f32_16x16x32_bf16 v[40:43], a[56:59], a[28:31], v[40:43]
    ds_read_b128 a[12:15], v154 offset:32768
    buffer_load_dwordx4 v147, s[8:11], s86 offen offset:3072 lds
    v_mfma_f32_16x16x32_bf16 v[44:47], a[60:63], a[28:31], v[44:47]
    ds_read_b128 a[16:19], v154 offset:24576
    s_waitcnt lgkmcnt(9)
    v_mfma_f32_16x16x32_bf16 v[48:51], a[56:59], a[32:35], v[48:51]
    s_add_u32 m0, s92, 45056
    ds_read_b128 a[20:23], v154 offset:34816
    ds_read_b128 v[96:99], v11 offset:0
    v_mfma_f32_16x16x32_bf16 v[52:55], a[60:63], a[32:35], v[52:55]
    s_lshl_b32 s79, s79, 7
    s_add_u32 s79, s79, 327680
    v_mfma_f32_16x16x32_bf16 v[56:59], a[56:59], a[36:39], v[56:59]
    ds_read_b128 a[24:27], v154 offset:26624
    ds_read_b128 v[100:103], v11 offset:16
    buffer_load_dwordx4 v148, s[8:11], s86 offen lds
    v_mfma_f32_16x16x32_bf16 v[60:63], a[60:63], a[36:39], v[60:63]
    ds_read_b128 a[28:31], v154 offset:36864
    ds_read_b128 v[104:107], v11 offset:512
    v_mfma_f32_16x16x32_bf16 v[64:67], a[56:59], a[40:43], v[64:67]
    v_mov_b32 v254, s79
    v_mfma_f32_16x16x32_bf16 v[68:71], a[60:63], a[40:43], v[68:71]
    ds_read_b128 a[32:35], v154 offset:28672
    ds_read_b128 v[108:111], v11 offset:528
    v_mfma_f32_16x16x32_bf16 v[72:75], a[56:59], a[44:47], v[72:75]
    ds_read_b128 a[36:39], v154 offset:38912
    ds_read_b128 v[112:115], v11 offset:1024
    v_mfma_f32_16x16x32_bf16 v[76:79], a[60:63], a[44:47], v[76:79]
    ds_read_b128 v[116:119], v11 offset:1040
    s_waitcnt lgkmcnt(14)
    v_mfma_f32_16x16x32_bf16 v[80:83], a[56:59], a[48:51], v[80:83]
    v_mfma_f32_16x16x32_bf16 v[84:87], a[60:63], a[48:51], v[84:87]
    ds_read_b128 v[120:123], v11 offset:1536
    v_mfma_f32_16x16x32_bf16 v[88:91], a[56:59], a[52:55], v[88:91]
    ds_read_b128 v[124:127], v11 offset:1552
    v_mfma_f32_16x16x32_bf16 v[92:95], a[60:63], a[52:55], v[92:95]
    v_mfma_f32_16x16x32_bf16 v[16:19], a[64:67], a[0:3], v[16:19]
    ds_read_b128 v[128:131], v11 offset:2048
    v_mfma_f32_16x16x32_bf16 v[20:23], a[68:71], a[0:3], v[20:23]
    ds_read_b128 v[132:135], v11 offset:2064
    v_mfma_f32_16x16x32_bf16 v[24:27], a[64:67], a[4:7], v[24:27]
    v_mfma_f32_16x16x32_bf16 v[28:31], a[68:71], a[4:7], v[28:31]
    s_waitcnt lgkmcnt(14)
    v_mfma_f32_16x16x32_bf16 v[32:35], a[64:67], a[8:11], v[32:35]
    v_mfma_f32_16x16x32_bf16 v[36:39], a[68:71], a[8:11], v[36:39]
    v_mfma_f32_16x16x32_bf16 v[40:43], a[64:67], a[12:15], v[40:43]
    s_waitcnt lgkmcnt(6)
    s_barrier
    ds_read_b128 a[56:59], v149 offset:0
    v_mfma_f32_16x16x32_bf16 v[44:47], a[68:71], a[12:15], v[44:47]
    ds_read_b128 a[60:63], v149 offset:2048
    ds_read_b128 a[40:43], v151 offset:0
    v_mfma_f32_16x16x32_bf16 v[48:51], a[64:67], a[16:19], v[48:51]
    s_add_u32 m0, s91, 12288
    v_mfma_f32_16x16x32_bf16 v[52:55], a[68:71], a[16:19], v[52:55]
    ds_read_b128 a[44:47], v151 offset:10240
    v_mfma_f32_16x16x32_bf16 v[56:59], a[64:67], a[20:23], v[56:59]
    ds_read_b128 a[48:51], v151 offset:2048
    buffer_load_dwordx4 v140, s[4:7], s87 offen offset:0 lds
    v_mfma_f32_16x16x32_bf16 v[60:63], a[68:71], a[20:23], v[60:63]
    v_mfma_f32_16x16x32_bf16 v[64:67], a[64:67], a[24:27], v[64:67]
    ds_read_b128 a[52:55], v151 offset:12288
    buffer_load_dwordx4 v141, s[4:7], s87 offen offset:1024 lds
    v_mfma_f32_16x16x32_bf16 v[68:71], a[68:71], a[24:27], v[68:71]
    ds_read_b128 a[0:3], v151 offset:4096
    v_mfma_f32_16x16x32_bf16 v[72:75], a[64:67], a[28:31], v[72:75]
    buffer_load_dwordx4 v142, s[4:7], s87 offen offset:2048 lds
    ds_read_b128 a[4:7], v151 offset:14336
    v_mfma_f32_16x16x32_bf16 v[76:79], a[68:71], a[28:31], v[76:79]
    v_mfma_f32_16x16x32_bf16 v[80:83], a[64:67], a[32:35], v[80:83]
    ds_read_b128 a[8:11], v151 offset:6144
    buffer_load_dwordx4 v143, s[4:7], s87 offen offset:3072 lds
    v_mfma_f32_16x16x32_bf16 v[84:87], a[68:71], a[32:35], v[84:87]
    ds_read_b128 a[12:15], v151 offset:16384
    v_mfma_f32_16x16x32_bf16 v[88:91], a[64:67], a[36:39], v[88:91]
    s_add_u32 m0, s92, 61440
    v_mfma_f32_16x16x32_bf16 v[92:95], a[68:71], a[36:39], v[92:95]
    ds_read_b128 a[16:19], v151 offset:8192
    s_waitcnt lgkmcnt(5)
    v_mfma_f32_16x16x32_bf16 v[16:19], a[56:59], a[40:43], v[16:19]
    ds_read_b128 a[20:23], v151 offset:18432
    buffer_load_dwordx4 v144, s[8:11], s87 offen offset:0 lds
    ds_read_b128 a[64:67], v150 offset:0
    v_mfma_f32_16x16x32_bf16 v[20:23], a[60:63], a[40:43], v[20:23]
    ds_read_b128 a[68:71], v150 offset:2048
    ds_read_b128 a[24:27], v152 offset:0
    v_mfma_f32_16x16x32_bf16 v[24:27], a[56:59], a[44:47], v[24:27]
    buffer_load_dwordx4 v145, s[8:11], s87 offen offset:1024 lds
    v_mul_f32 v182, v180, v102
    v_mfma_f32_16x16x32_bf16 v[28:31], a[60:63], a[44:47], v[28:31]
    ds_read_b128 a[28:31], v152 offset:10240
    v_mul_f32 v102, v180, v103
    v_mfma_f32_16x16x32_bf16 v[32:35], a[56:59], a[48:51], v[32:35]
    ds_read_b128 a[32:35], v152 offset:2048
    buffer_load_dwordx4 v146, s[8:11], s87 offen offset:2048 lds
    v_mfma_f32_16x16x32_bf16 v[36:39], a[60:63], a[48:51], v[36:39]
    v_exp_f32 v182, v182
    v_mfma_f32_16x16x32_bf16 v[40:43], a[56:59], a[52:55], v[40:43]
    ds_read_b128 a[36:39], v152 offset:12288
    buffer_load_dwordx4 v147, s[8:11], s87 offen offset:3072 lds
    v_mfma_f32_16x16x32_bf16 v[44:47], a[60:63], a[52:55], v[44:47]
    ds_read_b128 a[40:43], v152 offset:4096
    s_waitcnt lgkmcnt(9)
    v_mfma_f32_16x16x32_bf16 v[48:51], a[56:59], a[0:3], v[48:51]
    s_add_u32 m0, s92, 65536
    ds_read_b128 a[44:47], v152 offset:14336
    v_mfma_f32_16x16x32_bf16 v[52:55], a[60:63], a[0:3], v[52:55]
    v_rndne_f32 v183, v102
    v_sub_f32 v183, v102, v183
    v_mfma_f32_16x16x32_bf16 v[56:59], a[56:59], a[4:7], v[56:59]
    ds_read_b128 a[48:51], v152 offset:6144
    buffer_load_dwordx4 v148, s[8:11], s87 offen lds
    v_mfma_f32_16x16x32_bf16 v[60:63], a[60:63], a[4:7], v[60:63]
    ds_read_b128 a[52:55], v152 offset:16384
    v_mfma_f32_16x16x32_bf16 v[64:67], a[56:59], a[8:11], v[64:67]
    v_cos_f32 v102, v183
    v_mfma_f32_16x16x32_bf16 v[68:71], a[60:63], a[8:11], v[68:71]
    ds_read_b128 a[0:3], v152 offset:8192
    v_mfma_f32_16x16x32_bf16 v[72:75], a[56:59], a[12:15], v[72:75]
    ds_read_b128 a[4:7], v152 offset:18432
    v_mfma_f32_16x16x32_bf16 v[76:79], a[60:63], a[12:15], v[76:79]
    s_waitcnt lgkmcnt(8)
    v_mfma_f32_16x16x32_bf16 v[80:83], a[56:59], a[16:19], v[80:83]
    v_sin_f32 v103, v183
    v_mfma_f32_16x16x32_bf16 v[84:87], a[60:63], a[16:19], v[84:87]
    v_mul_f32 v102, v182, v102
    v_mul_f32 v103, v182, v103
    v_mfma_f32_16x16x32_bf16 v[88:91], a[56:59], a[20:23], v[88:91]
    v_mul_f32 v182, v180, v110
    v_mul_f32 v110, v180, v111
    v_mfma_f32_16x16x32_bf16 v[92:95], a[60:63], a[20:23], v[92:95]
    v_exp_f32 v182, v182
    v_mfma_f32_16x16x32_bf16 v[16:19], a[64:67], a[24:27], v[16:19]
    v_rndne_f32 v183, v110
    v_sub_f32 v183, v110, v183
    v_mfma_f32_16x16x32_bf16 v[20:23], a[68:71], a[24:27], v[20:23]
    v_cos_f32 v110, v183
    v_mfma_f32_16x16x32_bf16 v[24:27], a[64:67], a[28:31], v[24:27]
    v_sin_f32 v111, v183
    v_mfma_f32_16x16x32_bf16 v[28:31], a[68:71], a[28:31], v[28:31]
    v_mul_f32 v110, v182, v110
    s_waitcnt lgkmcnt(4)
    v_mfma_f32_16x16x32_bf16 v[32:35], a[64:67], a[32:35], v[32:35]
    v_mul_f32 v111, v182, v111
    v_mul_f32 v182, v180, v118
    v_mfma_f32_16x16x32_bf16 v[36:39], a[68:71], a[32:35], v[36:39]
    v_mul_f32 v118, v180, v119
    v_mfma_f32_16x16x32_bf16 v[40:43], a[64:67], a[36:39], v[40:43]
    s_waitcnt vmcnt(19) lgkmcnt(0)
    s_barrier
    ds_read_b128 a[56:59], v149 offset:4096
    v_mfma_f32_16x16x32_bf16 v[44:47], a[68:71], a[36:39], v[44:47]
    ds_read_b128 a[60:63], v149 offset:6144
    ds_read_b128 a[8:11], v151 offset:20480
    v_mfma_f32_16x16x32_bf16 v[48:51], a[64:67], a[40:43], v[48:51]
    s_add_u32 m0, s91, 0
    v_mfma_f32_16x16x32_bf16 v[52:55], a[68:71], a[40:43], v[52:55]
    ds_read_b128 a[12:15], v151 offset:30720
    v_mfma_f32_16x16x32_bf16 v[56:59], a[64:67], a[44:47], v[56:59]
    ds_read_b128 a[16:19], v151 offset:22528
    buffer_load_dwordx4 v140, s[4:7], s88 offen offset:0 lds
    v_mfma_f32_16x16x32_bf16 v[60:63], a[68:71], a[44:47], v[60:63]
    v_exp_f32 v182, v182
    v_mfma_f32_16x16x32_bf16 v[64:67], a[64:67], a[48:51], v[64:67]
    ds_read_b128 a[20:23], v151 offset:32768
    buffer_load_dwordx4 v141, s[4:7], s88 offen offset:1024 lds
    v_mfma_f32_16x16x32_bf16 v[68:71], a[68:71], a[48:51], v[68:71]
    ds_read_b128 a[24:27], v151 offset:24576
    v_rndne_f32 v183, v118
    v_mfma_f32_16x16x32_bf16 v[72:75], a[64:67], a[52:55], v[72:75]
    buffer_load_dwordx4 v142, s[4:7], s88 offen offset:2048 lds
    ds_read_b128 a[28:31], v151 offset:34816
    v_mfma_f32_16x16x32_bf16 v[76:79], a[68:71], a[52:55], v[76:79]
    v_sub_f32 v183, v118, v183
    v_mfma_f32_16x16x32_bf16 v[80:83], a[64:67], a[0:3], v[80:83]
    ds_read_b128 a[32:35], v151 offset:26624
    buffer_load_dwordx4 v143, s[4:7], s88 offen offset:3072 lds
    v_mfma_f32_16x16x32_bf16 v[84:87], a[68:71], a[0:3], v[84:87]
    ds_read_b128 a[36:39], v151 offset:36864
    v_mfma_f32_16x16x32_bf16 v[88:91], a[64:67], a[4:7], v[88:91]
    s_add_u32 m0, s92, 0
    v_mfma_f32_16x16x32_bf16 v[92:95], a[68:71], a[4:7], v[92:95]
    ds_read_b128 a[40:43], v151 offset:28672
    s_waitcnt lgkmcnt(5)
    v_mfma_f32_16x16x32_bf16 v[16:19], a[56:59], a[8:11], v[16:19]
    ds_read_b128 a[44:47], v151 offset:38912
    buffer_load_dwordx4 v144, s[8:11], s88 offen offset:0 lds
    ds_read_b128 a[64:67], v150 offset:4096
    v_mfma_f32_16x16x32_bf16 v[20:23], a[60:63], a[8:11], v[20:23]
    ds_read_b128 a[68:71], v150 offset:6144
    ds_read_b128 a[48:51], v152 offset:20480
    v_mfma_f32_16x16x32_bf16 v[24:27], a[56:59], a[12:15], v[24:27]
    buffer_load_dwordx4 v145, s[8:11], s88 offen offset:1024 lds
    v_mfma_f32_16x16x32_bf16 v[28:31], a[60:63], a[12:15], v[28:31]
    ds_read_b128 a[52:55], v152 offset:30720
    v_mfma_f32_16x16x32_bf16 v[32:35], a[56:59], a[16:19], v[32:35]
    ds_read_b128 a[0:3], v152 offset:22528
    buffer_load_dwordx4 v146, s[8:11], s88 offen offset:2048 lds
    v_mfma_f32_16x16x32_bf16 v[36:39], a[60:63], a[16:19], v[36:39]
    v_cos_f32 v118, v183
    v_mfma_f32_16x16x32_bf16 v[40:43], a[56:59], a[20:23], v[40:43]
    ds_read_b128 a[4:7], v152 offset:32768
    buffer_load_dwordx4 v147, s[8:11], s88 offen offset:3072 lds
    v_mfma_f32_16x16x32_bf16 v[44:47], a[60:63], a[20:23], v[44:47]
    ds_read_b128 a[8:11], v152 offset:24576
    s_waitcnt lgkmcnt(9)
    v_mfma_f32_16x16x32_bf16 v[48:51], a[56:59], a[24:27], v[48:51]
    s_add_u32 m0, s92, 4096
    ds_read_b128 a[12:15], v152 offset:34816
    v_mfma_f32_16x16x32_bf16 v[52:55], a[60:63], a[24:27], v[52:55]
    v_sin_f32 v119, v183
    v_mfma_f32_16x16x32_bf16 v[56:59], a[56:59], a[28:31], v[56:59]
    ds_read_b128 a[16:19], v152 offset:26624
    buffer_load_dwordx4 v148, s[8:11], s88 offen lds
    v_mfma_f32_16x16x32_bf16 v[60:63], a[60:63], a[28:31], v[60:63]
    ds_read_b128 a[20:23], v152 offset:36864
    v_mul_f32 v118, v182, v118
    v_mfma_f32_16x16x32_bf16 v[64:67], a[56:59], a[32:35], v[64:67]
    v_mul_f32 v119, v182, v119
    v_mul_f32 v182, v180, v126
    v_mfma_f32_16x16x32_bf16 v[68:71], a[60:63], a[32:35], v[68:71]
    ds_read_b128 a[24:27], v152 offset:28672
    v_mul_f32 v126, v180, v127
    v_mfma_f32_16x16x32_bf16 v[72:75], a[56:59], a[36:39], v[72:75]
    ds_read_b128 a[28:31], v152 offset:38912
    v_mfma_f32_16x16x32_bf16 v[76:79], a[60:63], a[36:39], v[76:79]
    s_waitcnt lgkmcnt(8)
    v_mfma_f32_16x16x32_bf16 v[80:83], a[56:59], a[40:43], v[80:83]
    v_exp_f32 v182, v182
    v_mfma_f32_16x16x32_bf16 v[84:87], a[60:63], a[40:43], v[84:87]
    v_rndne_f32 v183, v126
    v_sub_f32 v183, v126, v183
    v_mfma_f32_16x16x32_bf16 v[88:91], a[56:59], a[44:47], v[88:91]
    v_cos_f32 v126, v183
    v_mfma_f32_16x16x32_bf16 v[92:95], a[60:63], a[44:47], v[92:95]
    v_sin_f32 v127, v183
    v_mfma_f32_16x16x32_bf16 v[16:19], a[64:67], a[48:51], v[16:19]
    v_mul_f32 v126, v182, v126
    v_mul_f32 v127, v182, v127
    v_mfma_f32_16x16x32_bf16 v[20:23], a[68:71], a[48:51], v[20:23]
    v_mul_f32 v182, v180, v134
    v_mul_f32 v134, v180, v135
    v_mfma_f32_16x16x32_bf16 v[24:27], a[64:67], a[52:55], v[24:27]
    v_exp_f32 v182, v182
    v_mfma_f32_16x16x32_bf16 v[28:31], a[68:71], a[52:55], v[28:31]
    v_rndne_f32 v183, v134
    s_waitcnt lgkmcnt(4)
    v_mfma_f32_16x16x32_bf16 v[32:35], a[64:67], a[0:3], v[32:35]
    v_sub_f32 v183, v134, v183
    v_mfma_f32_16x16x32_bf16 v[36:39], a[68:71], a[0:3], v[36:39]
    v_cos_f32 v134, v183
    v_mfma_f32_16x16x32_bf16 v[40:43], a[64:67], a[4:7], v[40:43]
    s_waitcnt vmcnt(18) lgkmcnt(0)
    s_barrier
    ds_read_b128 a[56:59], v149 offset:8192
    v_mfma_f32_16x16x32_bf16 v[44:47], a[68:71], a[4:7], v[44:47]
    ds_read_b128 a[60:63], v149 offset:10240
    ds_read_b128 a[32:35], v153 offset:0
    v_mfma_f32_16x16x32_bf16 v[48:51], a[64:67], a[8:11], v[48:51]
    s_add_u32 m0, s91, 4096
    v_mfma_f32_16x16x32_bf16 v[52:55], a[68:71], a[8:11], v[52:55]
    ds_read_b128 a[36:39], v153 offset:10240
    v_mfma_f32_16x16x32_bf16 v[56:59], a[64:67], a[12:15], v[56:59]
    ds_read_b128 a[40:43], v153 offset:2048
    buffer_load_dwordx4 v140, s[4:7], s89 offen offset:0 lds
    v_mfma_f32_16x16x32_bf16 v[60:63], a[68:71], a[12:15], v[60:63]
    v_sin_f32 v135, v183
    v_mfma_f32_16x16x32_bf16 v[64:67], a[64:67], a[16:19], v[64:67]
    ds_read_b128 a[44:47], v153 offset:12288
    buffer_load_dwordx4 v141, s[4:7], s89 offen offset:1024 lds
    v_mfma_f32_16x16x32_bf16 v[68:71], a[68:71], a[16:19], v[68:71]
    ds_read_b128 a[48:51], v153 offset:4096
    v_mul_f32 v134, v182, v134
    v_mfma_f32_16x16x32_bf16 v[72:75], a[64:67], a[20:23], v[72:75]
    buffer_load_dwordx4 v142, s[4:7], s89 offen offset:2048 lds
    ds_read_b128 a[52:55], v153 offset:14336
    v_mfma_f32_16x16x32_bf16 v[76:79], a[68:71], a[20:23], v[76:79]
    v_mul_f32 v135, v182, v135
    v_mfma_f32_16x16x32_bf16 v[80:83], a[64:67], a[24:27], v[80:83]
    ds_read_b128 a[0:3], v153 offset:6144
    buffer_load_dwordx4 v143, s[4:7], s89 offen offset:3072 lds
    v_mfma_f32_16x16x32_bf16 v[84:87], a[68:71], a[24:27], v[84:87]
    ds_read_b128 a[4:7], v153 offset:16384
    v_mfma_f32_16x16x32_bf16 v[88:91], a[64:67], a[28:31], v[88:91]
    s_add_u32 m0, s92, 20480
    v_mfma_f32_16x16x32_bf16 v[92:95], a[68:71], a[28:31], v[92:95]
    ds_read_b128 a[8:11], v153 offset:8192
    s_waitcnt lgkmcnt(5)
    v_mfma_f32_16x16x32_bf16 v[16:19], a[56:59], a[32:35], v[16:19]
    ds_read_b128 a[12:15], v153 offset:18432
    buffer_load_dwordx4 v144, s[8:11], s89 offen offset:0 lds
    ds_read_b128 a[64:67], v150 offset:8192
    v_mfma_f32_16x16x32_bf16 v[20:23], a[60:63], a[32:35], v[20:23]
    ds_read_b128 a[68:71], v150 offset:10240
    ds_read_b128 a[16:19], v154 offset:0
    v_mfma_f32_16x16x32_bf16 v[24:27], a[56:59], a[36:39], v[24:27]
    buffer_load_dwordx4 v145, s[8:11], s89 offen offset:1024 lds
    v_mfma_f32_16x16x32_bf16 v[28:31], a[60:63], a[36:39], v[28:31]
    ds_read_b128 a[20:23], v154 offset:10240
    v_mfma_f32_16x16x32_bf16 v[32:35], a[56:59], a[40:43], v[32:35]
    ds_read_b128 a[24:27], v154 offset:2048
    buffer_load_dwordx4 v146, s[8:11], s89 offen offset:2048 lds
    v_mfma_f32_16x16x32_bf16 v[36:39], a[60:63], a[40:43], v[36:39]
    v_mfma_f32_16x16x32_bf16 v[40:43], a[56:59], a[44:47], v[40:43]
    ds_read_b128 a[28:31], v154 offset:12288
    buffer_load_dwordx4 v147, s[8:11], s89 offen offset:3072 lds
    v_mfma_f32_16x16x32_bf16 v[44:47], a[60:63], a[44:47], v[44:47]
    ds_read_b128 a[32:35], v154 offset:4096
    s_waitcnt lgkmcnt(9)
    v_mfma_f32_16x16x32_bf16 v[48:51], a[56:59], a[48:51], v[48:51]
    s_add_u32 m0, s92, 24576
    ds_read_b128 a[36:39], v154 offset:14336
    v_mfma_f32_16x16x32_bf16 v[52:55], a[60:63], a[48:51], v[52:55]
    s_lshl_b32 s101, s74, 3
    s_add_u32 s101, s101, s72
    v_mfma_f32_16x16x32_bf16 v[56:59], a[56:59], a[52:55], v[56:59]
    ds_read_b128 a[40:43], v154 offset:6144
    buffer_load_dwordx4 v148, s[8:11], s89 offen lds
    v_mfma_f32_16x16x32_bf16 v[60:63], a[60:63], a[52:55], v[60:63]
    ds_read_b128 a[44:47], v154 offset:16384
    s_lshl_b32 s101, s101, 4
    v_mfma_f32_16x16x32_bf16 v[64:67], a[56:59], a[0:3], v[64:67]
    s_mul_i32 s99, s75, 160
    s_mov_b32 s98, 81920
    v_mfma_f32_16x16x32_bf16 v[68:71], a[60:63], a[0:3], v[68:71]
    ds_read_b128 a[48:51], v154 offset:8192
    v_add_u32 v185, 0, v1
    v_mfma_f32_16x16x32_bf16 v[72:75], a[56:59], a[4:7], v[72:75]
    ds_read_b128 a[52:55], v154 offset:18432
    v_mfma_f32_16x16x32_bf16 v[76:79], a[60:63], a[4:7], v[76:79]
    s_waitcnt lgkmcnt(8)
    v_mfma_f32_16x16x32_bf16 v[80:83], a[56:59], a[8:11], v[80:83]
    v_mul_u32_u24 v186, 3277, v185
    v_mfma_f32_16x16x32_bf16 v[84:87], a[60:63], a[8:11], v[84:87]
    v_lshrrev_b32 v186, 16, v186
    v_mul_u32_u24 v187, 20, v186
    v_mfma_f32_16x16x32_bf16 v[88:91], a[56:59], a[12:15], v[88:91]
    v_sub_u32 v187, v185, v187
    v_add_u32 v186, s101, v186
    v_mfma_f32_16x16x32_bf16 v[92:95], a[60:63], a[12:15], v[92:95]
    buffer_load_dword v13, v159, s[12:15], 0 offen sc1
    v_mfma_f32_16x16x32_bf16 v[16:19], a[64:67], a[16:19], v[16:19]
    v_lshl_add_u32 v187, v187, 3, s99
    v_mfma_f32_16x16x32_bf16 v[20:23], a[68:71], a[16:19], v[20:23]
    v_min_u32 v157, 9, v1
    v_lshlrev_b32 v157, 7, v157
    v_mfma_f32_16x16x32_bf16 v[24:27], a[64:67], a[20:23], v[24:27]
    v_mul_u32_u24 v185, 1280, v186
    v_mfma_f32_16x16x32_bf16 v[28:31], a[68:71], a[20:23], v[28:31]
    global_load_dword v158, v157, s[64:65]
    s_waitcnt lgkmcnt(4)
    v_mfma_f32_16x16x32_bf16 v[32:35], a[64:67], a[24:27], v[32:35]
    v_add_u32 v185, v185, v187
    global_load_dwordx2 v[242:243], v187, s[56:57]
    v_mfma_f32_16x16x32_bf16 v[36:39], a[68:71], a[24:27], v[36:39]
    buffer_load_dwordx2 v[222:223], v185, s[4:7], 0 offen
    buffer_load_dwordx2 v[232:233], v185, s[4:7], s98 offen
    v_mfma_f32_16x16x32_bf16 v[40:43], a[64:67], a[28:31], v[40:43]
    s_waitcnt vmcnt(23)
    s_barrier
    ds_read_b128 a[56:59], v149 offset:12288
    v_mfma_f32_16x16x32_bf16 v[44:47], a[68:71], a[28:31], v[44:47]
    ds_read_b128 a[60:63], v149 offset:14336
    ds_read_b128 a[0:3], v153 offset:20480
    v_mfma_f32_16x16x32_bf16 v[48:51], a[64:67], a[32:35], v[48:51]
    v_add_u32 v185, 64, v1
    v_mfma_f32_16x16x32_bf16 v[52:55], a[68:71], a[32:35], v[52:55]
    ds_read_b128 a[4:7], v153 offset:30720
    v_mfma_f32_16x16x32_bf16 v[56:59], a[64:67], a[36:39], v[56:59]
    ds_read_b128 a[8:11], v153 offset:22528
    v_mfma_f32_16x16x32_bf16 v[60:63], a[68:71], a[36:39], v[60:63]
    s_waitcnt lgkmcnt(5)
    v_mfma_f32_16x16x32_bf16 v[64:67], a[64:67], a[40:43], v[64:67]
    ds_read_b128 a[12:15], v153 offset:32768
    v_mfma_f32_16x16x32_bf16 v[68:71], a[68:71], a[40:43], v[68:71]
    ds_read_b128 a[16:19], v153 offset:24576
    v_mfma_f32_16x16x32_bf16 v[72:75], a[64:67], a[44:47], v[72:75]
    ds_read_b128 a[20:23], v153 offset:34816
    v_mfma_f32_16x16x32_bf16 v[76:79], a[68:71], a[44:47], v[76:79]
    v_mul_u32_u24 v186, 3277, v185
    v_mfma_f32_16x16x32_bf16 v[80:83], a[64:67], a[48:51], v[80:83]
    ds_read_b128 a[24:27], v153 offset:26624
    v_lshrrev_b32 v186, 16, v186
    v_mfma_f32_16x16x32_bf16 v[84:87], a[68:71], a[48:51], v[84:87]
    ds_read_b128 a[28:31], v153 offset:36864
    v_mul_u32_u24 v187, 20, v186
    v_mfma_f32_16x16x32_bf16 v[88:91], a[64:67], a[52:55], v[88:91]
    v_sub_u32 v187, v185, v187
    v_add_u32 v186, s101, v186
    v_mfma_f32_16x16x32_bf16 v[92:95], a[68:71], a[52:55], v[92:95]
    ds_read_b128 a[32:35], v153 offset:28672
    s_waitcnt lgkmcnt(5)
    v_mfma_f32_16x16x32_bf16 v[16:19], a[56:59], a[0:3], v[16:19]
    ds_read_b128 a[36:39], v153 offset:38912
    ds_read_b128 a[64:67], v150 offset:12288
    v_mfma_f32_16x16x32_bf16 v[20:23], a[60:63], a[0:3], v[20:23]
    ds_read_b128 a[68:71], v150 offset:14336
    ds_read_b128 a[40:43], v154 offset:20480
    v_mfma_f32_16x16x32_bf16 v[24:27], a[56:59], a[4:7], v[24:27]
    v_lshl_add_u32 v187, v187, 3, s99
    v_mfma_f32_16x16x32_bf16 v[28:31], a[60:63], a[4:7], v[28:31]
    ds_read_b128 a[44:47], v154 offset:30720
    v_mfma_f32_16x16x32_bf16 v[32:35], a[56:59], a[8:11], v[32:35]
    ds_read_b128 a[48:51], v154 offset:22528
    v_mfma_f32_16x16x32_bf16 v[36:39], a[60:63], a[8:11], v[36:39]
    v_mul_u32_u24 v185, 1280, v186
    v_mfma_f32_16x16x32_bf16 v[40:43], a[56:59], a[12:15], v[40:43]
    ds_read_b128 a[52:55], v154 offset:32768
    v_add_u32 v185, v185, v187
    v_mfma_f32_16x16x32_bf16 v[44:47], a[60:63], a[12:15], v[44:47]
    ds_read_b128 a[0:3], v154 offset:24576
    s_waitcnt lgkmcnt(9)
    v_mfma_f32_16x16x32_bf16 v[48:51], a[56:59], a[16:19], v[48:51]
    ds_read_b128 a[4:7], v154 offset:34816
    global_load_dwordx2 v[244:245], v187, s[56:57]
    v_mfma_f32_16x16x32_bf16 v[52:55], a[60:63], a[16:19], v[52:55]
    buffer_load_dwordx2 v[224:225], v185, s[4:7], 0 offen
    buffer_load_dwordx2 v[234:235], v185, s[4:7], s98 offen
    v_mfma_f32_16x16x32_bf16 v[56:59], a[56:59], a[20:23], v[56:59]
    ds_read_b128 a[8:11], v154 offset:26624
    v_mfma_f32_16x16x32_bf16 v[60:63], a[60:63], a[20:23], v[60:63]
    ds_read_b128 a[12:15], v154 offset:36864
    v_mfma_f32_16x16x32_bf16 v[64:67], a[56:59], a[24:27], v[64:67]
    v_add_u32 v185, 128, v1
    v_mfma_f32_16x16x32_bf16 v[68:71], a[60:63], a[24:27], v[68:71]
    ds_read_b128 a[16:19], v154 offset:28672
    v_mfma_f32_16x16x32_bf16 v[72:75], a[56:59], a[28:31], v[72:75]
    ds_read_b128 a[20:23], v154 offset:38912
    v_mfma_f32_16x16x32_bf16 v[76:79], a[60:63], a[28:31], v[76:79]
    s_waitcnt lgkmcnt(8)
    v_mfma_f32_16x16x32_bf16 v[80:83], a[56:59], a[32:35], v[80:83]
    v_mul_u32_u24 v186, 3277, v185
    v_mfma_f32_16x16x32_bf16 v[84:87], a[60:63], a[32:35], v[84:87]
    v_lshrrev_b32 v186, 16, v186
    v_mul_u32_u24 v187, 20, v186
    v_mfma_f32_16x16x32_bf16 v[88:91], a[56:59], a[36:39], v[88:91]
    v_sub_u32 v187, v185, v187
    v_add_u32 v186, s101, v186
    v_mfma_f32_16x16x32_bf16 v[92:95], a[60:63], a[36:39], v[92:95]
    s_waitcnt vmcnt(7)
    v_cmp_ne_u32 vcc, s78, v13
    s_nop 0
    s_cmp_eq_u64 vcc, 0
    s_cbranch_scc0 L_pk_retry_15
L_pk_ok_16:
    v_mfma_f32_16x16x32_bf16 v[16:19], a[64:67], a[40:43], v[16:19]
    v_lshl_add_u32 v187, v187, 3, s99
    v_mfma_f32_16x16x32_bf16 v[20:23], a[68:71], a[40:43], v[20:23]
    buffer_load_dwordx4 a[160:163], v2, s[32:35], s40 offen offset:0 sc1
    v_mfma_f32_16x16x32_bf16 v[24:27], a[64:67], a[44:47], v[24:27]
    v_mul_u32_u24 v185, 1280, v186
    v_mfma_f32_16x16x32_bf16 v[28:31], a[68:71], a[44:47], v[28:31]
    v_add_u32 v185, v185, v187
    s_waitcnt lgkmcnt(4)
    v_mfma_f32_16x16x32_bf16 v[32:35], a[64:67], a[48:51], v[32:35]
    buffer_load_dwordx4 a[164:167], v2, s[32:35], s40 offen offset:1024 sc1
    global_load_dwordx2 v[246:247], v187, s[56:57]
    v_mfma_f32_16x16x32_bf16 v[36:39], a[68:71], a[48:51], v[36:39]
    buffer_load_dwordx2 v[226:227], v185, s[4:7], 0 offen
    buffer_load_dwordx2 v[236:237], v185, s[4:7], s98 offen
    v_mfma_f32_16x16x32_bf16 v[40:43], a[64:67], a[52:55], v[40:43]
    s_barrier
    ds_read_b128 a[56:59], v149 offset:0
    v_mfma_f32_16x16x32_bf16 v[44:47], a[68:71], a[52:55], v[44:47]
    ds_read_b128 a[60:63], v149 offset:2048
    ds_read_b128 a[24:27], v151 offset:0
    v_mfma_f32_16x16x32_bf16 v[48:51], a[64:67], a[0:3], v[48:51]
    buffer_load_dwordx4 a[168:171], v2, s[32:35], s40 offen offset:2048 sc1
    v_mfma_f32_16x16x32_bf16 v[52:55], a[68:71], a[0:3], v[52:55]
    ds_read_b128 a[28:31], v151 offset:10240
    v_mfma_f32_16x16x32_bf16 v[56:59], a[64:67], a[4:7], v[56:59]
    ds_read_b128 a[32:35], v151 offset:2048
    v_mfma_f32_16x16x32_bf16 v[60:63], a[68:71], a[4:7], v[60:63]
    buffer_load_dwordx4 a[172:175], v2, s[32:35], s40 offen offset:3072 sc1
    s_waitcnt lgkmcnt(5)
    v_mfma_f32_16x16x32_bf16 v[64:67], a[64:67], a[8:11], v[64:67]
    ds_read_b128 a[36:39], v151 offset:12288
    v_mfma_f32_16x16x32_bf16 v[68:71], a[68:71], a[8:11], v[68:71]
    ds_read_b128 a[40:43], v151 offset:4096
    v_mfma_f32_16x16x32_bf16 v[72:75], a[64:67], a[12:15], v[72:75]
    ds_read_b128 a[44:47], v151 offset:14336
    buffer_load_dwordx4 a[176:179], v3, s[32:35], s40 offen offset:0 sc1
    v_mfma_f32_16x16x32_bf16 v[76:79], a[68:71], a[12:15], v[76:79]
    v_add_u32 v185, 192, v1
    v_mfma_f32_16x16x32_bf16 v[80:83], a[64:67], a[16:19], v[80:83]
    ds_read_b128 a[48:51], v151 offset:6144
    v_mfma_f32_16x16x32_bf16 v[84:87], a[68:71], a[16:19], v[84:87]
    ds_read_b128 a[52:55], v151 offset:16384
    buffer_load_dwordx4 a[180:183], v2, s[32:35], s41 offen offset:0 sc1
    v_mfma_f32_16x16x32_bf16 v[88:91], a[64:67], a[20:23], v[88:91]
    v_mul_u32_u24 v186, 3277, v185
    v_mfma_f32_16x16x32_bf16 v[92:95], a[68:71], a[20:23], v[92:95]
    ds_read_b128 a[0:3], v151 offset:8192
    s_waitcnt lgkmcnt(5)
    v_mfma_f32_16x16x32_bf16 v[16:19], a[56:59], a[24:27], v[16:19]
    ds_read_b128 a[4:7], v151 offset:18432
    ds_read_b128 a[64:67], v150 offset:0
    v_mfma_f32_16x16x32_bf16 v[20:23], a[60:63], a[24:27], v[20:23]
    ds_read_b128 a[68:71], v150 offset:2048
    ds_read_b128 a[8:11], v152 offset:0
    v_lshrrev_b32 v186, 16, v186
    v_mfma_f32_16x16x32_bf16 v[24:27], a[56:59], a[28:31], v[24:27]
    buffer_load_dwordx4 a[184:187], v2, s[32:35], s41 offen offset:1024 sc1
    v_mul_u32_u24 v187, 20, v186
    v_mfma_f32_16x16x32_bf16 v[28:31], a[60:63], a[28:31], v[28:31]
    ds_read_b128 a[12:15], v152 offset:10240
    v_sub_u32 v187, v185, v187
    v_mfma_f32_16x16x32_bf16 v[32:35], a[56:59], a[32:35], v[32:35]
    ds_read_b128 a[16:19], v152 offset:2048
    buffer_load_dwordx4 a[188:191], v2, s[32:35], s41 offen offset:2048 sc1
    v_mfma_f32_16x16x32_bf16 v[36:39], a[60:63], a[32:35], v[36:39]
    v_add_u32 v186, s101, v186
    v_mfma_f32_16x16x32_bf16 v[40:43], a[56:59], a[36:39], v[40:43]
    ds_read_b128 a[20:23], v152 offset:12288
    v_mfma_f32_16x16x32_bf16 v[44:47], a[60:63], a[36:39], v[44:47]
    ds_read_b128 a[24:27], v152 offset:4096
    v_lshl_add_u32 v187, v187, 3, s99
    s_waitcnt lgkmcnt(9)
    v_mfma_f32_16x16x32_bf16 v[48:51], a[56:59], a[40:43], v[48:51]
    ds_read_b128 a[28:31], v152 offset:14336
    buffer_load_dwordx4 a[192:195], v2, s[32:35], s41 offen offset:3072 sc1
    v_mfma_f32_16x16x32_bf16 v[52:55], a[60:63], a[40:43], v[52:55]
    v_mul_u32_u24 v185, 1280, v186
    v_mfma_f32_16x16x32_bf16 v[56:59], a[56:59], a[44:47], v[56:59]
    ds_read_b128 a[32:35], v152 offset:6144
    v_add_u32 v185, v185, v187
    v_mfma_f32_16x16x32_bf16 v[60:63], a[60:63], a[44:47], v[60:63]
    ds_read_b128 a[36:39], v152 offset:16384
    buffer_load_dwordx4 a[196:199], v3, s[32:35], s41 offen offset:0 sc1
    v_mfma_f32_16x16x32_bf16 v[64:67], a[56:59], a[48:51], v[64:67]
    global_load_dwordx2 v[248:249], v187, s[56:57]
    buffer_load_dwordx2 v[228:229], v185, s[4:7], 0 offen
    v_mfma_f32_16x16x32_bf16 v[68:71], a[60:63], a[48:51], v[68:71]
    ds_read_b128 a[40:43], v152 offset:8192
    buffer_load_dwordx2 v[238:239], v185, s[4:7], s98 offen
    v_mfma_f32_16x16x32_bf16 v[72:75], a[56:59], a[52:55], v[72:75]
    ds_read_b128 a[44:47], v152 offset:18432
    buffer_load_dwordx4 a[200:203], v2, s[32:35], s46 offen offset:0 sc1
    v_mfma_f32_16x16x32_bf16 v[76:79], a[60:63], a[52:55], v[76:79]
    s_waitcnt lgkmcnt(8)
    v_mfma_f32_16x16x32_bf16 v[80:83], a[56:59], a[0:3], v[80:83]
    v_add_u32 v185, 256, v1
    v_mfma_f32_16x16x32_bf16 v[84:87], a[60:63], a[0:3], v[84:87]
    buffer_load_dwordx4 a[204:207], v2, s[32:35], s46 offen offset:1024 sc1
    v_mfma_f32_16x16x32_bf16 v[88:91], a[56:59], a[4:7], v[88:91]
    v_mul_u32_u24 v186, 3277, v185
    v_mfma_f32_16x16x32_bf16 v[92:95], a[60:63], a[4:7], v[92:95]
    v_lshrrev_b32 v186, 16, v186
    v_mul_u32_u24 v187, 20, v186
    v_mfma_f32_16x16x32_bf16 v[16:19], a[64:67], a[8:11], v[16:19]
    buffer_load_dwordx4 a[208:211], v2, s[32:35], s46 offen offset:2048 sc1
    v_sub_u32 v187, v185, v187
    v_mfma_f32_16x16x32_bf16 v[20:23], a[68:71], a[8:11], v[20:23]
    v_add_u32 v186, s101, v186
    v_mfma_f32_16x16x32_bf16 v[24:27], a[64:67], a[12:15], v[24:27]
    v_lshl_add_u32 v187, v187, 3, s99
    v_mfma_f32_16x16x32_bf16 v[28:31], a[68:71], a[12:15], v[28:31]
    s_waitcnt lgkmcnt(4)
    v_mfma_f32_16x16x32_bf16 v[32:35], a[64:67], a[16:19], v[32:35]
    buffer_load_dwordx4 a[212:215], v2, s[32:35], s46 offen offset:3072 sc1
    v_mfma_f32_16x16x32_bf16 v[36:39], a[68:71], a[16:19], v[36:39]
    v_mul_u32_u24 v185, 1280, v186
    v_mfma_f32_16x16x32_bf16 v[40:43], a[64:67], a[20:23], v[40:43]
    s_barrier
    ds_read_b128 a[56:59], v149 offset:4096
    v_mfma_f32_16x16x32_bf16 v[44:47], a[68:71], a[20:23], v[44:47]
    ds_read_b128 a[60:63], v149 offset:6144
    ds_read_b128 a[48:51], v151 offset:20480
    v_mfma_f32_16x16x32_bf16 v[48:51], a[64:67], a[24:27], v[48:51]
    buffer_load_dwordx4 a[216:219], v3, s[32:35], s46 offen offset:0 sc1
    v_add_u32 v185, v185, v187
    v_mfma_f32_16x16x32_bf16 v[52:55], a[68:71], a[24:27], v[52:55]
    ds_read_b128 a[52:55], v151 offset:30720
    global_load_dwordx2 v[250:251], v187, s[56:57]
    buffer_load_dwordx2 v[230:231], v185, s[4:7], 0 offen
    buffer_load_dwordx2 v[240:241], v185, s[4:7], s98 offen
    v_mfma_f32_16x16x32_bf16 v[56:59], a[64:67], a[28:31], v[56:59]
    ds_read_b128 a[0:3], v151 offset:22528
    buffer_load_dwordx4 a[220:223], v2, s[32:35], s47 offen offset:0 sc1
    v_mfma_f32_16x16x32_bf16 v[60:63], a[68:71], a[28:31], v[60:63]
    v_lshlrev_b32 v155, 3, v155
    s_waitcnt lgkmcnt(5)
    v_mfma_f32_16x16x32_bf16 v[64:67], a[64:67], a[32:35], v[64:67]
    ds_read_b128 a[4:7], v151 offset:32768
    v_mfma_f32_16x16x32_bf16 v[68:71], a[68:71], a[32:35], v[68:71]
    ds_read_b128 a[8:11], v151 offset:24576
    buffer_load_dwordx4 a[224:227], v2, s[32:35], s47 offen offset:1024 sc1
    v_mfma_f32_16x16x32_bf16 v[72:75], a[64:67], a[36:39], v[72:75]
    ds_read_b128 a[12:15], v151 offset:34816
    v_mul_u32_u24 v13, 640, v216
    v_mfma_f32_16x16x32_bf16 v[76:79], a[68:71], a[36:39], v[76:79]
    v_add_u32 v155, v155, v13
    v_add_u32 v155, 158976, v155
    v_mfma_f32_16x16x32_bf16 v[80:83], a[64:67], a[40:43], v[80:83]
    ds_read_b128 a[16:19], v151 offset:26624
    v_mov_b32 v13, 136
    v_mfma_f32_16x16x32_bf16 v[84:87], a[68:71], a[40:43], v[84:87]
    ds_read_b128 a[20:23], v151 offset:36864
    buffer_load_dwordx4 a[228:231], v2, s[32:35], s47 offen offset:2048 sc1
    v_cmp_gt_u32 vcc, 16, v0
    s_nop 1
    v_cndmask_b32 v13, 0, v13, vcc
    v_mfma_f32_16x16x32_bf16 v[88:91], a[64:67], a[44:47], v[88:91]
    v_add3_u32 v13, v13, v6, -8
    v_mfma_f32_16x16x32_bf16 v[92:95], a[68:71], a[44:47], v[92:95]
    ds_read_b128 a[24:27], v151 offset:28672
    v_mul_u32_u24 v216, 5, v216
    s_waitcnt lgkmcnt(5)
    v_mfma_f32_16x16x32_bf16 v[16:19], a[56:59], a[48:51], v[16:19]
    ds_read_b128 a[28:31], v151 offset:38912
    ds_read_b128 a[64:67], v150 offset:4096
    v_sub_u32 v216, s74, v216
    v_cmp_gt_u32 vcc, 60, v1
    s_nop 1
    v_cndmask_b32 v216, 0, v216, vcc
    v_mfma_f32_16x16x32_bf16 v[20:23], a[60:63], a[48:51], v[20:23]
    ds_read_b128 a[68:71], v150 offset:6144
    ds_read_b128 a[32:35], v152 offset:20480
    v_mfma_f32_16x16x32_bf16 v[24:27], a[56:59], a[52:55], v[24:27]
    buffer_load_dwordx4 a[232:235], v2, s[32:35], s47 offen offset:3072 sc1
    v_mul_i32_i24 v185, 1536, v216
    v_add_u32 v185, v185, v9
    v_mfma_f32_16x16x32_bf16 v[28:31], a[60:63], a[52:55], v[28:31]
    ds_read_b128 a[36:39], v152 offset:30720
    buffer_load_dwordx4 a[236:239], v3, s[32:35], s47 offen offset:0 sc1
    v_mov_b32 v186, 0x7f000000
    v_mfma_f32_16x16x32_bf16 v[32:35], a[56:59], a[0:3], v[32:35]
    ds_read_b128 a[40:43], v152 offset:22528
    v_subrev_u32 v140, 1536, v185
    v_cmp_lt_i32 vcc, 0, v216
    s_nop 1
    v_cndmask_b32 v140, v186, v140, vcc
    v_cndmask_b32 v145, 0, v253, vcc
    v_mfma_f32_16x16x32_bf16 v[36:39], a[60:63], a[0:3], v[36:39]
    v_subrev_u32 v141, 3072, v185
    v_mfma_f32_16x16x32_bf16 v[40:43], a[56:59], a[4:7], v[40:43]
    ds_read_b128 a[44:47], v152 offset:32768
    buffer_load_dwordx4 a[80:83], v2, s[32:35], s48 offen offset:0 sc1
    v_mfma_f32_16x16x32_bf16 v[44:47], a[60:63], a[4:7], v[44:47]
    ds_read_b128 a[48:51], v152 offset:24576
    v_cmp_lt_i32 vcc, 1, v216
    s_nop 1
    v_cndmask_b32 v141, v186, v141, vcc
    v_cndmask_b32 v146, 0, v253, vcc
    s_waitcnt lgkmcnt(9)
    v_mfma_f32_16x16x32_bf16 v[48:51], a[56:59], a[8:11], v[48:51]
    ds_read_b128 a[52:55], v152 offset:34816
    v_mfma_f32_16x16x32_bf16 v[52:55], a[60:63], a[8:11], v[52:55]
    v_subrev_u32 v142, 4608, v185
    v_mfma_f32_16x16x32_bf16 v[56:59], a[56:59], a[12:15], v[56:59]
    ds_read_b128 a[0:3], v152 offset:26624
    buffer_load_dwordx4 a[84:87], v2, s[32:35], s48 offen offset:1024 sc1
    v_cmp_lt_i32 vcc, 2, v216
    s_nop 1
    v_cndmask_b32 v142, v186, v142, vcc
    v_cndmask_b32 v147, 0, v253, vcc
    v_mfma_f32_16x16x32_bf16 v[60:63], a[60:63], a[12:15], v[60:63]
    ds_read_b128 a[4:7], v152 offset:36864
    v_mfma_f32_16x16x32_bf16 v[64:67], a[56:59], a[16:19], v[64:67]
    v_subrev_u32 v143, 6144, v185
    v_mfma_f32_16x16x32_bf16 v[68:71], a[60:63], a[16:19], v[68:71]
    ds_read_b128 a[8:11], v152 offset:28672
    buffer_load_dwordx4 a[88:91], v2, s[32:35], s48 offen offset:2048 sc1
    v_cmp_lt_i32 vcc, 3, v216
    s_nop 1
    v_cndmask_b32 v143, v186, v143, vcc
    v_cndmask_b32 v148, 0, v253, vcc
    v_mfma_f32_16x16x32_bf16 v[72:75], a[56:59], a[20:23], v[72:75]
    ds_read_b128 a[12:15], v152 offset:38912
    v_mfma_f32_16x16x32_bf16 v[76:79], a[60:63], a[20:23], v[76:79]
    v_subrev_u32 v144, 7680, v185
    s_waitcnt lgkmcnt(8)
    v_mfma_f32_16x16x32_bf16 v[80:83], a[56:59], a[24:27], v[80:83]
    buffer_load_dwordx4 a[92:95], v2, s[32:35], s48 offen offset:3072 sc1
    v_cmp_lt_i32 vcc, 4, v216
    s_nop 1
    v_cndmask_b32 v144, v186, v144, vcc
    v_cndmask_b32 v149, 0, v253, vcc
    v_mfma_f32_16x16x32_bf16 v[84:87], a[60:63], a[24:27], v[84:87]
    v_and_b32 v185, 15, v1
    v_mfma_f32_16x16x32_bf16 v[88:91], a[56:59], a[28:31], v[88:91]
    v_mul_u32_u24 v220, 80, v185
    v_mfma_f32_16x16x32_bf16 v[92:95], a[60:63], a[28:31], v[92:95]
    v_lshrrev_b32 v221, 4, v1
    v_mfma_f32_16x16x32_bf16 v[16:19], a[64:67], a[32:35], v[16:19]
    buffer_load_dwordx4 a[96:99], v3, s[32:35], s48 offen offset:0 sc1
    v_lshl_add_u32 v220, v221, 4, v220
    v_mfma_f32_16x16x32_bf16 v[20:23], a[68:71], a[32:35], v[20:23]
    v_add_u32 v220, s91, v220
    v_bfe_u32 v186, v1, 2, 2
    v_mfma_f32_16x16x32_bf16 v[24:27], a[64:67], a[36:39], v[24:27]
    v_lshl_add_u32 v221, v221, 3, v186
    v_mfma_f32_16x16x32_bf16 v[28:31], a[68:71], a[36:39], v[28:31]
    buffer_load_dwordx4 a[100:103], v2, s[32:35], s49 offen offset:0 sc1
    v_mul_u32_u24 v221, 80, v221
    s_waitcnt lgkmcnt(4)
    v_mfma_f32_16x16x32_bf16 v[32:35], a[64:67], a[40:43], v[32:35]
    v_and_b32 v186, 3, v1
    v_lshl_add_u32 v221, v186, 3, v221
    v_mfma_f32_16x16x32_bf16 v[36:39], a[68:71], a[40:43], v[36:39]
    v_add_u32 v221, s91, v221
    s_lshl_b32 s100, s74, 3
    v_mfma_f32_16x16x32_bf16 v[40:43], a[64:67], a[44:47], v[40:43]
    buffer_load_dwordx4 a[104:107], v2, s[32:35], s49 offen offset:1024 sc1
    s_add_u32 s100, s100, s75
    v_mfma_f32_16x16x32_bf16 v[44:47], a[68:71], a[44:47], v[44:47]
    s_lshl_b32 s100, s100, 4
    v_lshrrev_b32 v12, 4, v0
    v_mfma_f32_16x16x32_bf16 v[48:51], a[64:67], a[48:51], v[48:51]
    v_add_u32 v12, s100, v12
    v_lshlrev_b32 v11, 4, v185
    v_mfma_f32_16x16x32_bf16 v[52:55], a[68:71], a[48:51], v[52:55]
    buffer_load_dwordx4 a[108:111], v2, s[32:35], s49 offen offset:2048 sc1
    v_mfma_f32_16x16x32_bf16 v[56:59], a[64:67], a[52:55], v[56:59]
    v_mul_u32_u24 v10, 1280, v12
    v_mfma_f32_16x16x32_bf16 v[60:63], a[68:71], a[52:55], v[60:63]
    v_add_u32 v10, v10, v11
    s_and_b32 s100, s76, 0x63
    s_waitcnt lgkmcnt(0)
    v_mfma_f32_16x16x32_bf16 v[64:67], a[64:67], a[0:3], v[64:67]
    s_lshl_b32 s79, s72, 3
    s_add_u32 s100, s100, s79
    v_mfma_f32_16x16x32_bf16 v[68:71], a[68:71], a[0:3], v[68:71]
    buffer_load_dwordx4 a[112:115], v2, s[32:35], s49 offen offset:3072 sc1
    s_lshl_b32 s100, s100, 9
    v_mfma_f32_16x16x32_bf16 v[72:75], a[64:67], a[4:7], v[72:75]
    s_add_u32 s100, s100, 327680
    v_mfma_f32_16x16x32_bf16 v[76:79], a[68:71], a[4:7], v[76:79]
    v_bfe_u32 v4, v1, 2, 1
    v_lshlrev_b32 v4, 11, v4
    v_and_b32 v5, 3, v1
    v_lshl_add_u32 v4, v5, 7, v4
    v_add_u32 v4, s100, v4
    v_mfma_f32_16x16x32_bf16 v[80:83], a[64:67], a[8:11], v[80:83]
    buffer_load_dwordx4 a[116:119], v3, s[32:35], s49 offen offset:0 sc1
    v_mfma_f32_16x16x32_bf16 v[84:87], a[68:71], a[8:11], v[84:87]
    v_mfma_f32_16x16x32_bf16 v[88:91], a[64:67], a[12:15], v[88:91]
    v_mfma_f32_16x16x32_bf16 v[92:95], a[68:71], a[12:15], v[92:95]
    v_pk_fma_f32 v[160:161], v[96:97], v[16:17], v[18:19] op_sel:[0,0,0] op_sel_hi:[0,1,1]
    v_pk_fma_f32 v[162:163], v[96:97], v[24:25], v[26:27] op_sel:[0,0,0] op_sel_hi:[0,1,1]
    v_pk_fma_f32 v[164:165], v[104:105], v[32:33], v[34:35] op_sel:[0,0,0] op_sel_hi:[0,1,1]
    v_pk_fma_f32 v[166:167], v[104:105], v[40:41], v[42:43] op_sel:[0,0,0] op_sel_hi:[0,1,1]
    v_pk_fma_f32 v[168:169], v[112:113], v[48:49], v[50:51] op_sel:[0,0,0] op_sel_hi:[0,1,1]
    v_pk_fma_f32 v[170:171], v[112:113], v[56:57], v[58:59] op_sel:[0,0,0] op_sel_hi:[0,1,1]
    v_pk_fma_f32 v[172:173], v[120:121], v[64:65], v[66:67] op_sel:[0,0,0] op_sel_hi:[0,1,1]
    v_pk_fma_f32 v[174:175], v[120:121], v[72:73], v[74:75] op_sel:[0,0,0] op_sel_hi:[0,1,1]
    buffer_load_dwordx4 a[40:43], v10, s[4:7], 0 offen offset:0
    v_pk_fma_f32 v[176:177], v[128:129], v[80:81], v[82:83] op_sel:[0,0,0] op_sel_hi:[0,1,1]
    v_pk_fma_f32 v[178:179], v[128:129], v[88:89], v[90:91] op_sel:[0,0,0] op_sel_hi:[0,1,1]
    v_pk_fma_f32 v[160:161], v[96:97], v[24:25], v[160:161] op_sel:[1,0,0] op_sel_hi:[1,1,1] neg_lo:[1,0,0] neg_hi:[1,0,0]
    v_pk_fma_f32 v[162:163], v[96:97], v[16:17], v[162:163] op_sel:[1,0,0] op_sel_hi:[1,1,1]
    v_pk_fma_f32 v[164:165], v[104:105], v[40:41], v[164:165] op_sel:[1,0,0] op_sel_hi:[1,1,1] neg_lo:[1,0,0] neg_hi:[1,0,0]
    v_pk_fma_f32 v[166:167], v[104:105], v[32:33], v[166:167] op_sel:[1,0,0] op_sel_hi:[1,1,1]
    v_pk_fma_f32 v[168:169], v[112:113], v[56:57], v[168:169] op_sel:[1,0,0] op_sel_hi:[1,1,1] neg_lo:[1,0,0] neg_hi:[1,0,0]
    v_pk_fma_f32 v[170:171], v[112:113], v[48:49], v[170:171] op_sel:[1,0,0] op_sel_hi:[1,1,1]
    v_pk_fma_f32 v[172:173], v[120:121], v[72:73], v[172:173] op_sel:[1,0,0] op_sel_hi:[1,1,1] neg_lo:[1,0,0] neg_hi:[1,0,0]
    v_pk_fma_f32 v[174:175], v[120:121], v[64:65], v[174:175] op_sel:[1,0,0] op_sel_hi:[1,1,1]
    v_pk_fma_f32 v[176:177], v[128:129], v[88:89], v[176:177] op_sel:[1,0,0] op_sel_hi:[1,1,1] neg_lo:[1,0,0] neg_hi:[1,0,0]
    v_pk_fma_f32 v[178:179], v[128:129], v[80:81], v[178:179] op_sel:[1,0,0] op_sel_hi:[1,1,1]
    global_load_dwordx4 a[60:63], v11, s[64:65] offset:0
    v_pk_fma_f32 v[180:181], v[96:97], v[160:161], v[20:21] op_sel:[0,0,0] op_sel_hi:[0,1,1]
    v_pk_fma_f32 v[182:183], v[96:97], v[162:163], v[28:29] op_sel:[0,0,0] op_sel_hi:[0,1,1]
    v_pk_fma_f32 v[184:185], v[104:105], v[164:165], v[36:37] op_sel:[0,0,0] op_sel_hi:[0,1,1]
    v_pk_fma_f32 v[186:187], v[104:105], v[166:167], v[44:45] op_sel:[0,0,0] op_sel_hi:[0,1,1]
    v_pk_fma_f32 v[188:189], v[112:113], v[168:169], v[52:53] op_sel:[0,0,0] op_sel_hi:[0,1,1]
    v_pk_fma_f32 v[190:191], v[112:113], v[170:171], v[60:61] op_sel:[0,0,0] op_sel_hi:[0,1,1]
    v_pk_fma_f32 v[192:193], v[120:121], v[172:173], v[68:69] op_sel:[0,0,0] op_sel_hi:[0,1,1]
    v_pk_fma_f32 v[194:195], v[120:121], v[174:175], v[76:77] op_sel:[0,0,0] op_sel_hi:[0,1,1]
    v_pk_fma_f32 v[196:197], v[128:129], v[176:177], v[84:85] op_sel:[0,0,0] op_sel_hi:[0,1,1]
    v_pk_fma_f32 v[198:199], v[128:129], v[178:179], v[92:93] op_sel:[0,0,0] op_sel_hi:[0,1,1]
    v_pk_fma_f32 v[180:181], v[96:97], v[162:163], v[180:181] op_sel:[1,0,0] op_sel_hi:[1,1,1] neg_lo:[1,0,0] neg_hi:[1,0,0]
    v_pk_fma_f32 v[182:183], v[96:97], v[160:161], v[182:183] op_sel:[1,0,0] op_sel_hi:[1,1,1]
    buffer_load_dwordx4 a[44:47], v10, s[4:7], 0 offen offset:256
    v_pk_fma_f32 v[184:185], v[104:105], v[166:167], v[184:185] op_sel:[1,0,0] op_sel_hi:[1,1,1] neg_lo:[1,0,0] neg_hi:[1,0,0]
    v_pk_fma_f32 v[186:187], v[104:105], v[164:165], v[186:187] op_sel:[1,0,0] op_sel_hi:[1,1,1]
    v_pk_fma_f32 v[188:189], v[112:113], v[170:171], v[188:189] op_sel:[1,0,0] op_sel_hi:[1,1,1] neg_lo:[1,0,0] neg_hi:[1,0,0]
    v_pk_fma_f32 v[190:191], v[112:113], v[168:169], v[190:191] op_sel:[1,0,0] op_sel_hi:[1,1,1]
    v_pk_fma_f32 v[192:193], v[120:121], v[174:175], v[192:193] op_sel:[1,0,0] op_sel_hi:[1,1,1] neg_lo:[1,0,0] neg_hi:[1,0,0]
    v_pk_fma_f32 v[194:195], v[120:121], v[172:173], v[194:195] op_sel:[1,0,0] op_sel_hi:[1,1,1]
    v_pk_fma_f32 v[196:197], v[128:129], v[178:179], v[196:197] op_sel:[1,0,0] op_sel_hi:[1,1,1] neg_lo:[1,0,0] neg_hi:[1,0,0]
    v_pk_fma_f32 v[198:199], v[128:129], v[176:177], v[198:199] op_sel:[1,0,0] op_sel_hi:[1,1,1]
    v_pk_fma_f32 v[160:161], v[96:97], v[180:181], v[22:23] op_sel:[0,0,0] op_sel_hi:[0,1,1]
    v_pk_fma_f32 v[162:163], v[96:97], v[182:183], v[30:31] op_sel:[0,0,0] op_sel_hi:[0,1,1]
    v_pk_fma_f32 v[164:165], v[104:105], v[184:185], v[38:39] op_sel:[0,0,0] op_sel_hi:[0,1,1]
    v_pk_fma_f32 v[166:167], v[104:105], v[186:187], v[46:47] op_sel:[0,0,0] op_sel_hi:[0,1,1]
    global_load_dwordx4 a[64:67], v11, s[64:65] offset:256
    v_pk_fma_f32 v[168:169], v[112:113], v[188:189], v[54:55] op_sel:[0,0,0] op_sel_hi:[0,1,1]
    v_pk_fma_f32 v[170:171], v[112:113], v[190:191], v[62:63] op_sel:[0,0,0] op_sel_hi:[0,1,1]
    v_pk_fma_f32 v[172:173], v[120:121], v[192:193], v[70:71] op_sel:[0,0,0] op_sel_hi:[0,1,1]
    v_pk_fma_f32 v[174:175], v[120:121], v[194:195], v[78:79] op_sel:[0,0,0] op_sel_hi:[0,1,1]
    v_pk_fma_f32 v[176:177], v[128:129], v[196:197], v[86:87] op_sel:[0,0,0] op_sel_hi:[0,1,1]
    v_pk_fma_f32 v[178:179], v[128:129], v[198:199], v[94:95] op_sel:[0,0,0] op_sel_hi:[0,1,1]
    v_pk_fma_f32 v[160:161], v[96:97], v[182:183], v[160:161] op_sel:[1,0,0] op_sel_hi:[1,1,1] neg_lo:[1,0,0] neg_hi:[1,0,0]
    v_pk_fma_f32 v[162:163], v[96:97], v[180:181], v[162:163] op_sel:[1,0,0] op_sel_hi:[1,1,1]
    v_pk_fma_f32 v[164:165], v[104:105], v[186:187], v[164:165] op_sel:[1,0,0] op_sel_hi:[1,1,1] neg_lo:[1,0,0] neg_hi:[1,0,0]
    v_pk_fma_f32 v[166:167], v[104:105], v[184:185], v[166:167] op_sel:[1,0,0] op_sel_hi:[1,1,1]
    v_pk_fma_f32 v[168:169], v[112:113], v[190:191], v[168:169] op_sel:[1,0,0] op_sel_hi:[1,1,1] neg_lo:[1,0,0] neg_hi:[1,0,0]
    v_pk_fma_f32 v[170:171], v[112:113], v[188:189], v[170:171] op_sel:[1,0,0] op_sel_hi:[1,1,1]
    buffer_load_dwordx4 a[48:51], v10, s[4:7], 0 offen offset:512
    v_pk_fma_f32 v[172:173], v[120:121], v[194:195], v[172:173] op_sel:[1,0,0] op_sel_hi:[1,1,1] neg_lo:[1,0,0] neg_hi:[1,0,0]
    v_pk_fma_f32 v[174:175], v[120:121], v[192:193], v[174:175] op_sel:[1,0,0] op_sel_hi:[1,1,1]
    v_pk_fma_f32 v[176:177], v[128:129], v[198:199], v[176:177] op_sel:[1,0,0] op_sel_hi:[1,1,1] neg_lo:[1,0,0] neg_hi:[1,0,0]
    v_pk_fma_f32 v[178:179], v[128:129], v[196:197], v[178:179] op_sel:[1,0,0] op_sel_hi:[1,1,1]
    v_fma_f32 v200, v100, v160, v161
    v_fma_f32 v201, v100, v162, v163
    v_fma_f32 v202, v108, v164, v165
    v_fma_f32 v203, v108, v166, v167
    v_fma_f32 v204, v116, v168, v169
    v_fma_f32 v205, v116, v170, v171
    v_fma_f32 v206, v124, v172, v173
    v_fma_f32 v207, v124, v174, v175
    global_load_dwordx4 a[68:71], v11, s[64:65] offset:512
    v_fma_f32 v208, v132, v176, v177
    v_fma_f32 v209, v132, v178, v179
    v_fma_f32 v200, -v101, v162, v200
    v_fmac_f32 v201, v101, v160
    ds_write_b64 v6, v[200:201] offset:0
    v_fma_f32 v202, -v109, v166, v202
    v_fmac_f32 v203, v109, v164
    ds_write_b64 v6, v[202:203] offset:2304
    v_fma_f32 v204, -v117, v170, v204
    v_fmac_f32 v205, v117, v168
    ds_write_b64 v6, v[204:205] offset:4608
    v_fma_f32 v206, -v125, v174, v206
    v_fmac_f32 v207, v125, v172
    ds_write_b64 v6, v[206:207] offset:6912
    buffer_load_dwordx4 a[52:55], v10, s[4:7], 0 offen offset:768
    v_fma_f32 v208, -v133, v178, v208
    v_fmac_f32 v209, v133, v176
    ds_write_b64 v6, v[208:209] offset:9216
    s_waitcnt lgkmcnt(0)
    s_barrier
    ds_read_b128 v[180:183], v8 offset:0
    ds_read_b128 v[184:187], v8 offset:16
    ds_read_b128 v[188:191], v8 offset:32
    ds_read_b128 v[192:195], v8 offset:48
    ds_read_b128 v[196:199], v8 offset:64
    ds_read_b128 v[200:203], v8 offset:80
    ds_read_b128 v[204:207], v8 offset:96
    ds_read_b128 v[208:211], v8 offset:112
    v_mov_b32 v212, s78
    v_mov_b32 v213, s78
    global_load_dwordx4 a[72:75], v11, s[64:65] offset:768
    s_waitcnt lgkmcnt(5)
    v_pk_fma_f32 v[182:183], v[136:137], v[180:181], v[182:183] op_sel:[0,0,0] op_sel_hi:[0,1,1]
    v_pk_fma_f32 v[182:183], v[136:137], v[180:181], v[182:183] op_sel:[1,1,0] op_sel_hi:[1,0,1] neg_lo:[1,0,0]
    v_pk_fma_f32 v[184:185], v[136:137], v[182:183], v[184:185] op_sel:[0,0,0] op_sel_hi:[0,1,1]
    v_pk_fma_f32 v[184:185], v[136:137], v[182:183], v[184:185] op_sel:[1,1,0] op_sel_hi:[1,0,1] neg_lo:[1,0,0]
    v_pk_fma_f32 v[186:187], v[136:137], v[184:185], v[186:187] op_sel:[0,0,0] op_sel_hi:[0,1,1]
    v_pk_fma_f32 v[186:187], v[136:137], v[184:185], v[186:187] op_sel:[1,1,0] op_sel_hi:[1,0,1] neg_lo:[1,0,0]
    v_pk_fma_f32 v[188:189], v[136:137], v[186:187], v[188:189] op_sel:[0,0,0] op_sel_hi:[0,1,1]
    v_pk_fma_f32 v[188:189], v[136:137], v[186:187], v[188:189] op_sel:[1,1,0] op_sel_hi:[1,0,1] neg_lo:[1,0,0]
    v_pk_fma_f32 v[190:191], v[136:137], v[188:189], v[190:191] op_sel:[0,0,0] op_sel_hi:[0,1,1]
    v_pk_fma_f32 v[190:191], v[136:137], v[188:189], v[190:191] op_sel:[1,1,0] op_sel_hi:[1,0,1] neg_lo:[1,0,0]
    s_waitcnt lgkmcnt(0)
    v_pk_fma_f32 v[192:193], v[136:137], v[190:191], v[192:193] op_sel:[0,0,0] op_sel_hi:[0,1,1]
    buffer_load_dwordx4 a[56:59], v10, s[4:7], 0 offen offset:1024
    v_pk_fma_f32 v[192:193], v[136:137], v[190:191], v[192:193] op_sel:[1,1,0] op_sel_hi:[1,0,1] neg_lo:[1,0,0]
    v_pk_fma_f32 v[194:195], v[136:137], v[192:193], v[194:195] op_sel:[0,0,0] op_sel_hi:[0,1,1]
    v_pk_fma_f32 v[194:195], v[136:137], v[192:193], v[194:195] op_sel:[1,1,0] op_sel_hi:[1,0,1] neg_lo:[1,0,0]
    v_pk_fma_f32 v[196:197], v[136:137], v[194:195], v[196:197] op_sel:[0,0,0] op_sel_hi:[0,1,1]
    v_pk_fma_f32 v[196:197], v[136:137], v[194:195], v[196:197] op_sel:[1,1,0] op_sel_hi:[1,0,1] neg_lo:[1,0,0]
    v_pk_fma_f32 v[198:199], v[136:137], v[196:197], v[198:199] op_sel:[0,0,0] op_sel_hi:[0,1,1]
    v_pk_fma_f32 v[198:199], v[136:137], v[196:197], v[198:199] op_sel:[1,1,0] op_sel_hi:[1,0,1] neg_lo:[1,0,0]
    v_pk_fma_f32 v[200:201], v[136:137], v[198:199], v[200:201] op_sel:[0,0,0] op_sel_hi:[0,1,1]
    v_pk_fma_f32 v[200:201], v[136:137], v[198:199], v[200:201] op_sel:[1,1,0] op_sel_hi:[1,0,1] neg_lo:[1,0,0]
    v_pk_fma_f32 v[202:203], v[136:137], v[200:201], v[202:203] op_sel:[0,0,0] op_sel_hi:[0,1,1]
    v_pk_fma_f32 v[202:203], v[136:137], v[200:201], v[202:203] op_sel:[1,1,0] op_sel_hi:[1,0,1] neg_lo:[1,0,0]
    v_pk_fma_f32 v[204:205], v[136:137], v[202:203], v[204:205] op_sel:[0,0,0] op_sel_hi:[0,1,1]
    global_load_dwordx4 a[76:79], v11, s[64:65] offset:1024
    v_pk_fma_f32 v[204:205], v[136:137], v[202:203], v[204:205] op_sel:[1,1,0] op_sel_hi:[1,0,1] neg_lo:[1,0,0]
    v_pk_fma_f32 v[206:207], v[136:137], v[204:205], v[206:207] op_sel:[0,0,0] op_sel_hi:[0,1,1]
    v_pk_fma_f32 v[206:207], v[136:137], v[204:205], v[206:207] op_sel:[1,1,0] op_sel_hi:[1,0,1] neg_lo:[1,0,0]
    v_pk_fma_f32 v[208:209], v[136:137], v[206:207], v[208:209] op_sel:[0,0,0] op_sel_hi:[0,1,1]
    v_pk_fma_f32 v[208:209], v[136:137], v[206:207], v[208:209] op_sel:[1,1,0] op_sel_hi:[1,0,1] neg_lo:[1,0,0]
    v_pk_fma_f32 v[210:211], v[136:137], v[208:209], v[210:211] op_sel:[0,0,0] op_sel_hi:[0,1,1]
    v_pk_fma_f32 v[210:211], v[136:137], v[208:209], v[210:211] op_sel:[1,1,0] op_sel_hi:[1,0,1] neg_lo:[1,0,0]
    buffer_store_dwordx4 v[210:213], v9, s[12:15], s77 offen sc1
    v_mov_b32 v150, 0
    v_mov_b32 v151, 0
    s_mov_b64 exec, 0xfffff
    ds_write_b64 v8, v[150:151] offset:128
    ds_write_b128 v8, v[180:183] offset:0
    ds_write_b128 v8, v[184:187] offset:16
    ds_write_b128 v8, v[188:191] offset:32
    ds_write_b128 v8, v[192:195] offset:48
    ds_write_b128 v8, v[196:199] offset:64
    ds_write_b128 v8, v[200:203] offset:80
    ds_write_b128 v8, v[204:207] offset:96
    ds_write_b128 v8, v[208:211] offset:112
    s_mov_b64 exec, -1
    buffer_load_dwordx3 v[180:182], v140, s[12:15], 0 offen sc1
    buffer_load_dwordx3 v[184:186], v141, s[12:15], 0 offen sc1
    buffer_load_dwordx3 v[188:190], v142, s[12:15], 0 offen sc1
    buffer_load_dwordx3 v[192:194], v143, s[12:15], 0 offen sc1
    buffer_load_dwordx3 v[196:198], v144, s[12:15], 0 offen sc1
    buffer_load_dwordx4 a[120:123], v2, s[32:35], s50 offen offset:0 sc1
    s_waitcnt vmcnt(62)
    buffer_load_dwordx4 a[124:127], v2, s[32:35], s50 offen offset:1024 sc1
    s_waitcnt vmcnt(62)
    buffer_load_dwordx4 a[128:131], v2, s[32:35], s50 offen offset:2048 sc1
    s_waitcnt vmcnt(62)
    buffer_load_dwordx4 a[132:135], v2, s[32:35], s50 offen offset:3072 sc1
    s_waitcnt vmcnt(62)
    buffer_load_dwordx4 a[136:139], v3, s[32:35], s50 offen offset:0 sc1
    s_waitcnt vmcnt(62)
    buffer_load_dwordx4 a[140:143], v2, s[32:35], s51 offen offset:0 sc1
    v_pk_mul_f32 v[150:151], v[98:99], v[16:17] op_sel:[1,0] op_sel_hi:[1,1]
    v_pk_mul_f32 v[152:153], v[98:99], v[18:19] op_sel:[1,0] op_sel_hi:[1,1]
    v_pk_mul_f32 v[16:17], v[98:99], v[16:17] op_sel:[0,0] op_sel_hi:[0,1]
    v_pk_mul_f32 v[18:19], v[98:99], v[18:19] op_sel:[0,0] op_sel_hi:[0,1]
    v_pk_fma_f32 v[16:17], v[98:99], v[24:25], v[16:17] op_sel:[1,0,0] op_sel_hi:[1,1,1] neg_lo:[1,0,0] neg_hi:[1,0,0]
    v_pk_fma_f32 v[18:19], v[98:99], v[26:27], v[18:19] op_sel:[1,0,0] op_sel_hi:[1,1,1] neg_lo:[1,0,0] neg_hi:[1,0,0]
    v_pk_fma_f32 v[24:25], v[98:99], v[24:25], v[150:151] op_sel:[0,0,0] op_sel_hi:[0,1,1]
    v_pk_fma_f32 v[26:27], v[98:99], v[26:27], v[152:153] op_sel:[0,0,0] op_sel_hi:[0,1,1]
    v_pk_mul_f32 v[150:151], v[98:99], v[20:21] op_sel:[1,0] op_sel_hi:[1,1]
    v_pk_mul_f32 v[152:153], v[98:99], v[22:23] op_sel:[1,0] op_sel_hi:[1,1]
    v_pk_mul_f32 v[20:21], v[98:99], v[20:21] op_sel:[0,0] op_sel_hi:[0,1]
    v_pk_mul_f32 v[22:23], v[98:99], v[22:23] op_sel:[0,0] op_sel_hi:[0,1]
    v_pk_fma_f32 v[20:21], v[98:99], v[28:29], v[20:21] op_sel:[1,0,0] op_sel_hi:[1,1,1] neg_lo:[1,0,0] neg_hi:[1,0,0]
    v_pk_fma_f32 v[22:23], v[98:99], v[30:31], v[22:23] op_sel:[1,0,0] op_sel_hi:[1,1,1] neg_lo:[1,0,0] neg_hi:[1,0,0]
    v_pk_fma_f32 v[28:29], v[98:99], v[28:29], v[150:151] op_sel:[0,0,0] op_sel_hi:[0,1,1]
    v_pk_fma_f32 v[30:31], v[98:99], v[30:31], v[152:153] op_sel:[0,0,0] op_sel_hi:[0,1,1]
    v_mul_f32 v161, v98, v160
    v_mul_f32 v163, v98, v162
    v_fma_f32 v161, -v99, v162, v161
    v_fmac_f32 v163, v99, v160
    v_pk_mul_f32 v[150:151], v[106:107], v[32:33] op_sel:[1,0] op_sel_hi:[1,1]
    v_pk_mul_f32 v[152:153], v[106:107], v[34:35] op_sel:[1,0] op_sel_hi:[1,1]
    v_pk_mul_f32 v[32:33], v[106:107], v[32:33] op_sel:[0,0] op_sel_hi:[0,1]
    v_pk_mul_f32 v[34:35], v[106:107], v[34:35] op_sel:[0,0] op_sel_hi:[0,1]
    v_pk_fma_f32 v[32:33], v[106:107], v[40:41], v[32:33] op_sel:[1,0,0] op_sel_hi:[1,1,1] neg_lo:[1,0,0] neg_hi:[1,0,0]
    v_pk_fma_f32 v[34:35], v[106:107], v[42:43], v[34:35] op_sel:[1,0,0] op_sel_hi:[1,1,1] neg_lo:[1,0,0] neg_hi:[1,0,0]
    v_pk_fma_f32 v[40:41], v[106:107], v[40:41], v[150:151] op_sel:[0,0,0] op_sel_hi:[0,1,1]
    v_pk_fma_f32 v[42:43], v[106:107], v[42:43], v[152:153] op_sel:[0,0,0] op_sel_hi:[0,1,1]
    v_pk_mul_f32 v[150:151], v[106:107], v[36:37] op_sel:[1,0] op_sel_hi:[1,1]
    v_pk_mul_f32 v[152:153], v[106:107], v[38:39] op_sel:[1,0] op_sel_hi:[1,1]
    v_pk_mul_f32 v[36:37], v[106:107], v[36:37] op_sel:[0,0] op_sel_hi:[0,1]
    v_pk_mul_f32 v[38:39], v[106:107], v[38:39] op_sel:[0,0] op_sel_hi:[0,1]
    v_pk_fma_f32 v[36:37], v[106:107], v[44:45], v[36:37] op_sel:[1,0,0] op_sel_hi:[1,1,1] neg_lo:[1,0,0] neg_hi:[1,0,0]
    v_pk_fma_f32 v[38:39], v[106:107], v[46:47], v[38:39] op_sel:[1,0,0] op_sel_hi:[1,1,1] neg_lo:[1,0,0] neg_hi:[1,0,0]
    v_pk_fma_f32 v[44:45], v[106:107], v[44:45], v[150:151] op_sel:[0,0,0] op_sel_hi:[0,1,1]
    v_pk_fma_f32 v[46:47], v[106:107], v[46:47], v[152:153] op_sel:[0,0,0] op_sel_hi:[0,1,1]
    v_mul_f32 v165, v106, v164
    v_mul_f32 v167, v106, v166
    v_fma_f32 v165, -v107, v166, v165
    v_fmac_f32 v167, v107, v164
    v_pk_mul_f32 v[150:151], v[114:115], v[48:49] op_sel:[1,0] op_sel_hi:[1,1]
    v_pk_mul_f32 v[152:153], v[114:115], v[50:51] op_sel:[1,0] op_sel_hi:[1,1]
    v_pk_mul_f32 v[48:49], v[114:115], v[48:49] op_sel:[0,0] op_sel_hi:[0,1]
    v_pk_mul_f32 v[50:51], v[114:115], v[50:51] op_sel:[0,0] op_sel_hi:[0,1]
    v_pk_fma_f32 v[48:49], v[114:115], v[56:57], v[48:49] op_sel:[1,0,0] op_sel_hi:[1,1,1] neg_lo:[1,0,0] neg_hi:[1,0,0]
    v_pk_fma_f32 v[50:51], v[114:115], v[58:59], v[50:51] op_sel:[1,0,0] op_sel_hi:[1,1,1] neg_lo:[1,0,0] neg_hi:[1,0,0]
    v_pk_fma_f32 v[56:57], v[114:115], v[56:57], v[150:151] op_sel:[0,0,0] op_sel_hi:[0,1,1]
    v_pk_fma_f32 v[58:59], v[114:115], v[58:59], v[152:153] op_sel:[0,0,0] op_sel_hi:[0,1,1]
    v_pk_mul_f32 v[150:151], v[114:115], v[52:53] op_sel:[1,0] op_sel_hi:[1,1]
    v_pk_mul_f32 v[152:153], v[114:115], v[54:55] op_sel:[1,0] op_sel_hi:[1,1]
    v_pk_mul_f32 v[52:53], v[114:115], v[52:53] op_sel:[0,0] op_sel_hi:[0,1]
    v_pk_mul_f32 v[54:55], v[114:115], v[54:55] op_sel:[0,0] op_sel_hi:[0,1]
    v_pk_fma_f32 v[52:53], v[114:115], v[60:61], v[52:53] op_sel:[1,0,0] op_sel_hi:[1,1,1] neg_lo:[1,0,0] neg_hi:[1,0,0]
    v_pk_fma_f32 v[54:55], v[114:115], v[62:63], v[54:55] op_sel:[1,0,0] op_sel_hi:[1,1,1] neg_lo:[1,0,0] neg_hi:[1,0,0]
    v_pk_fma_f32 v[60:61], v[114:115], v[60:61], v[150:151] op_sel:[0,0,0] op_sel_hi:[0,1,1]
    v_pk_fma_f32 v[62:63], v[114:115], v[62:63], v[152:153] op_sel:[0,0,0] op_sel_hi:[0,1,1]
    v_mul_f32 v169, v114, v168
    v_mul_f32 v171, v114, v170
    v_fma_f32 v169, -v115, v170, v169
    v_fmac_f32 v171, v115, v168
    v_pk_mul_f32 v[150:151], v[122:123], v[64:65] op_sel:[1,0] op_sel_hi:[1,1]
    v_pk_mul_f32 v[152:153], v[122:123], v[66:67] op_sel:[1,0] op_sel_hi:[1,1]
    v_pk_mul_f32 v[64:65], v[122:123], v[64:65] op_sel:[0,0] op_sel_hi:[0,1]
    v_pk_mul_f32 v[66:67], v[122:123], v[66:67] op_sel:[0,0] op_sel_hi:[0,1]
    v_pk_fma_f32 v[64:65], v[122:123], v[72:73], v[64:65] op_sel:[1,0,0] op_sel_hi:[1,1,1] neg_lo:[1,0,0] neg_hi:[1,0,0]
    v_pk_fma_f32 v[66:67], v[122:123], v[74:75], v[66:67] op_sel:[1,0,0] op_sel_hi:[1,1,1] neg_lo:[1,0,0] neg_hi:[1,0,0]
    v_pk_fma_f32 v[72:73], v[122:123], v[72:73], v[150:151] op_sel:[0,0,0] op_sel_hi:[0,1,1]
    v_pk_fma_f32 v[74:75], v[122:123], v[74:75], v[152:153] op_sel:[0,0,0] op_sel_hi:[0,1,1]
    v_pk_mul_f32 v[150:151], v[122:123], v[68:69] op_sel:[1,0] op_sel_hi:[1,1]
    v_pk_mul_f32 v[152:153], v[122:123], v[70:71] op_sel:[1,0] op_sel_hi:[1,1]
    v_pk_mul_f32 v[68:69], v[122:123], v[68:69] op_sel:[0,0] op_sel_hi:[0,1]
    v_pk_mul_f32 v[70:71], v[122:123], v[70:71] op_sel:[0,0] op_sel_hi:[0,1]
    v_pk_fma_f32 v[68:69], v[122:123], v[76:77], v[68:69] op_sel:[1,0,0] op_sel_hi:[1,1,1] neg_lo:[1,0,0] neg_hi:[1,0,0]
    v_pk_fma_f32 v[70:71], v[122:123], v[78:79], v[70:71] op_sel:[1,0,0] op_sel_hi:[1,1,1] neg_lo:[1,0,0] neg_hi:[1,0,0]
    v_pk_fma_f32 v[76:77], v[122:123], v[76:77], v[150:151] op_sel:[0,0,0] op_sel_hi:[0,1,1]
    v_pk_fma_f32 v[78:79], v[122:123], v[78:79], v[152:153] op_sel:[0,0,0] op_sel_hi:[0,1,1]
    v_mul_f32 v173, v122, v172
    v_mul_f32 v175, v122, v174
    v_fma_f32 v173, -v123, v174, v173
    v_fmac_f32 v175, v123, v172
    v_pk_mul_f32 v[150:151], v[130:131], v[80:81] op_sel:[1,0] op_sel_hi:[1,1]
    v_pk_mul_f32 v[152:153], v[130:131], v[82:83] op_sel:[1,0] op_sel_hi:[1,1]
    v_pk_mul_f32 v[80:81], v[130:131], v[80:81] op_sel:[0,0] op_sel_hi:[0,1]
    v_pk_mul_f32 v[82:83], v[130:131], v[82:83] op_sel:[0,0] op_sel_hi:[0,1]
    v_pk_fma_f32 v[80:81], v[130:131], v[88:89], v[80:81] op_sel:[1,0,0] op_sel_hi:[1,1,1] neg_lo:[1,0,0] neg_hi:[1,0,0]
    v_pk_fma_f32 v[82:83], v[130:131], v[90:91], v[82:83] op_sel:[1,0,0] op_sel_hi:[1,1,1] neg_lo:[1,0,0] neg_hi:[1,0,0]
    v_pk_fma_f32 v[88:89], v[130:131], v[88:89], v[150:151] op_sel:[0,0,0] op_sel_hi:[0,1,1]
    v_pk_fma_f32 v[90:91], v[130:131], v[90:91], v[152:153] op_sel:[0,0,0] op_sel_hi:[0,1,1]
    v_pk_mul_f32 v[150:151], v[130:131], v[84:85] op_sel:[1,0] op_sel_hi:[1,1]
    v_pk_mul_f32 v[152:153], v[130:131], v[86:87] op_sel:[1,0] op_sel_hi:[1,1]
    v_pk_mul_f32 v[84:85], v[130:131], v[84:85] op_sel:[0,0] op_sel_hi:[0,1]
    v_pk_mul_f32 v[86:87], v[130:131], v[86:87] op_sel:[0,0] op_sel_hi:[0,1]
    v_pk_fma_f32 v[84:85], v[130:131], v[92:93], v[84:85] op_sel:[1,0,0] op_sel_hi:[1,1,1] neg_lo:[1,0,0] neg_hi:[1,0,0]
    v_pk_fma_f32 v[86:87], v[130:131], v[94:95], v[86:87] op_sel:[1,0,0] op_sel_hi:[1,1,1] neg_lo:[1,0,0] neg_hi:[1,0,0]
    v_pk_fma_f32 v[92:93], v[130:131], v[92:93], v[150:151] op_sel:[0,0,0] op_sel_hi:[0,1,1]
    v_pk_fma_f32 v[94:95], v[130:131], v[94:95], v[152:153] op_sel:[0,0,0] op_sel_hi:[0,1,1]
    v_mul_f32 v177, v130, v176
    v_mul_f32 v179, v130, v178
    v_fma_f32 v177, -v131, v178, v177
    v_fmac_f32 v179, v131, v176
    s_waitcnt vmcnt(6)
    v_xor_b32 v183, v149, v198
    v_xor_b32 v187, v148, v194
    v_or_b32 v183, v183, v187
    v_xor_b32 v187, v147, v190
    v_or_b32 v183, v183, v187
    v_xor_b32 v187, v146, v186
    v_or_b32 v183, v183, v187
    v_xor_b32 v187, v145, v182
    v_or_b32 v183, v183, v187
    v_cmp_ne_u32 vcc, 0, v183
    s_nop 0
    s_cmp_eq_u64 vcc, 0
    s_cbranch_scc0 L_carry_retry_17
L_carry_ok_18:
    buffer_load_dwordx4 a[144:147], v2, s[32:35], s51 offen offset:1024 sc1
    v_pk_fma_f32 v[192:193], v[138:139], v[196:197], v[192:193] op_sel:[0,0,0] op_sel_hi:[0,1,1]
    v_pk_fma_f32 v[192:193], v[138:139], v[196:197], v[192:193] op_sel:[1,1,0] op_sel_hi:[1,0,1] neg_lo:[1,0,0]
    v_pk_fma_f32 v[188:189], v[138:139], v[192:193], v[188:189] op_sel:[0,0,0] op_sel_hi:[0,1,1]
    v_pk_fma_f32 v[188:189], v[138:139], v[192:193], v[188:189] op_sel:[1,1,0] op_sel_hi:[1,0,1] neg_lo:[1,0,0]
    v_pk_fma_f32 v[184:185], v[138:139], v[188:189], v[184:185] op_sel:[0,0,0] op_sel_hi:[0,1,1]
    v_pk_fma_f32 v[184:185], v[138:139], v[188:189], v[184:185] op_sel:[1,1,0] op_sel_hi:[1,0,1] neg_lo:[1,0,0]
    v_pk_fma_f32 v[180:181], v[138:139], v[184:185], v[180:181] op_sel:[0,0,0] op_sel_hi:[0,1,1]
    v_pk_fma_f32 v[180:181], v[138:139], v[184:185], v[180:181] op_sel:[1,1,0] op_sel_hi:[1,0,1] neg_lo:[1,0,0]
    v_mul_f32 v184, v214, v180
    v_mul_f32 v185, v214, v181
    v_fma_f32 v184, -v215, v181, v184
    v_fmac_f32 v185, v215, v180
    ds_write_b64 v155, v[184:185]
    s_waitcnt lgkmcnt(0)
    s_barrier
    ds_read_b64 v[200:201], v7 offset:11520
    ds_read_b64 v[180:181], v7 offset:12160
    ds_read_b64 v[182:183], v7 offset:12800
    ds_read_b64 v[210:211], v13 offset:0
    ds_read_b64 v[202:203], v7 offset:11648
    ds_read_b64 v[184:185], v7 offset:12288
    ds_read_b64 v[186:187], v7 offset:12928
    ds_read_b64 v[212:213], v13 offset:2304
    ds_read_b64 v[204:205], v7 offset:11776
    ds_read_b64 v[188:189], v7 offset:12416
    ds_read_b64 v[190:191], v7 offset:13056
    ds_read_b64 v[214:215], v13 offset:4608
    ds_read_b64 v[206:207], v7 offset:11904
    ds_read_b64 v[192:193], v7 offset:12544
    ds_read_b64 v[194:195], v7 offset:13184
    ds_read_b64 v[216:217], v13 offset:6912
    ds_read_b64 v[208:209], v7 offset:12032
    ds_read_b64 v[196:197], v7 offset:12672
    ds_read_b64 v[198:199], v7 offset:13312
    ds_read_b64 v[218:219], v13 offset:9216
    buffer_load_dwordx4 a[148:151], v2, s[32:35], s51 offen offset:2048 sc1
    s_waitcnt lgkmcnt(15)
    v_pk_add_f32 v[200:201], v[200:201], v[180:181]
    s_waitcnt lgkmcnt(14)
    v_pk_add_f32 v[202:203], v[202:203], v[184:185]
    s_waitcnt lgkmcnt(10)
    v_pk_add_f32 v[204:205], v[204:205], v[188:189]
    s_waitcnt lgkmcnt(6)
    v_pk_add_f32 v[206:207], v[206:207], v[192:193]
    s_waitcnt lgkmcnt(2)
    v_pk_add_f32 v[208:209], v[208:209], v[196:197]
    v_pk_add_f32 v[200:201], v[200:201], v[182:183]
    v_pk_add_f32 v[202:203], v[202:203], v[186:187]
    v_pk_add_f32 v[204:205], v[204:205], v[190:191]
    v_pk_add_f32 v[206:207], v[206:207], v[194:195]
    s_waitcnt lgkmcnt(1)
    v_pk_add_f32 v[208:209], v[208:209], v[198:199]
    v_pk_fma_f32 v[210:211], v[102:103], v[200:201], v[210:211] op_sel:[0,0,0] op_sel_hi:[0,1,1]
    v_pk_fma_f32 v[212:213], v[110:111], v[202:203], v[212:213] op_sel:[0,0,0] op_sel_hi:[0,1,1]
    v_pk_fma_f32 v[214:215], v[118:119], v[204:205], v[214:215] op_sel:[0,0,0] op_sel_hi:[0,1,1]
    v_pk_fma_f32 v[216:217], v[126:127], v[206:207], v[216:217] op_sel:[0,0,0] op_sel_hi:[0,1,1]
    s_waitcnt lgkmcnt(0)
    v_pk_fma_f32 v[218:219], v[134:135], v[208:209], v[218:219] op_sel:[0,0,0] op_sel_hi:[0,1,1]
    v_pk_fma_f32 v[210:211], v[102:103], v[200:201], v[210:211] op_sel:[1,1,0] op_sel_hi:[1,0,1] neg_lo:[1,0,0]
    v_pk_fma_f32 v[212:213], v[110:111], v[202:203], v[212:213] op_sel:[1,1,0] op_sel_hi:[1,0,1] neg_lo:[1,0,0]
    v_pk_fma_f32 v[214:215], v[118:119], v[204:205], v[214:215] op_sel:[1,1,0] op_sel_hi:[1,0,1] neg_lo:[1,0,0]
    v_pk_fma_f32 v[216:217], v[126:127], v[206:207], v[216:217] op_sel:[1,1,0] op_sel_hi:[1,0,1] neg_lo:[1,0,0]
    v_pk_fma_f32 v[218:219], v[134:135], v[208:209], v[218:219] op_sel:[1,1,0] op_sel_hi:[1,0,1] neg_lo:[1,0,0]
    v_mul_f32 v160, v98, v210
    v_mul_f32 v162, v98, v211
    v_mul_f32 v164, v106, v212
    v_mul_f32 v166, v106, v213
    v_mul_f32 v168, v114, v214
    v_mul_f32 v170, v114, v215
    v_mul_f32 v172, v122, v216
    v_mul_f32 v174, v122, v217
    v_mul_f32 v176, v130, v218
    v_mul_f32 v178, v130, v219
    v_fma_f32 v160, -v99, v211, v160
    v_fmac_f32 v162, v99, v210
    v_fma_f32 v164, -v107, v213, v164
    v_fmac_f32 v166, v107, v212
    v_fma_f32 v168, -v115, v215, v168
    v_fmac_f32 v170, v115, v214
    v_fma_f32 v172, -v123, v217, v172
    v_fmac_f32 v174, v123, v216
    v_fma_f32 v176, -v131, v219, v176
    v_fmac_f32 v178, v131, v218
    v_fmac_f32 v161, v100, v160
    v_fmac_f32 v163, v100, v162
    v_fmac_f32 v165, v108, v164
    v_fmac_f32 v167, v108, v166
    v_fmac_f32 v169, v116, v168
    v_fmac_f32 v171, v116, v170
    v_fmac_f32 v173, v124, v172
    v_fmac_f32 v175, v124, v174
    v_fmac_f32 v177, v132, v176
    v_fmac_f32 v179, v132, v178
    v_fma_f32 v161, -v101, v162, v161
    v_fmac_f32 v163, v101, v160
    v_fma_f32 v165, -v109, v166, v165
    v_fmac_f32 v167, v109, v164
    v_fma_f32 v169, -v117, v170, v169
    v_fmac_f32 v171, v117, v168
    v_fma_f32 v173, -v125, v174, v173
    v_fmac_f32 v175, v125, v172
    v_fma_f32 v177, -v133, v178, v177
    v_fmac_f32 v179, v133, v176
    v_pk_fma_f32 v[16:17], v[96:97], v[160:161], v[16:17] op_sel:[0,0,0] op_sel_hi:[0,1,1]
    v_pk_fma_f32 v[24:25], v[96:97], v[162:163], v[24:25] op_sel:[0,0,0] op_sel_hi:[0,1,1]
    v_pk_fma_f32 v[32:33], v[104:105], v[164:165], v[32:33] op_sel:[0,0,0] op_sel_hi:[0,1,1]
    v_pk_fma_f32 v[40:41], v[104:105], v[166:167], v[40:41] op_sel:[0,0,0] op_sel_hi:[0,1,1]
    v_pk_fma_f32 v[16:17], v[96:97], v[162:163], v[16:17] op_sel:[1,0,0] op_sel_hi:[1,1,1] neg_lo:[1,0,0] neg_hi:[1,0,0]
    v_pk_fma_f32 v[24:25], v[96:97], v[160:161], v[24:25] op_sel:[1,0,0] op_sel_hi:[1,1,1]
    v_pk_fma_f32 v[32:33], v[104:105], v[166:167], v[32:33] op_sel:[1,0,0] op_sel_hi:[1,1,1] neg_lo:[1,0,0] neg_hi:[1,0,0]
    v_pk_fma_f32 v[40:41], v[104:105], v[164:165], v[40:41] op_sel:[1,0,0] op_sel_hi:[1,1,1]
    v_pk_fma_f32 v[18:19], v[96:97], v[16:17], v[18:19] op_sel:[0,0,0] op_sel_hi:[0,1,1]
    v_pk_fma_f32 v[26:27], v[96:97], v[24:25], v[26:27] op_sel:[0,0,0] op_sel_hi:[0,1,1]
    v_pk_fma_f32 v[34:35], v[104:105], v[32:33], v[34:35] op_sel:[0,0,0] op_sel_hi:[0,1,1]
    v_pk_fma_f32 v[42:43], v[104:105], v[40:41], v[42:43] op_sel:[0,0,0] op_sel_hi:[0,1,1]
    v_pk_fma_f32 v[18:19], v[96:97], v[24:25], v[18:19] op_sel:[1,0,0] op_sel_hi:[1,1,1] neg_lo:[1,0,0] neg_hi:[1,0,0]
    v_pk_fma_f32 v[26:27], v[96:97], v[16:17], v[26:27] op_sel:[1,0,0] op_sel_hi:[1,1,1]
    v_pk_fma_f32 v[34:35], v[104:105], v[40:41], v[34:35] op_sel:[1,0,0] op_sel_hi:[1,1,1] neg_lo:[1,0,0] neg_hi:[1,0,0]
    v_pk_fma_f32 v[42:43], v[104:105], v[32:33], v[42:43] op_sel:[1,0,0] op_sel_hi:[1,1,1]
    v_pk_fma_f32 v[20:21], v[96:97], v[18:19], v[20:21] op_sel:[0,0,0] op_sel_hi:[0,1,1]
    v_pk_fma_f32 v[28:29], v[96:97], v[26:27], v[28:29] op_sel:[0,0,0] op_sel_hi:[0,1,1]
    v_pk_fma_f32 v[36:37], v[104:105], v[34:35], v[36:37] op_sel:[0,0,0] op_sel_hi:[0,1,1]
    v_pk_fma_f32 v[44:45], v[104:105], v[42:43], v[44:45] op_sel:[0,0,0] op_sel_hi:[0,1,1]
    v_pk_fma_f32 v[20:21], v[96:97], v[26:27], v[20:21] op_sel:[1,0,0] op_sel_hi:[1,1,1] neg_lo:[1,0,0] neg_hi:[1,0,0]
    v_pk_fma_f32 v[28:29], v[96:97], v[18:19], v[28:29] op_sel:[1,0,0] op_sel_hi:[1,1,1]
    v_pk_fma_f32 v[36:37], v[104:105], v[42:43], v[36:37] op_sel:[1,0,0] op_sel_hi:[1,1,1] neg_lo:[1,0,0] neg_hi:[1,0,0]
    v_pk_fma_f32 v[44:45], v[104:105], v[34:35], v[44:45] op_sel:[1,0,0] op_sel_hi:[1,1,1]
    v_pk_fma_f32 v[22:23], v[96:97], v[20:21], v[22:23] op_sel:[0,0,0] op_sel_hi:[0,1,1]
    v_pk_fma_f32 v[30:31], v[96:97], v[28:29], v[30:31] op_sel:[0,0,0] op_sel_hi:[0,1,1]
    v_pk_fma_f32 v[38:39], v[104:105], v[36:37], v[38:39] op_sel:[0,0,0] op_sel_hi:[0,1,1]
    v_pk_fma_f32 v[46:47], v[104:105], v[44:45], v[46:47] op_sel:[0,0,0] op_sel_hi:[0,1,1]
    v_pk_fma_f32 v[22:23], v[96:97], v[28:29], v[22:23] op_sel:[1,0,0] op_sel_hi:[1,1,1] neg_lo:[1,0,0] neg_hi:[1,0,0]
    v_pk_fma_f32 v[30:31], v[96:97], v[20:21], v[30:31] op_sel:[1,0,0] op_sel_hi:[1,1,1]
    v_pk_fma_f32 v[38:39], v[104:105], v[44:45], v[38:39] op_sel:[1,0,0] op_sel_hi:[1,1,1] neg_lo:[1,0,0] neg_hi:[1,0,0]
    v_pk_fma_f32 v[46:47], v[104:105], v[36:37], v[46:47] op_sel:[1,0,0] op_sel_hi:[1,1,1]
    v_cvt_pk_bf16_f32 v104, v16, v18
    v_cvt_pk_bf16_f32 v105, v20, v22
    v_cvt_pk_bf16_f32 v106, v17, v19
    v_cvt_pk_bf16_f32 v107, v21, v23
    ds_write_b128 v220, v[104:107] offset:0
    v_cvt_pk_bf16_f32 v108, -v24, -v26
    v_cvt_pk_bf16_f32 v109, -v28, -v30
    v_cvt_pk_bf16_f32 v110, -v25, -v27
    v_cvt_pk_bf16_f32 v111, -v29, -v31
    ds_write_b128 v220, v[108:111] offset:1280
    ds_read_b64_tr_b16 v[148:149], v221 offset:0
    ds_read_b64_tr_b16 v[150:151], v221 offset:320
    ds_read_b64_tr_b16 v[152:153], v221 offset:32
    ds_read_b64_tr_b16 v[154:155], v221 offset:352
    v_pk_fma_f32 v[48:49], v[112:113], v[168:169], v[48:49] op_sel:[0,0,0] op_sel_hi:[0,1,1]
    v_cvt_pk_bf16_f32 v140, v32, v34
    v_pk_fma_f32 v[56:57], v[112:113], v[170:171], v[56:57] op_sel:[0,0,0] op_sel_hi:[0,1,1]
    v_cvt_pk_bf16_f32 v141, v36, v38
    v_pk_fma_f32 v[48:49], v[112:113], v[170:171], v[48:49] op_sel:[1,0,0] op_sel_hi:[1,1,1] neg_lo:[1,0,0] neg_hi:[1,0,0]
    v_cvt_pk_bf16_f32 v142, v33, v35
    v_pk_fma_f32 v[56:57], v[112:113], v[168:169], v[56:57] op_sel:[1,0,0] op_sel_hi:[1,1,1]
    v_cvt_pk_bf16_f32 v143, v37, v39
    v_pk_fma_f32 v[50:51], v[112:113], v[48:49], v[50:51] op_sel:[0,0,0] op_sel_hi:[0,1,1]
    ds_write_b128 v220, v[140:143] offset:2560
    v_pk_fma_f32 v[58:59], v[112:113], v[56:57], v[58:59] op_sel:[0,0,0] op_sel_hi:[0,1,1]
    v_cvt_pk_bf16_f32 v144, -v40, -v42
    v_pk_fma_f32 v[50:51], v[112:113], v[56:57], v[50:51] op_sel:[1,0,0] op_sel_hi:[1,1,1] neg_lo:[1,0,0] neg_hi:[1,0,0]
    v_cvt_pk_bf16_f32 v145, -v44, -v46
    v_pk_fma_f32 v[58:59], v[112:113], v[48:49], v[58:59] op_sel:[1,0,0] op_sel_hi:[1,1,1]
    v_pk_fma_f32 v[52:53], v[112:113], v[50:51], v[52:53] op_sel:[0,0,0] op_sel_hi:[0,1,1]
    v_cvt_pk_bf16_f32 v146, -v41, -v43
    v_pk_fma_f32 v[60:61], v[112:113], v[58:59], v[60:61] op_sel:[0,0,0] op_sel_hi:[0,1,1]
    v_cvt_pk_bf16_f32 v147, -v45, -v47
    v_pk_fma_f32 v[52:53], v[112:113], v[58:59], v[52:53] op_sel:[1,0,0] op_sel_hi:[1,1,1] neg_lo:[1,0,0] neg_hi:[1,0,0]
    ds_write_b128 v220, v[144:147] offset:3840
    v_pk_fma_f32 v[60:61], v[112:113], v[50:51], v[60:61] op_sel:[1,0,0] op_sel_hi:[1,1,1]
    ds_read_b64_tr_b16 v[96:97], v221 offset:2560
    v_pk_fma_f32 v[54:55], v[112:113], v[52:53], v[54:55] op_sel:[0,0,0] op_sel_hi:[0,1,1]
    ds_read_b64_tr_b16 v[98:99], v221 offset:2880
    v_pk_fma_f32 v[62:63], v[112:113], v[60:61], v[62:63] op_sel:[0,0,0] op_sel_hi:[0,1,1]
    ds_read_b64_tr_b16 v[100:101], v221 offset:2592
    v_pk_fma_f32 v[54:55], v[112:113], v[60:61], v[54:55] op_sel:[1,0,0] op_sel_hi:[1,1,1] neg_lo:[1,0,0] neg_hi:[1,0,0]
    ds_read_b64_tr_b16 v[102:103], v221 offset:2912
    v_pk_fma_f32 v[62:63], v[112:113], v[52:53], v[62:63] op_sel:[1,0,0] op_sel_hi:[1,1,1]
    s_waitcnt lgkmcnt(8)
    buffer_store_dwordx4 v[148:151], v156, s[36:39], 0 offen offset:0 sc1
    s_waitcnt lgkmcnt(6)
    buffer_store_dwordx4 v[152:155], v156, s[36:39], 0 offen offset:1024 sc1
    v_add_u32 v156, 8192, v156
    v_pk_fma_f32 v[64:65], v[120:121], v[172:173], v[64:65] op_sel:[0,0,0] op_sel_hi:[0,1,1]
    v_cvt_pk_bf16_f32 v104, v48, v50
    v_pk_fma_f32 v[72:73], v[120:121], v[174:175], v[72:73] op_sel:[0,0,0] op_sel_hi:[0,1,1]
    v_cvt_pk_bf16_f32 v105, v52, v54
    v_pk_fma_f32 v[64:65], v[120:121], v[174:175], v[64:65] op_sel:[1,0,0] op_sel_hi:[1,1,1] neg_lo:[1,0,0] neg_hi:[1,0,0]
    v_cvt_pk_bf16_f32 v106, v49, v51
    v_pk_fma_f32 v[72:73], v[120:121], v[172:173], v[72:73] op_sel:[1,0,0] op_sel_hi:[1,1,1]
    v_cvt_pk_bf16_f32 v107, v53, v55
    v_pk_fma_f32 v[66:67], v[120:121], v[64:65], v[66:67] op_sel:[0,0,0] op_sel_hi:[0,1,1]
    ds_write_b128 v220, v[104:107] offset:5120
    v_pk_fma_f32 v[74:75], v[120:121], v[72:73], v[74:75] op_sel:[0,0,0] op_sel_hi:[0,1,1]
    v_cvt_pk_bf16_f32 v108, -v56, -v58
    v_pk_fma_f32 v[66:67], v[120:121], v[72:73], v[66:67] op_sel:[1,0,0] op_sel_hi:[1,1,1] neg_lo:[1,0,0] neg_hi:[1,0,0]
    v_cvt_pk_bf16_f32 v109, -v60, -v62
    v_pk_fma_f32 v[74:75], v[120:121], v[64:65], v[74:75] op_sel:[1,0,0] op_sel_hi:[1,1,1]
    v_pk_fma_f32 v[68:69], v[120:121], v[66:67], v[68:69] op_sel:[0,0,0] op_sel_hi:[0,1,1]
    v_cvt_pk_bf16_f32 v110, -v57, -v59
    v_pk_fma_f32 v[76:77], v[120:121], v[74:75], v[76:77] op_sel:[0,0,0] op_sel_hi:[0,1,1]
    v_cvt_pk_bf16_f32 v111, -v61, -v63
    v_pk_fma_f32 v[68:69], v[120:121], v[74:75], v[68:69] op_sel:[1,0,0] op_sel_hi:[1,1,1] neg_lo:[1,0,0] neg_hi:[1,0,0]
    ds_write_b128 v220, v[108:111] offset:6400
    v_pk_fma_f32 v[76:77], v[120:121], v[66:67], v[76:77] op_sel:[1,0,0] op_sel_hi:[1,1,1]
    ds_read_b64_tr_b16 v[148:149], v221 offset:5120
    v_pk_fma_f32 v[70:71], v[120:121], v[68:69], v[70:71] op_sel:[0,0,0] op_sel_hi:[0,1,1]
    ds_read_b64_tr_b16 v[150:151], v221 offset:5440
    v_pk_fma_f32 v[78:79], v[120:121], v[76:77], v[78:79] op_sel:[0,0,0] op_sel_hi:[0,1,1]
    ds_read_b64_tr_b16 v[152:153], v221 offset:5152
    v_pk_fma_f32 v[70:71], v[120:121], v[76:77], v[70:71] op_sel:[1,0,0] op_sel_hi:[1,1,1] neg_lo:[1,0,0] neg_hi:[1,0,0]
    ds_read_b64_tr_b16 v[154:155], v221 offset:5472
    v_pk_fma_f32 v[78:79], v[120:121], v[68:69], v[78:79] op_sel:[1,0,0] op_sel_hi:[1,1,1]
    s_waitcnt lgkmcnt(8)
    buffer_store_dwordx4 v[96:99], v156, s[36:39], 0 offen offset:0 sc1
    s_waitcnt lgkmcnt(6)
    buffer_store_dwordx4 v[100:103], v156, s[36:39], 0 offen offset:1024 sc1
    v_add_u32 v156, 8192, v156
    v_pk_fma_f32 v[80:81], v[128:129], v[176:177], v[80:81] op_sel:[0,0,0] op_sel_hi:[0,1,1]
    v_cvt_pk_bf16_f32 v140, v64, v66
    v_pk_fma_f32 v[88:89], v[128:129], v[178:179], v[88:89] op_sel:[0,0,0] op_sel_hi:[0,1,1]
    v_cvt_pk_bf16_f32 v141, v68, v70
    v_pk_fma_f32 v[80:81], v[128:129], v[178:179], v[80:81] op_sel:[1,0,0] op_sel_hi:[1,1,1] neg_lo:[1,0,0] neg_hi:[1,0,0]
    v_cvt_pk_bf16_f32 v142, v65, v67
    v_pk_fma_f32 v[88:89], v[128:129], v[176:177], v[88:89] op_sel:[1,0,0] op_sel_hi:[1,1,1]
    v_cvt_pk_bf16_f32 v143, v69, v71
    v_pk_fma_f32 v[82:83], v[128:129], v[80:81], v[82:83] op_sel:[0,0,0] op_sel_hi:[0,1,1]
    ds_write_b128 v220, v[140:143] offset:7680
    v_pk_fma_f32 v[90:91], v[128:129], v[88:89], v[90:91] op_sel:[0,0,0] op_sel_hi:[0,1,1]
    v_cvt_pk_bf16_f32 v144, -v72, -v74
    v_pk_fma_f32 v[82:83], v[128:129], v[88:89], v[82:83] op_sel:[1,0,0] op_sel_hi:[1,1,1] neg_lo:[1,0,0] neg_hi:[1,0,0]
    v_cvt_pk_bf16_f32 v145, -v76, -v78
    v_pk_fma_f32 v[90:91], v[128:129], v[80:81], v[90:91] op_sel:[1,0,0] op_sel_hi:[1,1,1]
    v_pk_fma_f32 v[84:85], v[128:129], v[82:83], v[84:85] op_sel:[0,0,0] op_sel_hi:[0,1,1]
    v_cvt_pk_bf16_f32 v146, -v73, -v75
    v_pk_fma_f32 v[92:93], v[128:129], v[90:91], v[92:93] op_sel:[0,0,0] op_sel_hi:[0,1,1]
    v_cvt_pk_bf16_f32 v147, -v77, -v79
    v_pk_fma_f32 v[84:85], v[128:129], v[90:91], v[84:85] op_sel:[1,0,0] op_sel_hi:[1,1,1] neg_lo:[1,0,0] neg_hi:[1,0,0]
    ds_write_b128 v220, v[144:147] offset:8960
    v_pk_fma_f32 v[92:93], v[128:129], v[82:83], v[92:93] op_sel:[1,0,0] op_sel_hi:[1,1,1]
    ds_read_b64_tr_b16 v[96:97], v221 offset:7680
    v_pk_fma_f32 v[86:87], v[128:129], v[84:85], v[86:87] op_sel:[0,0,0] op_sel_hi:[0,1,1]
    ds_read_b64_tr_b16 v[98:99], v221 offset:8000
    v_pk_fma_f32 v[94:95], v[128:129], v[92:93], v[94:95] op_sel:[0,0,0] op_sel_hi:[0,1,1]
    ds_read_b64_tr_b16 v[100:101], v221 offset:7712
    v_pk_fma_f32 v[86:87], v[128:129], v[92:93], v[86:87] op_sel:[1,0,0] op_sel_hi:[1,1,1] neg_lo:[1,0,0] neg_hi:[1,0,0]
    ds_read_b64_tr_b16 v[102:103], v221 offset:8032
    v_pk_fma_f32 v[94:95], v[128:129], v[84:85], v[94:95] op_sel:[1,0,0] op_sel_hi:[1,1,1]
    s_waitcnt lgkmcnt(8)
    buffer_store_dwordx4 v[148:151], v156, s[36:39], 0 offen offset:0 sc1
    s_waitcnt lgkmcnt(6)
    buffer_store_dwordx4 v[152:155], v156, s[36:39], 0 offen offset:1024 sc1
    v_add_u32 v156, 8192, v156
    v_cvt_pk_bf16_f32 v104, v80, v82
    v_cvt_pk_bf16_f32 v105, v84, v86
    v_cvt_pk_bf16_f32 v106, v81, v83
    v_cvt_pk_bf16_f32 v107, v85, v87
    ds_write_b128 v220, v[104:107] offset:10240
    v_cvt_pk_bf16_f32 v108, -v88, -v90
    v_cvt_pk_bf16_f32 v109, -v92, -v94
    v_cvt_pk_bf16_f32 v110, -v89, -v91
    v_cvt_pk_bf16_f32 v111, -v93, -v95
    ds_write_b128 v220, v[108:111] offset:11520
    ds_read_b64_tr_b16 v[148:149], v221 offset:10240
    ds_read_b64_tr_b16 v[150:151], v221 offset:10560
    ds_read_b64_tr_b16 v[152:153], v221 offset:10272
    ds_read_b64_tr_b16 v[154:155], v221 offset:10592
    s_waitcnt lgkmcnt(8)
    buffer_store_dwordx4 v[96:99], v156, s[36:39], 0 offen offset:0 sc1
    s_waitcnt lgkmcnt(6)
    buffer_store_dwordx4 v[100:103], v156, s[36:39], 0 offen offset:1024 sc1
    v_add_u32 v156, 8192, v156
    s_waitcnt lgkmcnt(2)
    buffer_store_dwordx4 v[148:151], v156, s[36:39], 0 offen offset:0 sc1
    s_waitcnt lgkmcnt(0)
    buffer_store_dwordx4 v[152:155], v156, s[36:39], 0 offen offset:1024 sc1
    v_add_u32 v156, 8192, v156
    v_mov_b32 v24, 0
    v_mov_b32 v25, 0x3f803f80
    s_mov_b32 s99, 0xffff0000
    v_accvgpr_read_b32 v180, a40
    v_accvgpr_read_b32 v200, a60
    v_lshlrev_b32 v16, 16, v180
    v_and_b32 v17, s99, v180
    v_lshlrev_b32 v18, 16, v200
    v_and_b32 v19, s99, v200
    v_mul_f32 v16, v16, v18
    v_mul_f32 v17, v17, v19
    v_cvt_pk_bf16_f32 v16, v16, v17
    v_dot2_f32_bf16 v24, v16, v25, v24
    v_accvgpr_read_b32 v181, a41
    v_accvgpr_read_b32 v201, a61
    v_lshlrev_b32 v20, 16, v181
    v_and_b32 v21, s99, v181
    v_lshlrev_b32 v22, 16, v201
    v_and_b32 v23, s99, v201
    v_mul_f32 v20, v20, v22
    v_mul_f32 v21, v21, v23
    v_cvt_pk_bf16_f32 v20, v20, v21
    v_dot2_f32_bf16 v24, v20, v25, v24
    v_accvgpr_read_b32 v182, a42
    v_accvgpr_read_b32 v202, a62
    v_lshlrev_b32 v16, 16, v182
    v_and_b32 v17, s99, v182
    v_lshlrev_b32 v18, 16, v202
    v_and_b32 v19, s99, v202
    v_mul_f32 v16, v16, v18
    v_mul_f32 v17, v17, v19
    v_cvt_pk_bf16_f32 v16, v16, v17
    v_dot2_f32_bf16 v24, v16, v25, v24
    v_accvgpr_read_b32 v183, a43
    v_accvgpr_read_b32 v203, a63
    v_lshlrev_b32 v20, 16, v183
    v_and_b32 v21, s99, v183
    v_lshlrev_b32 v22, 16, v203
    v_and_b32 v23, s99, v203
    v_mul_f32 v20, v20, v22
    v_mul_f32 v21, v21, v23
    v_cvt_pk_bf16_f32 v20, v20, v21
    v_dot2_f32_bf16 v24, v20, v25, v24
    v_accvgpr_read_b32 v184, a44
    v_accvgpr_read_b32 v204, a64
    v_lshlrev_b32 v16, 16, v184
    v_and_b32 v17, s99, v184
    v_lshlrev_b32 v18, 16, v204
    v_and_b32 v19, s99, v204
    v_mul_f32 v16, v16, v18
    v_mul_f32 v17, v17, v19
    v_cvt_pk_bf16_f32 v16, v16, v17
    v_dot2_f32_bf16 v24, v16, v25, v24
    v_accvgpr_read_b32 v185, a45
    v_accvgpr_read_b32 v205, a65
    v_lshlrev_b32 v20, 16, v185
    v_and_b32 v21, s99, v185
    v_lshlrev_b32 v22, 16, v205
    v_and_b32 v23, s99, v205
    v_mul_f32 v20, v20, v22
    v_mul_f32 v21, v21, v23
    v_cvt_pk_bf16_f32 v20, v20, v21
    v_dot2_f32_bf16 v24, v20, v25, v24
    v_accvgpr_read_b32 v186, a46
    v_accvgpr_read_b32 v206, a66
    v_lshlrev_b32 v16, 16, v186
    v_and_b32 v17, s99, v186
    v_lshlrev_b32 v18, 16, v206
    v_and_b32 v19, s99, v206
    v_mul_f32 v16, v16, v18
    v_mul_f32 v17, v17, v19
    v_cvt_pk_bf16_f32 v16, v16, v17
    v_dot2_f32_bf16 v24, v16, v25, v24
    v_accvgpr_read_b32 v187, a47
    v_accvgpr_read_b32 v207, a67
    v_lshlrev_b32 v20, 16, v187
    v_and_b32 v21, s99, v187
    v_lshlrev_b32 v22, 16, v207
    v_and_b32 v23, s99, v207
    v_mul_f32 v20, v20, v22
    v_mul_f32 v21, v21, v23
    v_cvt_pk_bf16_f32 v20, v20, v21
    v_dot2_f32_bf16 v24, v20, v25, v24
    v_accvgpr_read_b32 v188, a48
    v_accvgpr_read_b32 v208, a68
    v_lshlrev_b32 v16, 16, v188
    v_and_b32 v17, s99, v188
    v_lshlrev_b32 v18, 16, v208
    v_and_b32 v19, s99, v208
    v_mul_f32 v16, v16, v18
    v_mul_f32 v17, v17, v19
    v_cvt_pk_bf16_f32 v16, v16, v17
    v_dot2_f32_bf16 v24, v16, v25, v24
    v_accvgpr_read_b32 v189, a49
    v_accvgpr_read_b32 v209, a69
    v_lshlrev_b32 v20, 16, v189
    v_and_b32 v21, s99, v189
    v_lshlrev_b32 v22, 16, v209
    v_and_b32 v23, s99, v209
    v_mul_f32 v20, v20, v22
    v_mul_f32 v21, v21, v23
    v_cvt_pk_bf16_f32 v20, v20, v21
    v_dot2_f32_bf16 v24, v20, v25, v24
    v_accvgpr_read_b32 v190, a50
    v_accvgpr_read_b32 v210, a70
    v_lshlrev_b32 v16, 16, v190
    v_and_b32 v17, s99, v190
    v_lshlrev_b32 v18, 16, v210
    v_and_b32 v19, s99, v210
    v_mul_f32 v16, v16, v18
    v_mul_f32 v17, v17, v19
    v_cvt_pk_bf16_f32 v16, v16, v17
    v_dot2_f32_bf16 v24, v16, v25, v24
    v_accvgpr_read_b32 v191, a51
    v_accvgpr_read_b32 v211, a71
    v_lshlrev_b32 v20, 16, v191
    v_and_b32 v21, s99, v191
    v_lshlrev_b32 v22, 16, v211
    v_and_b32 v23, s99, v211
    v_mul_f32 v20, v20, v22
    v_mul_f32 v21, v21, v23
    v_cvt_pk_bf16_f32 v20, v20, v21
    v_dot2_f32_bf16 v24, v20, v25, v24
    v_accvgpr_read_b32 v192, a52
    v_accvgpr_read_b32 v212, a72
    v_lshlrev_b32 v16, 16, v192
    v_and_b32 v17, s99, v192
    v_lshlrev_b32 v18, 16, v212
    v_and_b32 v19, s99, v212
    v_mul_f32 v16, v16, v18
    v_mul_f32 v17, v17, v19
    v_cvt_pk_bf16_f32 v16, v16, v17
    v_dot2_f32_bf16 v24, v16, v25, v24
    v_accvgpr_read_b32 v193, a53
    v_accvgpr_read_b32 v213, a73
    v_lshlrev_b32 v20, 16, v193
    v_and_b32 v21, s99, v193
    v_lshlrev_b32 v22, 16, v213
    v_and_b32 v23, s99, v213
    v_mul_f32 v20, v20, v22
    v_mul_f32 v21, v21, v23
    v_cvt_pk_bf16_f32 v20, v20, v21
    v_dot2_f32_bf16 v24, v20, v25, v24
    v_accvgpr_read_b32 v194, a54
    v_accvgpr_read_b32 v214, a74
    v_lshlrev_b32 v16, 16, v194
    v_and_b32 v17, s99, v194
    v_lshlrev_b32 v18, 16, v214
    v_and_b32 v19, s99, v214
    v_mul_f32 v16, v16, v18
    v_mul_f32 v17, v17, v19
    v_cvt_pk_bf16_f32 v16, v16, v17
    v_dot2_f32_bf16 v24, v16, v25, v24
    v_accvgpr_read_b32 v195, a55
    v_accvgpr_read_b32 v215, a75
    v_lshlrev_b32 v20, 16, v195
    v_and_b32 v21, s99, v195
    v_lshlrev_b32 v22, 16, v215
    v_and_b32 v23, s99, v215
    v_mul_f32 v20, v20, v22
    v_mul_f32 v21, v21, v23
    v_cvt_pk_bf16_f32 v20, v20, v21
    v_dot2_f32_bf16 v24, v20, v25, v24
    v_accvgpr_read_b32 v196, a56
    v_accvgpr_read_b32 v216, a76
    v_lshlrev_b32 v16, 16, v196
    v_and_b32 v17, s99, v196
    v_lshlrev_b32 v18, 16, v216
    v_and_b32 v19, s99, v216
    v_mul_f32 v16, v16, v18
    v_mul_f32 v17, v17, v19
    v_cvt_pk_bf16_f32 v16, v16, v17
    v_dot2_f32_bf16 v24, v16, v25, v24
    v_accvgpr_read_b32 v197, a57
    v_accvgpr_read_b32 v217, a77
    v_lshlrev_b32 v20, 16, v197
    v_and_b32 v21, s99, v197
    v_lshlrev_b32 v22, 16, v217
    v_and_b32 v23, s99, v217
    v_mul_f32 v20, v20, v22
    v_mul_f32 v21, v21, v23
    v_cvt_pk_bf16_f32 v20, v20, v21
    v_dot2_f32_bf16 v24, v20, v25, v24
    v_accvgpr_read_b32 v198, a58
    v_accvgpr_read_b32 v218, a78
    v_lshlrev_b32 v16, 16, v198
    v_and_b32 v17, s99, v198
    v_lshlrev_b32 v18, 16, v218
    v_and_b32 v19, s99, v218
    v_mul_f32 v16, v16, v18
    v_mul_f32 v17, v17, v19
    v_cvt_pk_bf16_f32 v16, v16, v17
    v_dot2_f32_bf16 v24, v16, v25, v24
    v_accvgpr_read_b32 v199, a59
    v_accvgpr_read_b32 v219, a79
    v_lshlrev_b32 v20, 16, v199
    v_and_b32 v21, s99, v199
    v_lshlrev_b32 v22, 16, v219
    v_and_b32 v23, s99, v219
    v_mul_f32 v20, v20, v22
    v_mul_f32 v21, v21, v23
    v_cvt_pk_bf16_f32 v20, v20, v21
    v_dot2_f32_bf16 v24, v20, v25, v24
    s_nop 2
    v_add_f32_dpp v24, v24, v24 row_ror:8 row_mask:0xf bank_mask:0xf
    s_nop 1
    v_add_f32_dpp v24, v24, v24 row_ror:4 row_mask:0xf bank_mask:0xf
    s_nop 1
    v_add_f32_dpp v24, v24, v24 row_ror:2 row_mask:0xf bank_mask:0xf
    s_nop 1
    v_add_f32_dpp v24, v24, v24 row_ror:1 row_mask:0xf bank_mask:0xf
    v_cvt_pk_bf16_f32 v24, v24, v24
    v_lshlrev_b32 v24, 16, v24
    v_mul_f32 v24, 0xbfb8aa3b, v24
    v_exp_f32 v24, v24
    v_mov_b32 v33, s78
    v_add_f32 v24, 1.0, v24
    v_rcp_f32 v24, v24
    v_mov_b32 v35, s78
    v_cvt_pk_bf16_f32 v24, v24, v24
    v_lshlrev_b32 v32, 16, v24
    v_sub_f32 v25, 1.0, v32
    v_cvt_pk_bf16_f32 v25, v25, v25
    v_lshlrev_b32 v34, 16, v25
    v_lshlrev_b32 v12, 4, v12
    v_add_u32 v12, 65536, v12
    buffer_store_dwordx4 v[32:35], v12, s[12:15], 0 offen sc1
    s_mov_b32 s64, 0x20000
    s_mov_b32 s65, 0x0
    s_waitcnt vmcnt(1)
    buffer_store_dword v253, v254, s[12:15], s64 offen
    buffer_store_dword v253, v254, s[12:15], s65 offen sc1
    s_mov_b32 s64, 0x20000
    buffer_load_dword v5, v4, s[12:15], s64 offen sc1
    s_waitcnt vmcnt(0)
    v_cmp_ne_u32 vcc, s78, v5
    s_nop 0
    s_cmp_eq_u64 vcc, 0
    s_cbranch_scc0 L_h00_retry_19
L_h00_ok_20:
    buffer_load_dwordx4 v[96:99], v2, s[36:39], s58 offen offset:0 sc1
    buffer_load_dwordx4 v[100:103], v2, s[36:39], s58 offen offset:1024 sc1
    buffer_load_dwordx4 v[104:107], v2, s[36:39], s58 offen offset:2048 sc1
    buffer_load_dwordx4 v[108:111], v2, s[36:39], s58 offen offset:3072 sc1
    buffer_load_dwordx4 v[112:115], v2, s[36:39], s59 offen offset:0 sc1
    buffer_load_dwordx4 v[116:119], v2, s[36:39], s59 offen offset:1024 sc1
    buffer_load_dwordx4 v[120:123], v2, s[36:39], s59 offen offset:2048 sc1
    buffer_load_dwordx4 v[124:127], v2, s[36:39], s59 offen offset:3072 sc1
    buffer_load_dwordx4 v[128:131], v2, s[36:39], s60 offen offset:0 sc1
    buffer_load_dwordx4 v[132:135], v2, s[36:39], s60 offen offset:1024 sc1
    buffer_load_dwordx4 v[136:139], v2, s[36:39], s60 offen offset:2048 sc1
    buffer_load_dwordx4 v[140:143], v2, s[36:39], s60 offen offset:3072 sc1
    s_waitcnt vmcnt(11)
    v_mfma_f32_16x16x32_bf16 v[16:19], a[160:163], v[96:99], 0
    buffer_load_dwordx4 v[144:147], v2, s[36:39], s61 offen offset:0 sc1
    v_mfma_f32_16x16x32_bf16 v[20:23], a[164:167], v[96:99], 0
    s_lshl_b32 s98, s74, 3
    s_add_u32 s98, s98, s72
    v_mfma_f32_16x16x32_bf16 v[24:27], a[168:171], v[96:99], 0
    buffer_load_dwordx4 a[152:155], v2, s[32:35], s51 offen offset:3072 sc1
    s_lshl_b32 s98, s98, 4
    v_mfma_f32_16x16x32_bf16 v[28:31], a[172:175], v[96:99], 0
    s_mul_i32 s99, s75, 160
    s_mul_i32 s100, s72, 5376
    v_mfma_f32_16x16x32_bf16 v[32:35], a[176:179], v[96:99], 0
    s_mov_b32 s92, 0xffff0000
    s_waitcnt vmcnt(12)
    v_mfma_f32_16x16x32_bf16 v[36:39], a[160:163], v[100:103], 0
    buffer_load_dwordx4 v[148:151], v2, s[36:39], s61 offen offset:1024 sc1
    s_mov_b32 s101, 81920
    v_mfma_f32_16x16x32_bf16 v[40:43], a[164:167], v[100:103], 0
    buffer_load_dwordx4 a[156:159], v3, s[32:35], s51 offen offset:0 sc1
    v_mfma_f32_16x16x32_bf16 v[44:47], a[168:171], v[100:103], 0
    v_bfe_u32 v180, v1, 4, 1
    v_mfma_f32_16x16x32_bf16 v[48:51], a[172:175], v[100:103], 0
    v_and_b32 v181, 15, v1
    v_mfma_f32_16x16x32_bf16 v[52:55], a[176:179], v[100:103], 0
    s_waitcnt vmcnt(13)
    v_mfma_f32_16x16x32_bf16 v[56:59], a[160:163], v[104:107], 0
    buffer_load_dwordx4 v[152:155], v2, s[36:39], s61 offen offset:2048 sc1
    buffer_load_dwordx4 a[0:3], v2, s[32:35], s52 offen offset:0 sc1
    v_lshl_add_u32 v180, v180, 6, v181
    v_mfma_f32_16x16x32_bf16 v[60:63], a[164:167], v[104:107], 0
    v_add_u32 v180, s98, v180
    v_lshlrev_b32 v180, 4, v180
    v_mfma_f32_16x16x32_bf16 v[64:67], a[168:171], v[104:107], 0
    v_add_u32 v165, 65536, v180
    v_mfma_f32_16x16x32_bf16 v[68:71], a[172:175], v[104:107], 0
    v_add_u32 v180, 0, v1
    v_mfma_f32_16x16x32_bf16 v[72:75], a[176:179], v[104:107], 0
    buffer_load_dwordx4 a[4:7], v2, s[32:35], s52 offen offset:1024 sc1
    v_mul_u32_u24 v181, 3277, v180
    s_waitcnt vmcnt(15)
    v_mfma_f32_16x16x32_bf16 v[76:79], a[160:163], v[108:111], 0
    buffer_load_dwordx4 v[156:159], v2, s[36:39], s61 offen offset:3072 sc1
    v_lshrrev_b32 v181, 16, v181
    v_mfma_f32_16x16x32_bf16 v[80:83], a[164:167], v[108:111], 0
    v_mul_u32_u24 v182, 20, v181
    v_sub_u32 v182, v180, v182
    v_mfma_f32_16x16x32_bf16 v[84:87], a[168:171], v[108:111], 0
    v_lshrrev_b32 v183, 2, v182
    v_mfma_f32_16x16x32_bf16 v[88:91], a[172:175], v[108:111], 0
    buffer_load_dwordx4 a[8:11], v2, s[32:35], s52 offen offset:2048 sc1
    v_mul_u32_u24 v7, 272, v183
    v_mfma_f32_16x16x32_bf16 v[92:95], a[176:179], v[108:111], 0
    v_and_b32 v183, 3, v182
    s_waitcnt vmcnt(16)
    v_mfma_f32_16x16x32_bf16 v[16:19], a[180:183], v[112:115], v[16:19]
    buffer_load_dwordx4 v[96:99], v2, s[36:39], s62 offen offset:0 sc1
    v_mul_u32_u24 v183, 1344, v183
    v_mfma_f32_16x16x32_bf16 v[20:23], a[184:187], v[112:115], v[20:23]
    v_add3_u32 v7, v7, v183, s100
    v_mfma_f32_16x16x32_bf16 v[24:27], a[188:191], v[112:115], v[24:27]
    buffer_load_dwordx4 a[12:15], v2, s[32:35], s52 offen offset:3072 sc1
    v_lshl_add_u32 v7, v181, 4, v7
    v_mfma_f32_16x16x32_bf16 v[28:31], a[192:195], v[112:115], v[28:31]
    v_lshlrev_b32 v160, 2, v181
    v_add_u32 v181, s98, v181
    v_mfma_f32_16x16x32_bf16 v[32:35], a[196:199], v[112:115], v[32:35]
    v_lshl_add_u32 v182, v182, 3, s99
    s_waitcnt vmcnt(17)
    v_mfma_f32_16x16x32_bf16 v[36:39], a[180:183], v[116:119], v[36:39]
    buffer_load_dwordx4 v[100:103], v2, s[36:39], s62 offen offset:1024 sc1
    v_mul_u32_u24 v180, 1280, v181
    v_mfma_f32_16x16x32_bf16 v[40:43], a[184:187], v[116:119], v[40:43]
    buffer_load_dwordx4 a[16:19], v3, s[32:35], s52 offen offset:0 sc1
    v_add_u32 v180, v180, v182
    v_mfma_f32_16x16x32_bf16 v[44:47], a[188:191], v[116:119], v[44:47]
    v_add_u32 v180, s101, v180
    v_lshlrev_b32 v12, 1, v180
    v_mfma_f32_16x16x32_bf16 v[48:51], a[192:195], v[116:119], v[48:51]
    v_add_u32 v180, 64, v1
    v_mfma_f32_16x16x32_bf16 v[52:55], a[196:199], v[116:119], v[52:55]
    v_mul_u32_u24 v181, 3277, v180
    s_waitcnt vmcnt(18)
    v_mfma_f32_16x16x32_bf16 v[56:59], a[180:183], v[120:123], v[56:59]
    buffer_load_dwordx4 v[104:107], v2, s[36:39], s62 offen offset:2048 sc1
    buffer_load_dwordx4 a[20:23], v2, s[32:35], s53 offen offset:0 sc1
    v_lshrrev_b32 v181, 16, v181
    v_mfma_f32_16x16x32_bf16 v[60:63], a[184:187], v[120:123], v[60:63]
    v_mul_u32_u24 v182, 20, v181
    v_sub_u32 v182, v180, v182
    v_mfma_f32_16x16x32_bf16 v[64:67], a[188:191], v[120:123], v[64:67]
    v_lshrrev_b32 v183, 2, v182
    v_mfma_f32_16x16x32_bf16 v[68:71], a[192:195], v[120:123], v[68:71]
    v_mul_u32_u24 v8, 272, v183
    v_mfma_f32_16x16x32_bf16 v[72:75], a[196:199], v[120:123], v[72:75]
    buffer_load_dwordx4 a[24:27], v2, s[32:35], s53 offen offset:1024 sc1
    v_and_b32 v183, 3, v182
    s_waitcnt vmcnt(20)
    v_mfma_f32_16x16x32_bf16 v[76:79], a[180:183], v[124:127], v[76:79]
    buffer_load_dwordx4 v[108:111], v2, s[36:39], s62 offen offset:3072 sc1
    v_mul_u32_u24 v183, 1344, v183
    v_mfma_f32_16x16x32_bf16 v[80:83], a[184:187], v[124:127], v[80:83]
    v_add3_u32 v8, v8, v183, s100
    v_mfma_f32_16x16x32_bf16 v[84:87], a[188:191], v[124:127], v[84:87]
    v_lshl_add_u32 v8, v181, 4, v8
    v_mfma_f32_16x16x32_bf16 v[88:91], a[192:195], v[124:127], v[88:91]
    buffer_load_dwordx4 a[28:31], v2, s[32:35], s53 offen offset:2048 sc1
    v_lshlrev_b32 v161, 2, v181
    v_add_u32 v181, s98, v181
    v_mfma_f32_16x16x32_bf16 v[92:95], a[196:199], v[124:127], v[92:95]
    v_lshl_add_u32 v182, v182, 3, s99
    s_waitcnt vmcnt(21)
    v_mfma_f32_16x16x32_bf16 v[16:19], a[200:203], v[128:131], v[16:19]
    buffer_load_dwordx4 v[112:115], v2, s[36:39], s63 offen offset:0 sc1
    v_mul_u32_u24 v180, 1280, v181
    v_mfma_f32_16x16x32_bf16 v[20:23], a[204:207], v[128:131], v[20:23]
    v_add_u32 v180, v180, v182
    v_add_u32 v180, s101, v180
    v_mfma_f32_16x16x32_bf16 v[24:27], a[208:211], v[128:131], v[24:27]
    buffer_load_dwordx4 a[32:35], v2, s[32:35], s53 offen offset:3072 sc1
    v_lshlrev_b32 v13, 1, v180
    v_mfma_f32_16x16x32_bf16 v[28:31], a[212:215], v[128:131], v[28:31]
    v_add_u32 v180, 128, v1
    v_mfma_f32_16x16x32_bf16 v[32:35], a[216:219], v[128:131], v[32:35]
    v_mul_u32_u24 v181, 3277, v180
    s_waitcnt vmcnt(22)
    v_mfma_f32_16x16x32_bf16 v[36:39], a[200:203], v[132:135], v[36:39]
    buffer_load_dwordx4 v[116:119], v2, s[36:39], s63 offen offset:1024 sc1
    v_lshrrev_b32 v181, 16, v181
    v_mfma_f32_16x16x32_bf16 v[40:43], a[204:207], v[132:135], v[40:43]
    buffer_load_dwordx4 a[36:39], v3, s[32:35], s53 offen offset:0 sc1
    v_mul_u32_u24 v182, 20, v181
    v_sub_u32 v182, v180, v182
    v_mfma_f32_16x16x32_bf16 v[44:47], a[208:211], v[132:135], v[44:47]
    v_lshrrev_b32 v183, 2, v182
    v_mfma_f32_16x16x32_bf16 v[48:51], a[212:215], v[132:135], v[48:51]
    v_mul_u32_u24 v9, 272, v183
    v_mfma_f32_16x16x32_bf16 v[52:55], a[216:219], v[132:135], v[52:55]
    v_and_b32 v183, 3, v182
    s_waitcnt vmcnt(23)
    v_mfma_f32_16x16x32_bf16 v[56:59], a[200:203], v[136:139], v[56:59]
    buffer_load_dwordx4 v[120:123], v2, s[36:39], s63 offen offset:2048 sc1
    v_mul_u32_u24 v183, 1344, v183
    v_mfma_f32_16x16x32_bf16 v[60:63], a[204:207], v[136:139], v[60:63]
    v_add3_u32 v9, v9, v183, s100
    v_lshl_add_u32 v9, v181, 4, v9
    v_mfma_f32_16x16x32_bf16 v[64:67], a[208:211], v[136:139], v[64:67]
    v_lshlrev_b32 v162, 2, v181
    v_add_u32 v181, s98, v181
    v_mfma_f32_16x16x32_bf16 v[68:71], a[212:215], v[136:139], v[68:71]
    v_lshl_add_u32 v182, v182, 3, s99
    v_mfma_f32_16x16x32_bf16 v[72:75], a[216:219], v[136:139], v[72:75]
    s_waitcnt vmcnt(23)
    v_mfma_f32_16x16x32_bf16 v[76:79], a[200:203], v[140:143], v[76:79]
    buffer_load_dwordx4 v[124:127], v2, s[36:39], s63 offen offset:3072 sc1
    v_mul_u32_u24 v180, 1280, v181
    v_mfma_f32_16x16x32_bf16 v[80:83], a[204:207], v[140:143], v[80:83]
    v_add_u32 v180, v180, v182
    v_add_u32 v180, s101, v180
    v_mfma_f32_16x16x32_bf16 v[84:87], a[208:211], v[140:143], v[84:87]
    v_lshlrev_b32 v14, 1, v180
    v_mfma_f32_16x16x32_bf16 v[88:91], a[212:215], v[140:143], v[88:91]
    v_add_u32 v180, 192, v1
    v_mfma_f32_16x16x32_bf16 v[92:95], a[216:219], v[140:143], v[92:95]
    v_mul_u32_u24 v181, 3277, v180
    s_waitcnt vmcnt(23)
    v_mfma_f32_16x16x32_bf16 v[16:19], a[220:223], v[144:147], v[16:19]
    buffer_load_dwordx4 v[128:131], v2, s[36:39], s66 offen offset:0 sc1
    v_lshrrev_b32 v181, 16, v181
    v_mfma_f32_16x16x32_bf16 v[20:23], a[224:227], v[144:147], v[20:23]
    v_mul_u32_u24 v182, 20, v181
    v_sub_u32 v182, v180, v182
    v_mfma_f32_16x16x32_bf16 v[24:27], a[228:231], v[144:147], v[24:27]
    v_lshrrev_b32 v183, 2, v182
    v_mfma_f32_16x16x32_bf16 v[28:31], a[232:235], v[144:147], v[28:31]
    v_mul_u32_u24 v10, 272, v183
    v_mfma_f32_16x16x32_bf16 v[32:35], a[236:239], v[144:147], v[32:35]
    v_and_b32 v183, 3, v182
    v_mul_u32_u24 v183, 1344, v183
    s_waitcnt vmcnt(22)
    v_mfma_f32_16x16x32_bf16 v[36:39], a[220:223], v[148:151], v[36:39]
    buffer_load_dwordx4 v[132:135], v2, s[36:39], s66 offen offset:1024 sc1
    v_add3_u32 v10, v10, v183, s100
    v_mfma_f32_16x16x32_bf16 v[40:43], a[224:227], v[148:151], v[40:43]
    v_lshl_add_u32 v10, v181, 4, v10
    v_mfma_f32_16x16x32_bf16 v[44:47], a[228:231], v[148:151], v[44:47]
    v_lshlrev_b32 v163, 2, v181
    v_add_u32 v181, s98, v181
    v_mfma_f32_16x16x32_bf16 v[48:51], a[232:235], v[148:151], v[48:51]
    v_lshl_add_u32 v182, v182, 3, s99
    v_mfma_f32_16x16x32_bf16 v[52:55], a[236:239], v[148:151], v[52:55]
    s_waitcnt vmcnt(21)
    v_mfma_f32_16x16x32_bf16 v[56:59], a[220:223], v[152:155], v[56:59]
    buffer_load_dwordx4 v[136:139], v2, s[36:39], s66 offen offset:2048 sc1
    v_mul_u32_u24 v180, 1280, v181
    v_mfma_f32_16x16x32_bf16 v[60:63], a[224:227], v[152:155], v[60:63]
    v_add_u32 v180, v180, v182
    v_add_u32 v180, s101, v180
    v_mfma_f32_16x16x32_bf16 v[64:67], a[228:231], v[152:155], v[64:67]
    v_lshlrev_b32 v15, 1, v180
    v_mfma_f32_16x16x32_bf16 v[68:71], a[232:235], v[152:155], v[68:71]
    v_add_u32 v180, 256, v1
    v_mfma_f32_16x16x32_bf16 v[72:75], a[236:239], v[152:155], v[72:75]
    v_mul_u32_u24 v181, 3277, v180
    s_waitcnt vmcnt(19)
    v_mfma_f32_16x16x32_bf16 v[76:79], a[220:223], v[156:159], v[76:79]
    buffer_load_dwordx4 v[140:143], v2, s[36:39], s66 offen offset:3072 sc1
    v_lshrrev_b32 v181, 16, v181
    v_mul_u32_u24 v182, 20, v181
    v_mfma_f32_16x16x32_bf16 v[80:83], a[224:227], v[156:159], v[80:83]
    v_sub_u32 v182, v180, v182
    v_lshrrev_b32 v183, 2, v182
    v_mfma_f32_16x16x32_bf16 v[84:87], a[228:231], v[156:159], v[84:87]
    v_mul_u32_u24 v11, 272, v183
    v_mfma_f32_16x16x32_bf16 v[88:91], a[232:235], v[156:159], v[88:91]
    v_and_b32 v183, 3, v182
    v_mfma_f32_16x16x32_bf16 v[92:95], a[236:239], v[156:159], v[92:95]
    s_barrier
    v_mul_u32_u24 v183, 1344, v183
    s_waitcnt vmcnt(18)
    v_mfma_f32_16x16x32_bf16 v[16:19], a[80:83], v[96:99], v[16:19]
    buffer_load_dwordx4 v[144:147], v2, s[36:39], s67 offen offset:0 sc1
    v_add3_u32 v11, v11, v183, s100
    v_mfma_f32_16x16x32_bf16 v[20:23], a[84:87], v[96:99], v[20:23]
    v_lshl_add_u32 v11, v181, 4, v11
    v_mfma_f32_16x16x32_bf16 v[24:27], a[88:91], v[96:99], v[24:27]
    v_lshlrev_b32 v164, 2, v181
    v_add_u32 v181, s98, v181
    v_mfma_f32_16x16x32_bf16 v[28:31], a[92:95], v[96:99], v[28:31]
    v_lshl_add_u32 v182, v182, 3, s99
    v_mfma_f32_16x16x32_bf16 v[32:35], a[96:99], v[96:99], v[32:35]
    s_waitcnt vmcnt(17)
    v_mfma_f32_16x16x32_bf16 v[36:39], a[80:83], v[100:103], v[36:39]
    buffer_load_dwordx4 v[148:151], v2, s[36:39], s67 offen offset:1024 sc1
    v_mul_u32_u24 v180, 1280, v181
    v_add_u32 v180, v180, v182
    v_mfma_f32_16x16x32_bf16 v[40:43], a[84:87], v[100:103], v[40:43]
    v_add_u32 v180, s101, v180
    v_lshlrev_b32 v0, 1, v180
    v_mfma_f32_16x16x32_bf16 v[44:47], a[88:91], v[100:103], v[44:47]
    s_mul_i32 s98, s72, 21504
    v_lshrrev_b32 v6, 4, v1
    v_mfma_f32_16x16x32_bf16 v[48:51], a[92:95], v[100:103], v[48:51]
    v_mul_u32_u24 v6, 1344, v6
    v_mfma_f32_16x16x32_bf16 v[52:55], a[96:99], v[100:103], v[52:55]
    v_and_b32 v181, 15, v1
    s_waitcnt vmcnt(16)
    v_mfma_f32_16x16x32_bf16 v[56:59], a[80:83], v[104:107], v[56:59]
    buffer_load_dwordx4 v[152:155], v2, s[36:39], s67 offen offset:2048 sc1
    v_mfma_f32_16x16x32_bf16 v[60:63], a[84:87], v[104:107], v[60:63]
    v_lshl_add_u32 v6, v181, 4, v6
    v_mfma_f32_16x16x32_bf16 v[64:67], a[88:91], v[104:107], v[64:67]
    v_add_u32 v6, s98, v6
    s_lshl_b32 s98, s76, 2
    v_mfma_f32_16x16x32_bf16 v[68:71], a[92:95], v[104:107], v[68:71]
    s_add_u32 s98, s98, s72
    s_mul_i32 s98, s98, 5120
    v_mfma_f32_16x16x32_bf16 v[72:75], a[96:99], v[104:107], v[72:75]
    s_add_u32 s90, s98, 0x1000000
    s_waitcnt vmcnt(14)
    v_mfma_f32_16x16x32_bf16 v[76:79], a[80:83], v[108:111], v[76:79]
    buffer_load_dwordx4 v[156:159], v2, s[36:39], s67 offen offset:3072 sc1
    s_add_u32 s91, s98, 0x1280000
    v_mfma_f32_16x16x32_bf16 v[80:83], a[84:87], v[108:111], v[80:83]
    s_lshl_b32 s79, s73, 7
    s_add_u32 s79, s79, s76
    v_mfma_f32_16x16x32_bf16 v[84:87], a[88:91], v[108:111], v[84:87]
    s_lshl_b32 s79, s79, 2
    s_add_u32 s79, s79, s72
    v_mfma_f32_16x16x32_bf16 v[88:91], a[92:95], v[108:111], v[88:91]
    s_lshl_b32 s79, s79, 7
    s_add_u32 s79, s79, 917504
    v_mov_b32 v252, s79
    v_mfma_f32_16x16x32_bf16 v[92:95], a[96:99], v[108:111], v[92:95]
    s_waitcnt vmcnt(13)
    v_mfma_f32_16x16x32_bf16 v[16:19], a[100:103], v[112:115], v[16:19]
    buffer_load_dwordx4 v[96:99], v2, s[36:39], s68 offen offset:0 sc1
    v_mfma_f32_16x16x32_bf16 v[20:23], a[104:107], v[112:115], v[20:23]
    v_lshlrev_b32 v180, 16, v222
    v_and_b32 v181, s92, v222
    v_mfma_f32_16x16x32_bf16 v[24:27], a[108:111], v[112:115], v[24:27]
    v_lshlrev_b32 v182, 16, v242
    v_and_b32 v183, s92, v242
    v_mfma_f32_16x16x32_bf16 v[28:31], a[112:115], v[112:115], v[28:31]
    buffer_load_dwordx3 v[166:168], v165, s[12:15], 0 offen sc1
    v_mul_f32 v180, v180, v182
    v_mfma_f32_16x16x32_bf16 v[32:35], a[116:119], v[112:115], v[32:35]
    buffer_load_dwordx4 v[100:103], v2, s[36:39], s68 offen offset:1024 sc1
    s_waitcnt vmcnt(14)
    v_mfma_f32_16x16x32_bf16 v[36:39], a[100:103], v[116:119], v[36:39]
    v_mul_f32 v181, v181, v183
    v_mfma_f32_16x16x32_bf16 v[40:43], a[104:107], v[116:119], v[40:43]
    v_cvt_pk_bf16_f32 v180, v180, v181
    v_mfma_f32_16x16x32_bf16 v[44:47], a[108:111], v[116:119], v[44:47]
    v_lshlrev_b32 v192, 16, v180
    v_and_b32 v193, s92, v180
    v_mfma_f32_16x16x32_bf16 v[48:51], a[112:115], v[116:119], v[48:51]
    buffer_load_dwordx4 v[104:107], v2, s[36:39], s68 offen offset:2048 sc1
    v_lshlrev_b32 v180, 16, v223
    v_mfma_f32_16x16x32_bf16 v[52:55], a[116:119], v[116:119], v[52:55]
    v_and_b32 v181, s92, v223
    s_waitcnt vmcnt(13)
    v_mfma_f32_16x16x32_bf16 v[56:59], a[100:103], v[120:123], v[56:59]
    v_lshlrev_b32 v182, 16, v243
    v_and_b32 v183, s92, v243
    v_mfma_f32_16x16x32_bf16 v[60:63], a[104:107], v[120:123], v[60:63]
    v_mul_f32 v180, v180, v182
    v_mul_f32 v181, v181, v183
    v_mfma_f32_16x16x32_bf16 v[64:67], a[108:111], v[120:123], v[64:67]
    buffer_load_dwordx4 v[108:111], v2, s[36:39], s68 offen offset:3072 sc1
    v_cvt_pk_bf16_f32 v180, v180, v181
    v_mfma_f32_16x16x32_bf16 v[68:71], a[112:115], v[120:123], v[68:71]
    v_lshlrev_b32 v194, 16, v180
    v_and_b32 v195, s92, v180
    v_mfma_f32_16x16x32_bf16 v[72:75], a[116:119], v[120:123], v[72:75]
    v_lshlrev_b32 v180, 16, v224
    v_and_b32 v181, s92, v224
    s_waitcnt vmcnt(13)
    v_mfma_f32_16x16x32_bf16 v[76:79], a[100:103], v[124:127], v[76:79]
    v_lshlrev_b32 v182, 16, v244
    v_and_b32 v183, s92, v244
    v_mfma_f32_16x16x32_bf16 v[80:83], a[104:107], v[124:127], v[80:83]
    v_mul_f32 v180, v180, v182
    v_mul_f32 v181, v181, v183
    v_mfma_f32_16x16x32_bf16 v[84:87], a[108:111], v[124:127], v[84:87]
    v_cvt_pk_bf16_f32 v180, v180, v181
    v_mfma_f32_16x16x32_bf16 v[88:91], a[112:115], v[124:127], v[88:91]
    v_lshlrev_b32 v196, 16, v180
    v_and_b32 v197, s92, v180
    v_mfma_f32_16x16x32_bf16 v[92:95], a[116:119], v[124:127], v[92:95]
    v_lshlrev_b32 v180, 16, v225
    s_waitcnt vmcnt(12)
    v_mfma_f32_16x16x32_bf16 v[16:19], a[120:123], v[128:131], v[16:19]
    buffer_load_dwordx4 v[112:115], v2, s[36:39], s69 offen offset:0 sc1
    v_and_b32 v181, s92, v225
    v_mfma_f32_16x16x32_bf16 v[20:23], a[124:127], v[128:131], v[20:23]
    v_lshlrev_b32 v182, 16, v245
    v_and_b32 v183, s92, v245
    v_mfma_f32_16x16x32_bf16 v[24:27], a[128:131], v[128:131], v[24:27]
    v_mul_f32 v180, v180, v182
    v_mul_f32 v181, v181, v183
    v_mfma_f32_16x16x32_bf16 v[28:31], a[132:135], v[128:131], v[28:31]
    buffer_load_dwordx4 v[116:119], v2, s[36:39], s69 offen offset:1024 sc1
    v_cvt_pk_bf16_f32 v180, v180, v181
    v_mfma_f32_16x16x32_bf16 v[32:35], a[136:139], v[128:131], v[32:35]
    v_lshlrev_b32 v198, 16, v180
    v_and_b32 v199, s92, v180
    s_waitcnt vmcnt(13)
    v_mfma_f32_16x16x32_bf16 v[36:39], a[120:123], v[132:135], v[36:39]
    v_lshlrev_b32 v180, 16, v226
    v_and_b32 v181, s92, v226
    v_mfma_f32_16x16x32_bf16 v[40:43], a[124:127], v[132:135], v[40:43]
    buffer_load_dwordx4 v[120:123], v2, s[36:39], s69 offen offset:2048 sc1
    v_lshlrev_b32 v182, 16, v246
    v_mfma_f32_16x16x32_bf16 v[44:47], a[128:131], v[132:135], v[44:47]
    v_and_b32 v183, s92, v246
    v_mul_f32 v180, v180, v182
    v_mfma_f32_16x16x32_bf16 v[48:51], a[132:135], v[132:135], v[48:51]
    v_mul_f32 v181, v181, v183
    v_cvt_pk_bf16_f32 v180, v180, v181
    v_mfma_f32_16x16x32_bf16 v[52:55], a[136:139], v[132:135], v[52:55]
    buffer_load_dwordx4 v[124:127], v2, s[36:39], s69 offen offset:3072 sc1
    v_lshlrev_b32 v200, 16, v180
    s_waitcnt vmcnt(14)
    v_mfma_f32_16x16x32_bf16 v[56:59], a[120:123], v[136:139], v[56:59]
    v_and_b32 v201, s92, v180
    v_lshlrev_b32 v180, 16, v227
    v_mfma_f32_16x16x32_bf16 v[60:63], a[124:127], v[136:139], v[60:63]
    v_and_b32 v181, s92, v227
    v_lshlrev_b32 v182, 16, v247
    v_mfma_f32_16x16x32_bf16 v[64:67], a[128:131], v[136:139], v[64:67]
    v_and_b32 v183, s92, v247
    v_mul_f32 v180, v180, v182
    v_mfma_f32_16x16x32_bf16 v[68:71], a[132:135], v[136:139], v[68:71]
    v_mul_f32 v181, v181, v183
    v_mfma_f32_16x16x32_bf16 v[72:75], a[136:139], v[136:139], v[72:75]
    v_cvt_pk_bf16_f32 v180, v180, v181
    s_waitcnt vmcnt(13)
    v_mfma_f32_16x16x32_bf16 v[76:79], a[120:123], v[140:143], v[76:79]
    v_lshlrev_b32 v202, 16, v180
    v_and_b32 v203, s92, v180
    v_mfma_f32_16x16x32_bf16 v[80:83], a[124:127], v[140:143], v[80:83]
    v_lshlrev_b32 v180, 16, v228
    v_and_b32 v181, s92, v228
    v_mfma_f32_16x16x32_bf16 v[84:87], a[128:131], v[140:143], v[84:87]
    v_lshlrev_b32 v182, 16, v248
    v_and_b32 v183, s92, v248
    v_mfma_f32_16x16x32_bf16 v[88:91], a[132:135], v[140:143], v[88:91]
    v_mul_f32 v180, v180, v182
    v_mul_f32 v181, v181, v183
    v_mfma_f32_16x16x32_bf16 v[92:95], a[136:139], v[140:143], v[92:95]
    v_cvt_pk_bf16_f32 v180, v180, v181
    s_waitcnt vmcnt(12)
    v_mfma_f32_16x16x32_bf16 v[16:19], a[140:143], v[144:147], v[16:19]
    buffer_load_dwordx4 v[128:131], v3, s[36:39], s58 offen offset:0 sc1
    v_lshlrev_b32 v204, 16, v180
    v_mfma_f32_16x16x32_bf16 v[20:23], a[144:147], v[144:147], v[20:23]
    v_xor_b32 v4, 65536, v252
    v_and_b32 v205, s92, v180
    v_lshlrev_b32 v180, 16, v229
    v_mfma_f32_16x16x32_bf16 v[24:27], a[148:151], v[144:147], v[24:27]
    v_and_b32 v181, s92, v229
    v_lshlrev_b32 v182, 16, v249
    v_mfma_f32_16x16x32_bf16 v[28:31], a[152:155], v[144:147], v[28:31]
    v_and_b32 v183, s92, v249
    v_mul_f32 v180, v180, v182
    v_mfma_f32_16x16x32_bf16 v[32:35], a[156:159], v[144:147], v[32:35]
    v_mul_f32 v181, v181, v183
    s_waitcnt vmcnt(12)
    v_mfma_f32_16x16x32_bf16 v[36:39], a[140:143], v[148:151], v[36:39]
    buffer_load_dwordx4 v[132:135], v3, s[36:39], s58 offen offset:1024 sc1
    v_cvt_pk_bf16_f32 v180, v180, v181
    v_mfma_f32_16x16x32_bf16 v[40:43], a[144:147], v[148:151], v[40:43]
    v_lshlrev_b32 v206, 16, v180
    v_and_b32 v207, s92, v180
    v_mfma_f32_16x16x32_bf16 v[44:47], a[148:151], v[148:151], v[44:47]
    v_lshlrev_b32 v180, 16, v230
    v_and_b32 v181, s92, v230
    v_mfma_f32_16x16x32_bf16 v[48:51], a[152:155], v[148:151], v[48:51]
    v_lshlrev_b32 v182, 16, v250
    v_and_b32 v183, s92, v250
    v_mfma_f32_16x16x32_bf16 v[52:55], a[156:159], v[148:151], v[52:55]
    s_waitcnt vmcnt(9)
    v_cmp_ne_u32 vcc, s78, v167
    s_nop 0
    s_cmp_eq_u64 vcc, 0
    s_cbranch_scc0 L_gt_retry_21
L_gt_ok_22:
    v_mul_f32 v180, v180, v182
    v_mfma_f32_16x16x32_bf16 v[56:59], a[140:143], v[152:155], v[56:59]
    buffer_load_dwordx4 v[136:139], v3, s[36:39], s58 offen offset:2048 sc1
    ds_bpermute_b32 v212, v160, v166 offset:0
    v_mul_f32 v181, v181, v183
    v_cvt_pk_bf16_f32 v180, v180, v181
    v_mfma_f32_16x16x32_bf16 v[60:63], a[144:147], v[152:155], v[60:63]
    ds_bpermute_b32 v217, v160, v166 offset:64
    v_lshlrev_b32 v208, 16, v180
    v_mfma_f32_16x16x32_bf16 v[64:67], a[148:151], v[152:155], v[64:67]
    ds_bpermute_b32 v213, v161, v166 offset:0
    v_and_b32 v209, s92, v180
    v_lshlrev_b32 v180, 16, v231
    v_mfma_f32_16x16x32_bf16 v[68:71], a[152:155], v[152:155], v[68:71]
    ds_bpermute_b32 v218, v161, v166 offset:64
    v_and_b32 v181, s92, v231
    v_mfma_f32_16x16x32_bf16 v[72:75], a[156:159], v[152:155], v[72:75]
    ds_bpermute_b32 v214, v162, v166 offset:0
    v_lshlrev_b32 v182, 16, v251
    v_and_b32 v183, s92, v251
    v_mfma_f32_16x16x32_bf16 v[76:79], a[140:143], v[156:159], v[76:79]
    buffer_load_dwordx4 v[140:143], v3, s[36:39], s58 offen offset:3072 sc1
    ds_bpermute_b32 v219, v162, v166 offset:64
    v_mul_f32 v180, v180, v182
    v_mul_f32 v181, v181, v183
    v_cvt_pk_bf16_f32 v180, v180, v181
    v_lshlrev_b32 v210, 16, v180
    v_and_b32 v211, s92, v180
    v_mfma_f32_16x16x32_bf16 v[80:83], a[144:147], v[156:159], v[80:83]
    ds_bpermute_b32 v215, v163, v166 offset:0
    v_mfma_f32_16x16x32_bf16 v[84:87], a[148:151], v[156:159], v[84:87]
    ds_bpermute_b32 v220, v163, v166 offset:64
    v_mfma_f32_16x16x32_bf16 v[88:91], a[152:155], v[156:159], v[88:91]
    ds_bpermute_b32 v216, v164, v166 offset:0
    v_mfma_f32_16x16x32_bf16 v[92:95], a[156:159], v[156:159], v[92:95]
    ds_bpermute_b32 v221, v164, v166 offset:64
    v_mfma_f32_16x16x32_bf16 v[16:19], a[0:3], v[96:99], v[16:19]
    buffer_load_dwordx4 v[144:147], v3, s[36:39], s59 offen offset:0 sc1
    v_mfma_f32_16x16x32_bf16 v[20:23], a[4:7], v[96:99], v[20:23]
    s_waitcnt vmcnt(8)
    v_mfma_f32_16x16x32_bf16 v[16:19], a[20:23], v[112:115], v[16:19]
    v_mfma_f32_16x16x32_bf16 v[20:23], a[24:27], v[112:115], v[20:23]
    v_mfma_f32_16x16x32_bf16 v[24:27], a[8:11], v[96:99], v[24:27]
    v_mfma_f32_16x16x32_bf16 v[28:31], a[12:15], v[96:99], v[28:31]
    buffer_load_dwordx4 v[148:151], v3, s[36:39], s59 offen offset:1024 sc1
    v_mfma_f32_16x16x32_bf16 v[24:27], a[28:31], v[112:115], v[24:27]
    v_mfma_f32_16x16x32_bf16 v[28:31], a[32:35], v[112:115], v[28:31]
    v_mfma_f32_16x16x32_bf16 v[32:35], a[16:19], v[96:99], v[32:35]
    s_nop 0
    ds_write_b128 v6, v[16:19] offset:0
    v_mfma_f32_16x16x32_bf16 v[36:39], a[0:3], v[100:103], v[36:39]
    v_mfma_f32_16x16x32_bf16 v[32:35], a[36:39], v[112:115], v[32:35]
    buffer_load_dwordx4 v[152:155], v3, s[36:39], s59 offen offset:2048 sc1
    ds_write_b128 v6, v[20:23] offset:272
    s_waitcnt vmcnt(9)
    v_mfma_f32_16x16x32_bf16 v[36:39], a[20:23], v[116:119], v[36:39]
    v_mfma_f32_16x16x32_bf16 v[40:43], a[4:7], v[100:103], v[40:43]
    ds_write_b128 v6, v[24:27] offset:544
    v_mfma_f32_16x16x32_bf16 v[44:47], a[8:11], v[100:103], v[44:47]
    v_mfma_f32_16x16x32_bf16 v[40:43], a[24:27], v[116:119], v[40:43]
    ds_write_b128 v6, v[28:31] offset:816
    v_mfma_f32_16x16x32_bf16 v[44:47], a[28:31], v[116:119], v[44:47]
    buffer_load_dwordx4 v[156:159], v3, s[36:39], s59 offen offset:3072 sc1
    v_mfma_f32_16x16x32_bf16 v[48:51], a[12:15], v[100:103], v[48:51]
    ds_write_b128 v6, v[32:35] offset:1088
    v_mfma_f32_16x16x32_bf16 v[52:55], a[16:19], v[100:103], v[52:55]
    v_mfma_f32_16x16x32_bf16 v[48:51], a[32:35], v[116:119], v[48:51]
    ds_write_b128 v6, v[36:39] offset:5376
    v_mfma_f32_16x16x32_bf16 v[52:55], a[36:39], v[116:119], v[52:55]
    v_mfma_f32_16x16x32_bf16 v[56:59], a[0:3], v[104:107], v[56:59]
    buffer_load_dwordx4 v[96:99], v3, s[36:39], s60 offen offset:0 sc1
    ds_write_b128 v6, v[40:43] offset:5648
    v_mfma_f32_16x16x32_bf16 v[60:63], a[4:7], v[104:107], v[60:63]
    s_waitcnt vmcnt(10)
    v_mfma_f32_16x16x32_bf16 v[56:59], a[20:23], v[120:123], v[56:59]
    ds_write_b128 v6, v[44:47] offset:5920
    v_mfma_f32_16x16x32_bf16 v[60:63], a[24:27], v[120:123], v[60:63]
    v_mfma_f32_16x16x32_bf16 v[64:67], a[8:11], v[104:107], v[64:67]
    ds_write_b128 v6, v[48:51] offset:6192
    v_mfma_f32_16x16x32_bf16 v[68:71], a[12:15], v[104:107], v[68:71]
    buffer_load_dwordx4 v[100:103], v3, s[36:39], s60 offen offset:1024 sc1
    v_mfma_f32_16x16x32_bf16 v[64:67], a[28:31], v[120:123], v[64:67]
    ds_write_b128 v6, v[52:55] offset:6464
    v_mfma_f32_16x16x32_bf16 v[68:71], a[32:35], v[120:123], v[68:71]
    v_mfma_f32_16x16x32_bf16 v[72:75], a[16:19], v[104:107], v[72:75]
    ds_write_b128 v6, v[56:59] offset:10752
    v_mfma_f32_16x16x32_bf16 v[76:79], a[0:3], v[108:111], v[76:79]
    v_mfma_f32_16x16x32_bf16 v[72:75], a[36:39], v[120:123], v[72:75]
    ds_write_b128 v6, v[60:63] offset:11024
    s_waitcnt vmcnt(10)
    v_mfma_f32_16x16x32_bf16 v[76:79], a[20:23], v[124:127], v[76:79]
    buffer_load_dwordx4 v[104:107], v3, s[36:39], s60 offen offset:2048 sc1
    v_mfma_f32_16x16x32_bf16 v[80:83], a[4:7], v[108:111], v[80:83]
    ds_write_b128 v6, v[64:67] offset:11296
    v_mfma_f32_16x16x32_bf16 v[84:87], a[8:11], v[108:111], v[84:87]
    v_mfma_f32_16x16x32_bf16 v[80:83], a[24:27], v[124:127], v[80:83]
    ds_write_b128 v6, v[68:71] offset:11568
    v_mfma_f32_16x16x32_bf16 v[84:87], a[28:31], v[124:127], v[84:87]
    v_mfma_f32_16x16x32_bf16 v[88:91], a[12:15], v[108:111], v[88:91]
    ds_write_b128 v6, v[72:75] offset:11840
    v_mfma_f32_16x16x32_bf16 v[92:95], a[16:19], v[108:111], v[92:95]
    v_mfma_f32_16x16x32_bf16 v[88:91], a[32:35], v[124:127], v[88:91]
    ds_write_b128 v6, v[76:79] offset:16128
    v_mfma_f32_16x16x32_bf16 v[92:95], a[36:39], v[124:127], v[92:95]
    v_lshlrev_b32 v254, 3, v1
    s_waitcnt vmcnt(10)
    v_mfma_f32_16x16x32_bf16 v[16:19], a[160:163], v[128:131], 0
    buffer_load_dwordx4 v[112:115], v3, s[36:39], s61 offen offset:0 sc1
    ds_write_b128 v6, v[80:83] offset:16400
    v_mfma_f32_16x16x32_bf16 v[20:23], a[164:167], v[128:131], 0
    buffer_load_dwordx4 v[108:111], v3, s[36:39], s60 offen offset:3072 sc1
    v_mfma_f32_16x16x32_bf16 v[24:27], a[168:171], v[128:131], 0
    ds_write_b128 v6, v[84:87] offset:16672
    v_mfma_f32_16x16x32_bf16 v[28:31], a[172:175], v[128:131], 0
    v_mfma_f32_16x16x32_bf16 v[32:35], a[176:179], v[128:131], 0
    ds_write_b128 v6, v[88:91] offset:16944
    s_waitcnt vmcnt(11)
    v_mfma_f32_16x16x32_bf16 v[36:39], a[160:163], v[132:135], 0
    buffer_load_dwordx4 v[116:119], v3, s[36:39], s61 offen offset:1024 sc1
    v_mfma_f32_16x16x32_bf16 v[40:43], a[164:167], v[132:135], 0
    ds_write_b128 v6, v[92:95] offset:17216
    v_mfma_f32_16x16x32_bf16 v[44:47], a[168:171], v[132:135], 0
    v_mfma_f32_16x16x32_bf16 v[48:51], a[172:175], v[132:135], 0
    v_mfma_f32_16x16x32_bf16 v[52:55], a[176:179], v[132:135], 0
    s_waitcnt vmcnt(11)
    v_mfma_f32_16x16x32_bf16 v[56:59], a[160:163], v[136:139], 0
    buffer_load_dwordx4 v[120:123], v3, s[36:39], s61 offen offset:2048 sc1
    v_mfma_f32_16x16x32_bf16 v[60:63], a[164:167], v[136:139], 0
    v_mfma_f32_16x16x32_bf16 v[64:67], a[168:171], v[136:139], 0
    v_mfma_f32_16x16x32_bf16 v[68:71], a[172:175], v[136:139], 0
    v_mfma_f32_16x16x32_bf16 v[72:75], a[176:179], v[136:139], 0
    s_waitcnt vmcnt(11)
    v_mfma_f32_16x16x32_bf16 v[76:79], a[160:163], v[140:143], 0
    s_waitcnt lgkmcnt(0)
    s_barrier
    buffer_load_dwordx4 v[124:127], v3, s[36:39], s61 offen offset:3072 sc1
    ds_read_b128 v[160:163], v7 offset:0
    v_mfma_f32_16x16x32_bf16 v[80:83], a[164:167], v[140:143], 0
    ds_read_b128 v[164:167], v7 offset:21504
    v_mfma_f32_16x16x32_bf16 v[84:87], a[168:171], v[140:143], 0
    ds_read_b128 v[168:171], v7 offset:43008
    v_mfma_f32_16x16x32_bf16 v[88:91], a[172:175], v[140:143], 0
    ds_read_b128 v[172:175], v7 offset:64512
    v_mfma_f32_16x16x32_bf16 v[92:95], a[176:179], v[140:143], 0
    ds_read_b128 v[176:179], v8 offset:0
    s_waitcnt vmcnt(11)
    v_mfma_f32_16x16x32_bf16 v[16:19], a[180:183], v[144:147], v[16:19]
    buffer_load_dwordx4 v[128:131], v3, s[36:39], s62 offen offset:0 sc1
    ds_read_b128 v[180:183], v8 offset:21504
    v_mfma_f32_16x16x32_bf16 v[20:23], a[184:187], v[144:147], v[20:23]
    ds_read_b128 v[184:187], v8 offset:43008
    v_mfma_f32_16x16x32_bf16 v[24:27], a[188:191], v[144:147], v[24:27]
    ds_read_b128 v[188:191], v8 offset:64512
    v_mfma_f32_16x16x32_bf16 v[28:31], a[192:195], v[144:147], v[28:31]
    v_mfma_f32_16x16x32_bf16 v[32:35], a[196:199], v[144:147], v[32:35]
    s_waitcnt vmcnt(11)
    v_mfma_f32_16x16x32_bf16 v[36:39], a[180:183], v[148:151], v[36:39]
    buffer_load_dwordx4 v[132:135], v3, s[36:39], s62 offen offset:1024 sc1
    v_mfma_f32_16x16x32_bf16 v[40:43], a[184:187], v[148:151], v[40:43]
    v_mfma_f32_16x16x32_bf16 v[44:47], a[188:191], v[148:151], v[44:47]
    s_waitcnt lgkmcnt(7)
    v_add_f32 v192, v192, v160
    v_mfma_f32_16x16x32_bf16 v[48:51], a[192:195], v[148:151], v[48:51]
    v_add_f32 v193, v193, v161
    v_mfma_f32_16x16x32_bf16 v[52:55], a[196:199], v[148:151], v[52:55]
    v_add_f32 v194, v194, v162
    v_add_f32 v195, v195, v163
    s_waitcnt vmcnt(11)
    v_mfma_f32_16x16x32_bf16 v[56:59], a[180:183], v[152:155], v[56:59]
    s_waitcnt lgkmcnt(6)
    v_add_f32 v192, v192, v164
    v_add_f32 v193, v193, v165
    buffer_load_dwordx4 v[136:139], v3, s[36:39], s62 offen offset:2048 sc1
    v_mfma_f32_16x16x32_bf16 v[60:63], a[184:187], v[152:155], v[60:63]
    v_add_f32 v194, v194, v166
    v_add_f32 v195, v195, v167
    v_mfma_f32_16x16x32_bf16 v[64:67], a[188:191], v[152:155], v[64:67]
    s_waitcnt lgkmcnt(5)
    v_add_f32 v192, v192, v168
    v_add_f32 v193, v193, v169
    v_mfma_f32_16x16x32_bf16 v[68:71], a[192:195], v[152:155], v[68:71]
    v_add_f32 v194, v194, v170
    v_mfma_f32_16x16x32_bf16 v[72:75], a[196:199], v[152:155], v[72:75]
    v_add_f32 v195, v195, v171
    s_waitcnt lgkmcnt(4)
    v_add_f32 v192, v192, v172
    s_waitcnt vmcnt(11)
    v_mfma_f32_16x16x32_bf16 v[76:79], a[180:183], v[156:159], v[76:79]
    v_add_f32 v193, v193, v173
    v_add_f32 v194, v194, v174
    buffer_load_dwordx4 v[140:143], v3, s[36:39], s62 offen offset:3072 sc1
    v_mfma_f32_16x16x32_bf16 v[80:83], a[184:187], v[156:159], v[80:83]
    v_add_f32 v195, v195, v175
    v_mul_f32 v192, v212, v192
    ds_read_b128 v[160:163], v9 offset:0
    v_mfma_f32_16x16x32_bf16 v[84:87], a[188:191], v[156:159], v[84:87]
    v_mul_f32 v193, v212, v193
    v_mul_f32 v194, v212, v194
    ds_read_b128 v[164:167], v9 offset:21504
    v_mfma_f32_16x16x32_bf16 v[88:91], a[192:195], v[156:159], v[88:91]
    v_mul_f32 v195, v212, v195
    ds_read_b128 v[168:171], v9 offset:43008
    v_cvt_pk_bf16_f32 v192, v192, v193
    v_mfma_f32_16x16x32_bf16 v[92:95], a[196:199], v[156:159], v[92:95]
    v_cvt_pk_bf16_f32 v193, v194, v195
    ds_read_b128 v[172:175], v9 offset:64512
    s_waitcnt vmcnt(11)
    v_mfma_f32_16x16x32_bf16 v[16:19], a[200:203], v[96:99], v[16:19]
    buffer_load_dwordx4 v[144:147], v3, s[36:39], s63 offen offset:0 sc1
    s_waitcnt lgkmcnt(7)
    v_add_f32 v196, v196, v176
    v_mfma_f32_16x16x32_bf16 v[20:23], a[204:207], v[96:99], v[20:23]
    v_add_f32 v197, v197, v177
    v_mfma_f32_16x16x32_bf16 v[24:27], a[208:211], v[96:99], v[24:27]
    v_add_f32 v198, v198, v178
    v_add_f32 v199, v199, v179
    v_mfma_f32_16x16x32_bf16 v[28:31], a[212:215], v[96:99], v[28:31]
    s_waitcnt lgkmcnt(6)
    v_add_f32 v196, v196, v180
    v_add_f32 v197, v197, v181
    v_mfma_f32_16x16x32_bf16 v[32:35], a[216:219], v[96:99], v[32:35]
    v_add_f32 v198, v198, v182
    v_add_f32 v199, v199, v183
    s_waitcnt vmcnt(11)
    v_mfma_f32_16x16x32_bf16 v[36:39], a[200:203], v[100:103], v[36:39]
    s_waitcnt lgkmcnt(5)
    v_add_f32 v196, v196, v184
    v_add_f32 v197, v197, v185
    buffer_load_dwordx4 v[148:151], v3, s[36:39], s63 offen offset:1024 sc1
    v_mfma_f32_16x16x32_bf16 v[40:43], a[204:207], v[100:103], v[40:43]
    v_add_f32 v198, v198, v186
    v_mfma_f32_16x16x32_bf16 v[44:47], a[208:211], v[100:103], v[44:47]
    v_add_f32 v199, v199, v187
    s_waitcnt lgkmcnt(4)
    v_add_f32 v196, v196, v188
    v_mfma_f32_16x16x32_bf16 v[48:51], a[212:215], v[100:103], v[48:51]
    v_add_f32 v197, v197, v189
    v_add_f32 v198, v198, v190
    v_mfma_f32_16x16x32_bf16 v[52:55], a[216:219], v[100:103], v[52:55]
    v_add_f32 v199, v199, v191
    v_mul_f32 v196, v213, v196
    ds_read_b128 v[176:179], v10 offset:0
    s_waitcnt vmcnt(11)
    v_mfma_f32_16x16x32_bf16 v[56:59], a[200:203], v[104:107], v[56:59]
    v_mul_f32 v197, v213, v197
    v_mul_f32 v198, v213, v198
    ds_read_b128 v[180:183], v10 offset:21504
    buffer_load_dwordx4 v[152:155], v3, s[36:39], s63 offen offset:2048 sc1
    v_mfma_f32_16x16x32_bf16 v[60:63], a[204:207], v[104:107], v[60:63]
    v_mul_f32 v199, v213, v199
    ds_read_b128 v[184:187], v10 offset:43008
    v_cvt_pk_bf16_f32 v194, v196, v197
    v_mfma_f32_16x16x32_bf16 v[64:67], a[208:211], v[104:107], v[64:67]
    v_cvt_pk_bf16_f32 v195, v198, v199
    ds_read_b128 v[188:191], v10 offset:64512
    v_mfma_f32_16x16x32_bf16 v[68:71], a[212:215], v[104:107], v[68:71]
    buffer_store_dwordx4 v[192:195], v2, s[12:15], s90 offen offset:0 sc1
    s_waitcnt lgkmcnt(7)
    v_add_f32 v200, v200, v160
    v_mfma_f32_16x16x32_bf16 v[72:75], a[216:219], v[104:107], v[72:75]
    v_add_f32 v201, v201, v161
    s_waitcnt vmcnt(11)
    v_mfma_f32_16x16x32_bf16 v[76:79], a[200:203], v[108:111], v[76:79]
    v_add_f32 v202, v202, v162
    v_add_f32 v203, v203, v163
    buffer_load_dwordx4 v[156:159], v3, s[36:39], s63 offen offset:3072 sc1
    v_mfma_f32_16x16x32_bf16 v[80:83], a[204:207], v[108:111], v[80:83]
    s_waitcnt lgkmcnt(6)
    v_add_f32 v200, v200, v164
    v_add_f32 v201, v201, v165
    v_mfma_f32_16x16x32_bf16 v[84:87], a[208:211], v[108:111], v[84:87]
    v_add_f32 v202, v202, v166
    v_add_f32 v203, v203, v167
    v_mfma_f32_16x16x32_bf16 v[88:91], a[212:215], v[108:111], v[88:91]
    s_waitcnt lgkmcnt(5)
    v_add_f32 v200, v200, v168
    v_add_f32 v201, v201, v169
    v_mfma_f32_16x16x32_bf16 v[92:95], a[216:219], v[108:111], v[92:95]
    v_add_f32 v202, v202, v170
    v_mfma_f32_16x16x32_bf16 v[16:19], a[220:223], v[112:115], v[16:19]
    v_add_f32 v203, v203, v171
    s_waitcnt lgkmcnt(4)
    v_add_f32 v200, v200, v172
    buffer_load_dwordx4 v[96:99], v3, s[36:39], s66 offen offset:0 sc1
    v_mfma_f32_16x16x32_bf16 v[20:23], a[224:227], v[112:115], v[20:23]
    v_add_f32 v201, v201, v173
    v_add_f32 v202, v202, v174
    v_mfma_f32_16x16x32_bf16 v[24:27], a[228:231], v[112:115], v[24:27]
    v_add_f32 v203, v203, v175
    v_mul_f32 v200, v214, v200
    ds_read_b128 v[160:163], v11 offset:0
    v_mfma_f32_16x16x32_bf16 v[28:31], a[232:235], v[112:115], v[28:31]
    v_mul_f32 v201, v214, v201
    v_mul_f32 v202, v214, v202
    ds_read_b128 v[164:167], v11 offset:21504
    v_mfma_f32_16x16x32_bf16 v[32:35], a[236:239], v[112:115], v[32:35]
    v_mul_f32 v203, v214, v203
    ds_read_b128 v[168:171], v11 offset:43008
    v_cvt_pk_bf16_f32 v200, v200, v201
    s_waitcnt vmcnt(12)
    v_mfma_f32_16x16x32_bf16 v[36:39], a[220:223], v[116:119], v[36:39]
    v_cvt_pk_bf16_f32 v201, v202, v203
    ds_read_b128 v[172:175], v11 offset:64512
    buffer_load_dwordx4 v[100:103], v3, s[36:39], s66 offen offset:1024 sc1
    v_mfma_f32_16x16x32_bf16 v[40:43], a[224:227], v[116:119], v[40:43]
    s_waitcnt lgkmcnt(7)
    v_add_f32 v204, v204, v176
    v_mfma_f32_16x16x32_bf16 v[44:47], a[228:231], v[116:119], v[44:47]
    v_add_f32 v205, v205, v177
    v_mfma_f32_16x16x32_bf16 v[48:51], a[232:235], v[116:119], v[48:51]
    v_add_f32 v206, v206, v178
    v_add_f32 v207, v207, v179
    v_mfma_f32_16x16x32_bf16 v[52:55], a[236:239], v[116:119], v[52:55]
    s_waitcnt lgkmcnt(6)
    v_add_f32 v204, v204, v180
    v_add_f32 v205, v205, v181
    s_waitcnt vmcnt(12)
    v_mfma_f32_16x16x32_bf16 v[56:59], a[220:223], v[120:123], v[56:59]
    v_add_f32 v206, v206, v182
    v_add_f32 v207, v207, v183
    buffer_load_dwordx4 v[104:107], v3, s[36:39], s66 offen offset:2048 sc1
    v_mfma_f32_16x16x32_bf16 v[60:63], a[224:227], v[120:123], v[60:63]
    s_waitcnt lgkmcnt(5)
    v_add_f32 v204, v204, v184
    v_add_f32 v205, v205, v185
    v_mfma_f32_16x16x32_bf16 v[64:67], a[228:231], v[120:123], v[64:67]
    v_add_f32 v206, v206, v186
    v_mfma_f32_16x16x32_bf16 v[68:71], a[232:235], v[120:123], v[68:71]
    v_add_f32 v207, v207, v187
    s_waitcnt lgkmcnt(4)
    v_add_f32 v204, v204, v188
    v_mfma_f32_16x16x32_bf16 v[72:75], a[236:239], v[120:123], v[72:75]
    v_add_f32 v205, v205, v189
    v_add_f32 v206, v206, v190
    s_waitcnt vmcnt(12)
    v_mfma_f32_16x16x32_bf16 v[76:79], a[220:223], v[124:127], v[76:79]
    v_add_f32 v207, v207, v191
    v_mul_f32 v204, v215, v204
    buffer_load_dwordx4 v[108:111], v3, s[36:39], s66 offen offset:3072 sc1
    v_mfma_f32_16x16x32_bf16 v[80:83], a[224:227], v[124:127], v[80:83]
    v_mul_f32 v205, v215, v205
    v_mul_f32 v206, v215, v206
    v_mfma_f32_16x16x32_bf16 v[84:87], a[228:231], v[124:127], v[84:87]
    v_mul_f32 v207, v215, v207
    v_cvt_pk_bf16_f32 v202, v204, v205
    v_mfma_f32_16x16x32_bf16 v[88:91], a[232:235], v[124:127], v[88:91]
    v_cvt_pk_bf16_f32 v203, v206, v207
    v_mfma_f32_16x16x32_bf16 v[92:95], a[236:239], v[124:127], v[92:95]
    buffer_store_dwordx4 v[200:203], v2, s[12:15], s90 offen offset:1024 sc1
    s_waitcnt lgkmcnt(3)
    v_add_f32 v208, v208, v160
    s_waitcnt vmcnt(13)
    v_mfma_f32_16x16x32_bf16 v[16:19], a[80:83], v[128:131], v[16:19]
    v_add_f32 v209, v209, v161
    buffer_load_dwordx4 v[112:115], v3, s[36:39], s67 offen offset:0 sc1
    v_mfma_f32_16x16x32_bf16 v[20:23], a[84:87], v[128:131], v[20:23]
    v_add_f32 v210, v210, v162
    v_add_f32 v211, v211, v163
    v_mfma_f32_16x16x32_bf16 v[24:27], a[88:91], v[128:131], v[24:27]
    s_waitcnt lgkmcnt(2)
    v_add_f32 v208, v208, v164
    v_add_f32 v209, v209, v165
    v_mfma_f32_16x16x32_bf16 v[28:31], a[92:95], v[128:131], v[28:31]
    v_add_f32 v210, v210, v166
    v_add_f32 v211, v211, v167
    v_mfma_f32_16x16x32_bf16 v[32:35], a[96:99], v[128:131], v[32:35]
    s_waitcnt lgkmcnt(1)
    v_add_f32 v208, v208, v168
    v_add_f32 v209, v209, v169
    s_waitcnt vmcnt(13)
    v_mfma_f32_16x16x32_bf16 v[36:39], a[80:83], v[132:135], v[36:39]
    v_add_f32 v210, v210, v170
    buffer_load_dwordx4 v[116:119], v3, s[36:39], s67 offen offset:1024 sc1
    v_mfma_f32_16x16x32_bf16 v[40:43], a[84:87], v[132:135], v[40:43]
    v_add_f32 v211, v211, v171
    s_waitcnt lgkmcnt(0)
    v_add_f32 v208, v208, v172
    v_mfma_f32_16x16x32_bf16 v[44:47], a[88:91], v[132:135], v[44:47]
    v_add_f32 v209, v209, v173
    v_add_f32 v210, v210, v174
    v_mfma_f32_16x16x32_bf16 v[48:51], a[92:95], v[132:135], v[48:51]
    v_add_f32 v211, v211, v175
    v_mul_f32 v208, v216, v208
    v_mfma_f32_16x16x32_bf16 v[52:55], a[96:99], v[132:135], v[52:55]
    v_mul_f32 v209, v216, v209
    v_mul_f32 v210, v216, v210
    s_waitcnt vmcnt(13)
    v_mfma_f32_16x16x32_bf16 v[56:59], a[80:83], v[136:139], v[56:59]
    v_mul_f32 v211, v216, v211
    buffer_load_dwordx4 v[120:123], v3, s[36:39], s67 offen offset:2048 sc1
    v_cvt_pk_bf16_f32 v208, v208, v209
    v_mfma_f32_16x16x32_bf16 v[60:63], a[84:87], v[136:139], v[60:63]
    v_cvt_pk_bf16_f32 v209, v210, v211
    v_mfma_f32_16x16x32_bf16 v[64:67], a[88:91], v[136:139], v[64:67]
    buffer_store_dwordx2 v[208:209], v254, s[12:15], s90 offen offset:2048 sc1
    v_mfma_f32_16x16x32_bf16 v[68:71], a[92:95], v[136:139], v[68:71]
    v_mfma_f32_16x16x32_bf16 v[72:75], a[96:99], v[136:139], v[72:75]
    s_waitcnt vmcnt(14)
    v_mfma_f32_16x16x32_bf16 v[76:79], a[80:83], v[140:143], v[76:79]
    buffer_load_dwordx4 v[124:127], v3, s[36:39], s67 offen offset:3072 sc1
    v_mfma_f32_16x16x32_bf16 v[80:83], a[84:87], v[140:143], v[80:83]
    v_mfma_f32_16x16x32_bf16 v[84:87], a[88:91], v[140:143], v[84:87]
    v_mfma_f32_16x16x32_bf16 v[88:91], a[92:95], v[140:143], v[88:91]
    v_mfma_f32_16x16x32_bf16 v[92:95], a[96:99], v[140:143], v[92:95]
    s_waitcnt vmcnt(14)
    v_mfma_f32_16x16x32_bf16 v[16:19], a[100:103], v[144:147], v[16:19]
    buffer_load_dwordx4 v[128:131], v3, s[36:39], s68 offen offset:0 sc1
    v_mfma_f32_16x16x32_bf16 v[20:23], a[104:107], v[144:147], v[20:23]
    v_mfma_f32_16x16x32_bf16 v[24:27], a[108:111], v[144:147], v[24:27]
    v_mfma_f32_16x16x32_bf16 v[28:31], a[112:115], v[144:147], v[28:31]
    v_mfma_f32_16x16x32_bf16 v[32:35], a[116:119], v[144:147], v[32:35]
    buffer_load_dwordx4 v[132:135], v3, s[36:39], s68 offen offset:1024 sc1
    s_waitcnt vmcnt(15)
    v_mfma_f32_16x16x32_bf16 v[36:39], a[100:103], v[148:151], v[36:39]
    v_mfma_f32_16x16x32_bf16 v[40:43], a[104:107], v[148:151], v[40:43]
    v_mfma_f32_16x16x32_bf16 v[44:47], a[108:111], v[148:151], v[44:47]
    v_mfma_f32_16x16x32_bf16 v[48:51], a[112:115], v[148:151], v[48:51]
    buffer_load_dwordx4 v[136:139], v3, s[36:39], s68 offen offset:2048 sc1
    v_mfma_f32_16x16x32_bf16 v[52:55], a[116:119], v[148:151], v[52:55]
    s_waitcnt vmcnt(15)
    v_mfma_f32_16x16x32_bf16 v[56:59], a[100:103], v[152:155], v[56:59]
    v_mfma_f32_16x16x32_bf16 v[60:63], a[104:107], v[152:155], v[60:63]
    s_barrier
    v_lshlrev_b32 v180, 16, v232
    v_mfma_f32_16x16x32_bf16 v[64:67], a[108:111], v[152:155], v[64:67]
    buffer_load_dwordx4 v[140:143], v3, s[36:39], s68 offen offset:3072 sc1
    v_and_b32 v181, s92, v232
    v_mfma_f32_16x16x32_bf16 v[68:71], a[112:115], v[152:155], v[68:71]
    v_lshlrev_b32 v182, 16, v242
    v_and_b32 v183, s92, v242
    v_mfma_f32_16x16x32_bf16 v[72:75], a[116:119], v[152:155], v[72:75]
    v_mul_f32 v180, v180, v182
    s_waitcnt vmcnt(14)
    v_mfma_f32_16x16x32_bf16 v[76:79], a[100:103], v[156:159], v[76:79]
    v_mul_f32 v181, v181, v183
    v_mfma_f32_16x16x32_bf16 v[80:83], a[104:107], v[156:159], v[80:83]
    v_cvt_pk_bf16_f32 v180, v180, v181
    v_mfma_f32_16x16x32_bf16 v[84:87], a[108:111], v[156:159], v[84:87]
    v_lshlrev_b32 v192, 16, v180
    v_and_b32 v193, s92, v180
    v_mfma_f32_16x16x32_bf16 v[88:91], a[112:115], v[156:159], v[88:91]
    v_lshlrev_b32 v180, 16, v233
    v_and_b32 v181, s92, v233
    v_mfma_f32_16x16x32_bf16 v[92:95], a[116:119], v[156:159], v[92:95]
    v_lshlrev_b32 v182, 16, v243
    s_waitcnt vmcnt(13)
    v_mfma_f32_16x16x32_bf16 v[16:19], a[120:123], v[96:99], v[16:19]
    buffer_load_dwordx4 v[144:147], v3, s[36:39], s69 offen offset:0 sc1
    v_and_b32 v183, s92, v243
    v_mfma_f32_16x16x32_bf16 v[20:23], a[124:127], v[96:99], v[20:23]
    v_mul_f32 v180, v180, v182
    v_mul_f32 v181, v181, v183
    v_mfma_f32_16x16x32_bf16 v[24:27], a[128:131], v[96:99], v[24:27]
    v_cvt_pk_bf16_f32 v180, v180, v181
    v_mfma_f32_16x16x32_bf16 v[28:31], a[132:135], v[96:99], v[28:31]
    buffer_load_dwordx4 v[148:151], v3, s[36:39], s69 offen offset:1024 sc1
    v_lshlrev_b32 v194, 16, v180
    v_mfma_f32_16x16x32_bf16 v[32:35], a[136:139], v[96:99], v[32:35]
    v_and_b32 v195, s92, v180
    s_waitcnt vmcnt(14)
    v_mfma_f32_16x16x32_bf16 v[36:39], a[120:123], v[100:103], v[36:39]
    v_lshlrev_b32 v180, 16, v234
    v_and_b32 v181, s92, v234
    v_mfma_f32_16x16x32_bf16 v[40:43], a[124:127], v[100:103], v[40:43]
    buffer_load_dwordx4 v[152:155], v3, s[36:39], s69 offen offset:2048 sc1
    v_lshlrev_b32 v182, 16, v244
    v_mfma_f32_16x16x32_bf16 v[44:47], a[128:131], v[100:103], v[44:47]
    v_and_b32 v183, s92, v244
    v_mul_f32 v180, v180, v182
    v_mfma_f32_16x16x32_bf16 v[48:51], a[132:135], v[100:103], v[48:51]
    v_mul_f32 v181, v181, v183
    v_mfma_f32_16x16x32_bf16 v[52:55], a[136:139], v[100:103], v[52:55]
    buffer_load_dwordx4 v[156:159], v3, s[36:39], s69 offen offset:3072 sc1
    s_waitcnt vmcnt(15)
    v_mfma_f32_16x16x32_bf16 v[56:59], a[120:123], v[104:107], v[56:59]
    v_cvt_pk_bf16_f32 v180, v180, v181
    v_mfma_f32_16x16x32_bf16 v[60:63], a[124:127], v[104:107], v[60:63]
    v_lshlrev_b32 v196, 16, v180
    v_and_b32 v197, s92, v180
    v_mfma_f32_16x16x32_bf16 v[64:67], a[128:131], v[104:107], v[64:67]
    v_lshlrev_b32 v180, 16, v235
    v_and_b32 v181, s92, v235
    v_mfma_f32_16x16x32_bf16 v[68:71], a[132:135], v[104:107], v[68:71]
    v_lshlrev_b32 v182, 16, v245
    v_and_b32 v183, s92, v245
    v_mfma_f32_16x16x32_bf16 v[72:75], a[136:139], v[104:107], v[72:75]
    v_mul_f32 v180, v180, v182
    s_waitcnt vmcnt(14)
    v_mfma_f32_16x16x32_bf16 v[76:79], a[120:123], v[108:111], v[76:79]
    v_mul_f32 v181, v181, v183
    v_mfma_f32_16x16x32_bf16 v[80:83], a[124:127], v[108:111], v[80:83]
    v_cvt_pk_bf16_f32 v180, v180, v181
    v_mfma_f32_16x16x32_bf16 v[84:87], a[128:131], v[108:111], v[84:87]
    v_lshlrev_b32 v198, 16, v180
    v_and_b32 v199, s92, v180
    v_mfma_f32_16x16x32_bf16 v[88:91], a[132:135], v[108:111], v[88:91]
    v_lshlrev_b32 v180, 16, v236
    v_and_b32 v181, s92, v236
    v_mfma_f32_16x16x32_bf16 v[92:95], a[136:139], v[108:111], v[92:95]
    v_lshlrev_b32 v182, 16, v246
    s_waitcnt vmcnt(12)
    v_mfma_f32_16x16x32_bf16 v[16:19], a[140:143], v[112:115], v[16:19]
    v_and_b32 v183, s92, v246
    v_mul_f32 v180, v180, v182
    v_mfma_f32_16x16x32_bf16 v[20:23], a[144:147], v[112:115], v[20:23]
    v_mul_f32 v181, v181, v183
    v_mfma_f32_16x16x32_bf16 v[24:27], a[148:151], v[112:115], v[24:27]
    v_cvt_pk_bf16_f32 v180, v180, v181
    v_mfma_f32_16x16x32_bf16 v[28:31], a[152:155], v[112:115], v[28:31]
    v_lshlrev_b32 v200, 16, v180
    v_and_b32 v201, s92, v180
    v_mfma_f32_16x16x32_bf16 v[32:35], a[156:159], v[112:115], v[32:35]
    v_lshlrev_b32 v180, 16, v237
    s_waitcnt vmcnt(11)
    v_mfma_f32_16x16x32_bf16 v[36:39], a[140:143], v[116:119], v[36:39]
    v_and_b32 v181, s92, v237
    v_lshlrev_b32 v182, 16, v247
    v_mfma_f32_16x16x32_bf16 v[40:43], a[144:147], v[116:119], v[40:43]
    v_and_b32 v183, s92, v247
    v_mul_f32 v180, v180, v182
    v_mfma_f32_16x16x32_bf16 v[44:47], a[148:151], v[116:119], v[44:47]
    v_mul_f32 v181, v181, v183
    v_mfma_f32_16x16x32_bf16 v[48:51], a[152:155], v[116:119], v[48:51]
    v_cvt_pk_bf16_f32 v180, v180, v181
    v_mfma_f32_16x16x32_bf16 v[52:55], a[156:159], v[116:119], v[52:55]
    s_waitcnt vmcnt(9)
    buffer_store_dword v253, v252, s[12:15], 0 offen sc1
    v_mfma_f32_16x16x32_bf16 v[56:59], a[140:143], v[120:123], v[56:59]
    v_lshlrev_b32 v202, 16, v180
    v_and_b32 v203, s92, v180
    v_mfma_f32_16x16x32_bf16 v[60:63], a[144:147], v[120:123], v[60:63]
    v_lshlrev_b32 v180, 16, v238
    v_and_b32 v181, s92, v238
    v_mfma_f32_16x16x32_bf16 v[64:67], a[148:151], v[120:123], v[64:67]
    v_lshlrev_b32 v182, 16, v248
    v_and_b32 v183, s92, v248
    v_mfma_f32_16x16x32_bf16 v[68:71], a[152:155], v[120:123], v[68:71]
    v_mul_f32 v180, v180, v182
    v_mul_f32 v181, v181, v183
    v_mfma_f32_16x16x32_bf16 v[72:75], a[156:159], v[120:123], v[72:75]
    s_waitcnt vmcnt(9)
    v_mfma_f32_16x16x32_bf16 v[76:79], a[140:143], v[124:127], v[76:79]
    v_cvt_pk_bf16_f32 v180, v180, v181
    v_mfma_f32_16x16x32_bf16 v[80:83], a[144:147], v[124:127], v[80:83]
    v_lshlrev_b32 v204, 16, v180
    v_and_b32 v205, s92, v180
    v_mfma_f32_16x16x32_bf16 v[84:87], a[148:151], v[124:127], v[84:87]
    v_lshlrev_b32 v180, 16, v239
    v_and_b32 v181, s92, v239
    v_mfma_f32_16x16x32_bf16 v[88:91], a[152:155], v[124:127], v[88:91]
    v_lshlrev_b32 v182, 16, v249
    v_and_b32 v183, s92, v249
    v_mfma_f32_16x16x32_bf16 v[92:95], a[156:159], v[124:127], v[92:95]
    v_mul_f32 v180, v180, v182
    s_waitcnt vmcnt(8)
    v_mfma_f32_16x16x32_bf16 v[16:19], a[0:3], v[128:131], v[16:19]
    v_mul_f32 v181, v181, v183
    v_mfma_f32_16x16x32_bf16 v[20:23], a[4:7], v[128:131], v[20:23]
    s_waitcnt vmcnt(4)
    v_mfma_f32_16x16x32_bf16 v[16:19], a[20:23], v[144:147], v[16:19]
    v_cvt_pk_bf16_f32 v180, v180, v181
    v_mfma_f32_16x16x32_bf16 v[20:23], a[24:27], v[144:147], v[20:23]
    v_lshlrev_b32 v206, 16, v180
    v_and_b32 v207, s92, v180
    v_mfma_f32_16x16x32_bf16 v[24:27], a[8:11], v[128:131], v[24:27]
    v_lshlrev_b32 v180, 16, v240
    v_and_b32 v181, s92, v240
    v_mfma_f32_16x16x32_bf16 v[28:31], a[12:15], v[128:131], v[28:31]
    v_lshlrev_b32 v182, 16, v250
    v_and_b32 v183, s92, v250
    v_mfma_f32_16x16x32_bf16 v[24:27], a[28:31], v[144:147], v[24:27]
    v_mul_f32 v180, v180, v182
    v_mul_f32 v181, v181, v183
    v_mfma_f32_16x16x32_bf16 v[28:31], a[32:35], v[144:147], v[28:31]
    v_cvt_pk_bf16_f32 v180, v180, v181
    v_mfma_f32_16x16x32_bf16 v[32:35], a[16:19], v[128:131], v[32:35]
    ds_write_b128 v6, v[16:19] offset:0
    v_lshlrev_b32 v208, 16, v180
    v_mfma_f32_16x16x32_bf16 v[36:39], a[0:3], v[132:135], v[36:39]
    buffer_load_dword v5, v4, s[12:15], 0 offen sc1
    v_and_b32 v209, s92, v180
    v_mfma_f32_16x16x32_bf16 v[32:35], a[36:39], v[144:147], v[32:35]
    ds_write_b128 v6, v[20:23] offset:272
    s_waitcnt vmcnt(4)
    v_mfma_f32_16x16x32_bf16 v[36:39], a[20:23], v[148:151], v[36:39]
    v_lshlrev_b32 v180, 16, v241
    v_and_b32 v181, s92, v241
    v_mfma_f32_16x16x32_bf16 v[40:43], a[4:7], v[132:135], v[40:43]
    ds_write_b128 v6, v[24:27] offset:544
    v_lshlrev_b32 v182, 16, v251
    v_mfma_f32_16x16x32_bf16 v[44:47], a[8:11], v[132:135], v[44:47]
    v_and_b32 v183, s92, v251
    v_mul_f32 v180, v180, v182
    v_mfma_f32_16x16x32_bf16 v[40:43], a[24:27], v[148:151], v[40:43]
    ds_write_b128 v6, v[28:31] offset:816
    v_mul_f32 v181, v181, v183
    v_mfma_f32_16x16x32_bf16 v[44:47], a[28:31], v[148:151], v[44:47]
    v_cvt_pk_bf16_f32 v180, v180, v181
    v_mfma_f32_16x16x32_bf16 v[48:51], a[12:15], v[132:135], v[48:51]
    ds_write_b128 v6, v[32:35] offset:1088
    v_lshlrev_b32 v210, 16, v180
    v_mfma_f32_16x16x32_bf16 v[52:55], a[16:19], v[132:135], v[52:55]
    v_and_b32 v211, s92, v180
    v_mfma_f32_16x16x32_bf16 v[48:51], a[32:35], v[148:151], v[48:51]
    ds_write_b128 v6, v[36:39] offset:5376
    v_mfma_f32_16x16x32_bf16 v[52:55], a[36:39], v[148:151], v[52:55]
    v_mfma_f32_16x16x32_bf16 v[56:59], a[0:3], v[136:139], v[56:59]
    ds_write_b128 v6, v[40:43] offset:5648
    v_mfma_f32_16x16x32_bf16 v[60:63], a[4:7], v[136:139], v[60:63]
    s_waitcnt vmcnt(3)
    v_mfma_f32_16x16x32_bf16 v[56:59], a[20:23], v[152:155], v[56:59]
    ds_write_b128 v6, v[44:47] offset:5920
    v_mfma_f32_16x16x32_bf16 v[60:63], a[24:27], v[152:155], v[60:63]
    v_mfma_f32_16x16x32_bf16 v[64:67], a[8:11], v[136:139], v[64:67]
    ds_write_b128 v6, v[48:51] offset:6192
    v_mfma_f32_16x16x32_bf16 v[68:71], a[12:15], v[136:139], v[68:71]
    v_mfma_f32_16x16x32_bf16 v[64:67], a[28:31], v[152:155], v[64:67]
    ds_write_b128 v6, v[52:55] offset:6464
    v_mfma_f32_16x16x32_bf16 v[68:71], a[32:35], v[152:155], v[68:71]
    v_mfma_f32_16x16x32_bf16 v[72:75], a[16:19], v[136:139], v[72:75]
    ds_write_b128 v6, v[56:59] offset:10752
    v_mfma_f32_16x16x32_bf16 v[76:79], a[0:3], v[140:143], v[76:79]
    v_mfma_f32_16x16x32_bf16 v[72:75], a[36:39], v[152:155], v[72:75]
    ds_write_b128 v6, v[60:63] offset:11024
    s_waitcnt vmcnt(2)
    v_mfma_f32_16x16x32_bf16 v[76:79], a[20:23], v[156:159], v[76:79]
    v_mfma_f32_16x16x32_bf16 v[80:83], a[4:7], v[140:143], v[80:83]
    ds_write_b128 v6, v[64:67] offset:11296
    v_mfma_f32_16x16x32_bf16 v[84:87], a[8:11], v[140:143], v[84:87]
    v_mfma_f32_16x16x32_bf16 v[80:83], a[24:27], v[156:159], v[80:83]
    ds_write_b128 v6, v[68:71] offset:11568
    v_mfma_f32_16x16x32_bf16 v[84:87], a[28:31], v[156:159], v[84:87]
    v_mfma_f32_16x16x32_bf16 v[88:91], a[12:15], v[140:143], v[88:91]
    ds_write_b128 v6, v[72:75] offset:11840
    v_mfma_f32_16x16x32_bf16 v[92:95], a[16:19], v[140:143], v[92:95]
    v_mfma_f32_16x16x32_bf16 v[88:91], a[32:35], v[156:159], v[88:91]
    ds_write_b128 v6, v[76:79] offset:16128
    v_mfma_f32_16x16x32_bf16 v[92:95], a[36:39], v[156:159], v[92:95]
    ds_write_b128 v6, v[80:83] offset:16400
    s_nop 0
    ds_write_b128 v6, v[84:87] offset:16672
    s_nop 2
    ds_write_b128 v6, v[88:91] offset:16944
    s_nop 0
    ds_write_b128 v6, v[92:95] offset:17216
    s_waitcnt vmcnt(0)
    v_cmp_ne_u32 vcc, s78, v5
    s_nop 0
    s_cmp_eq_u64 vcc, 0
    s_cbranch_scc0 L_xf_retry_23
L_xf_ok_24:
    buffer_load_dwordx4 v[170:173], v2, s[12:15], s91 offen offset:0 sc1
    buffer_load_dwordx4 v[174:177], v2, s[12:15], s91 offen offset:1024 sc1
    buffer_load_dwordx2 v[178:179], v254, s[12:15], s91 offen offset:2048 sc1
    s_waitcnt lgkmcnt(0)
    s_barrier
    ds_read_b128 v[16:19], v7 offset:0
    ds_read_b128 v[20:23], v7 offset:21504
    ds_read_b128 v[24:27], v7 offset:43008
    ds_read_b128 v[28:31], v7 offset:64512
    ds_read_b128 v[32:35], v8 offset:0
    ds_read_b128 v[36:39], v8 offset:21504
    ds_read_b128 v[40:43], v8 offset:43008
    ds_read_b128 v[44:47], v8 offset:64512
    ds_read_b128 v[48:51], v9 offset:0
    ds_read_b128 v[52:55], v9 offset:21504
    ds_read_b128 v[56:59], v9 offset:43008
    ds_read_b128 v[60:63], v9 offset:64512
    ds_read_b128 v[64:67], v10 offset:0
    ds_read_b128 v[68:71], v10 offset:21504
    ds_read_b128 v[72:75], v10 offset:43008
    ds_read_b128 v[76:79], v10 offset:64512
    ds_read_b128 v[80:83], v11 offset:0
    ds_read_b128 v[84:87], v11 offset:21504
    ds_read_b128 v[88:91], v11 offset:43008
    ds_read_b128 v[92:95], v11 offset:64512
    s_waitcnt lgkmcnt(15)
    v_pk_add_f32 v[192:193], v[192:193], v[16:17]
    v_pk_add_f32 v[194:195], v[194:195], v[18:19]
    v_pk_add_f32 v[192:193], v[192:193], v[20:21]
    v_pk_add_f32 v[194:195], v[194:195], v[22:23]
    v_pk_add_f32 v[192:193], v[192:193], v[24:25]
    v_pk_add_f32 v[194:195], v[194:195], v[26:27]
    v_pk_add_f32 v[192:193], v[192:193], v[28:29]
    v_pk_add_f32 v[194:195], v[194:195], v[30:31]
    v_pk_add_f32 v[196:197], v[196:197], v[32:33]
    v_pk_add_f32 v[198:199], v[198:199], v[34:35]
    s_waitcnt lgkmcnt(14)
    v_pk_add_f32 v[196:197], v[196:197], v[36:37]
    v_pk_add_f32 v[198:199], v[198:199], v[38:39]
    s_waitcnt lgkmcnt(13)
    v_pk_add_f32 v[196:197], v[196:197], v[40:41]
    v_pk_add_f32 v[198:199], v[198:199], v[42:43]
    s_waitcnt lgkmcnt(12)
    v_pk_add_f32 v[196:197], v[196:197], v[44:45]
    v_pk_add_f32 v[198:199], v[198:199], v[46:47]
    s_waitcnt lgkmcnt(11)
    v_pk_add_f32 v[200:201], v[200:201], v[48:49]
    v_pk_add_f32 v[202:203], v[202:203], v[50:51]
    s_waitcnt lgkmcnt(10)
    v_pk_add_f32 v[200:201], v[200:201], v[52:53]
    v_pk_add_f32 v[202:203], v[202:203], v[54:55]
    s_waitcnt lgkmcnt(9)
    v_pk_add_f32 v[200:201], v[200:201], v[56:57]
    v_pk_add_f32 v[202:203], v[202:203], v[58:59]
    s_waitcnt lgkmcnt(8)
    v_pk_add_f32 v[200:201], v[200:201], v[60:61]
    v_pk_add_f32 v[202:203], v[202:203], v[62:63]
    s_waitcnt lgkmcnt(7)
    v_pk_add_f32 v[204:205], v[204:205], v[64:65]
    v_pk_add_f32 v[206:207], v[206:207], v[66:67]
    s_waitcnt lgkmcnt(6)
    v_pk_add_f32 v[204:205], v[204:205], v[68:69]
    v_pk_add_f32 v[206:207], v[206:207], v[70:71]
    s_waitcnt lgkmcnt(5)
    v_pk_add_f32 v[204:205], v[204:205], v[72:73]
    v_pk_add_f32 v[206:207], v[206:207], v[74:75]
    s_waitcnt lgkmcnt(4)
    v_pk_add_f32 v[204:205], v[204:205], v[76:77]
    v_pk_add_f32 v[206:207], v[206:207], v[78:79]
    s_waitcnt lgkmcnt(3)
    v_pk_add_f32 v[208:209], v[208:209], v[80:81]
    v_pk_add_f32 v[210:211], v[210:211], v[82:83]
    s_waitcnt lgkmcnt(2)
    v_pk_add_f32 v[208:209], v[208:209], v[84:85]
    v_pk_add_f32 v[210:211], v[210:211], v[86:87]
    s_waitcnt lgkmcnt(1)
    v_pk_add_f32 v[208:209], v[208:209], v[88:89]
    v_pk_add_f32 v[210:211], v[210:211], v[90:91]
    s_waitcnt lgkmcnt(0)
    v_pk_add_f32 v[208:209], v[208:209], v[92:93]
    v_pk_add_f32 v[210:211], v[210:211], v[94:95]
    s_waitcnt vmcnt(2)
    v_lshlrev_b32 v160, 16, v170
    v_and_b32 v161, s92, v170
    v_lshlrev_b32 v162, 16, v171
    v_and_b32 v163, s92, v171
    v_pk_fma_f32 v[160:161], v[216:217], v[192:193], v[160:161] op_sel:[1,0,0] op_sel_hi:[1,1,1]
    v_pk_fma_f32 v[162:163], v[216:217], v[194:195], v[162:163] op_sel:[1,0,0] op_sel_hi:[1,1,1]
    buffer_store_dwordx4 v[160:163], v12, s[28:31], 0 offen nt
    v_lshlrev_b32 v164, 16, v172
    v_and_b32 v165, s92, v172
    v_lshlrev_b32 v166, 16, v173
    v_and_b32 v167, s92, v173
    v_pk_fma_f32 v[164:165], v[218:219], v[196:197], v[164:165] op_sel:[0,0,0] op_sel_hi:[0,1,1]
    v_pk_fma_f32 v[166:167], v[218:219], v[198:199], v[166:167] op_sel:[0,0,0] op_sel_hi:[0,1,1]
    buffer_store_dwordx4 v[164:167], v13, s[28:31], 0 offen nt
    s_waitcnt vmcnt(3)
    v_lshlrev_b32 v168, 16, v174
    v_and_b32 v169, s92, v174
    v_lshlrev_b32 v170, 16, v175
    v_and_b32 v171, s92, v175
    v_pk_fma_f32 v[168:169], v[218:219], v[200:201], v[168:169] op_sel:[1,0,0] op_sel_hi:[1,1,1]
    v_pk_fma_f32 v[170:171], v[218:219], v[202:203], v[170:171] op_sel:[1,0,0] op_sel_hi:[1,1,1]
    buffer_store_dwordx4 v[168:171], v14, s[28:31], 0 offen nt
    v_lshlrev_b32 v172, 16, v176
    v_and_b32 v173, s92, v176
    v_lshlrev_b32 v174, 16, v177
    v_and_b32 v175, s92, v177
    v_pk_fma_f32 v[172:173], v[220:221], v[204:205], v[172:173] op_sel:[0,0,0] op_sel_hi:[0,1,1]
    v_pk_fma_f32 v[174:175], v[220:221], v[206:207], v[174:175] op_sel:[0,0,0] op_sel_hi:[0,1,1]
    buffer_store_dwordx4 v[172:175], v15, s[28:31], 0 offen nt
    s_waitcnt vmcnt(4)
    v_lshlrev_b32 v176, 16, v178
    v_and_b32 v177, s92, v178
    v_lshlrev_b32 v178, 16, v179
    v_and_b32 v179, s92, v179
    v_pk_fma_f32 v[176:177], v[220:221], v[208:209], v[176:177] op_sel:[1,0,0] op_sel_hi:[1,1,1]
    v_pk_fma_f32 v[178:179], v[220:221], v[210:211], v[178:179] op_sel:[1,0,0] op_sel_hi:[1,1,1]
    buffer_store_dwordx4 v[176:179], v0, s[28:31], 0 offen nt
L_exit:
    s_endpgm
L_pk_retry_1:
    s_mov_b32 s3, 0x40000
L_pk_loop_25:
    s_sub_u32 s3, s3, 1
    s_cmp_eq_u32 s3, 0
    s_nop 7
    s_cbranch_scc1 L_pk_ok_2
    s_waitcnt lgkmcnt(0)
    buffer_load_dword v13, v159, s[12:15], 0 offen sc1
    s_waitcnt vmcnt(0)
    v_cmp_ne_u32 vcc, s78, v13
    s_nop 0
    s_cmp_eq_u64 vcc, 0
    s_nop 7
    s_cbranch_scc1 L_pk_ok_2
    s_branch L_pk_loop_25
L_h10_retry_3:
    s_mov_b32 s3, 0x40000
L_h10_loop_26:
    s_sub_u32 s3, s3, 1
    s_cmp_eq_u32 s3, 0
    s_nop 7
    s_cbranch_scc1 L_h10_ok_4
    s_waitcnt lgkmcnt(0)
    s_mov_b32 s64, 0x30000
    s_and_b32 s65, s3, 3
    s_cbranch_scc1 L_ld_28
    s_mov_b32 s64, 0x0
L_ld_28:
    buffer_load_dword v5, v4, s[12:15], s64 offen sc1
    s_waitcnt vmcnt(0)
    v_cmp_ne_u32 vcc, s78, v5
    s_nop 0
    s_cmp_eq_u64 vcc, 0
    s_nop 7
    s_cbranch_scc1 L_h10_ok_4
    s_branch L_h10_loop_26
L_h11_retry_5:
    s_mov_b32 s3, 0x40000
L_h11_loop_29:
    s_sub_u32 s3, s3, 1
    s_cmp_eq_u32 s3, 0
    s_nop 7
    s_cbranch_scc1 L_h11_ok_6
    s_waitcnt lgkmcnt(0)
    s_mov_b32 s64, 0xa0000
    s_and_b32 s65, s3, 3
    s_cbranch_scc1 L_ld_31
    s_mov_b32 s64, 0x20000
L_ld_31:
    buffer_load_dword v5, v4, s[12:15], s64 offen sc1
    s_waitcnt vmcnt(0)
    v_cmp_ne_u32 vcc, s78, v5
    s_nop 0
    s_cmp_eq_u64 vcc, 0
    s_nop 7
    s_cbranch_scc1 L_h11_ok_6
    s_branch L_h11_loop_29
L_h12_retry_7:
    s_mov_b32 s3, 0x40000
L_h12_loop_32:
    s_sub_u32 s3, s3, 1
    s_cmp_eq_u32 s3, 0
    s_nop 7
    s_cbranch_scc1 L_h12_ok_8
    s_waitcnt lgkmcnt(0)
    s_mov_b32 s64, 0x70000
    s_and_b32 s65, s3, 3
    s_cbranch_scc1 L_ld_34
    s_mov_b32 s64, 0x40000
L_ld_34:
    buffer_load_dword v5, v4, s[12:15], s64 offen sc1
    s_waitcnt vmcnt(0)
    v_cmp_ne_u32 vcc, s78, v5
    s_nop 0
    s_cmp_eq_u64 vcc, 0
    s_nop 7
    s_cbranch_scc1 L_h12_ok_8
    s_branch L_h12_loop_32
L_gt_retry_9:
    s_mov_b32 s3, 0x40000
L_gt_loop_35:
    s_sub_u32 s3, s3, 1
    s_cmp_eq_u32 s3, 0
    s_nop 7
    s_cbranch_scc1 L_gt_ok_10
    s_waitcnt lgkmcnt(0)
    buffer_load_dwordx3 v[166:168], v165, s[12:15], 0 offen sc1
    s_waitcnt vmcnt(0)
    v_cmp_ne_u32 vcc, s78, v167
    s_nop 0
    s_cmp_eq_u64 vcc, 0
    s_nop 7
    s_cbranch_scc1 L_gt_ok_10
    s_branch L_gt_loop_35
L_up_retry_11:
    s_mov_b32 s3, 0x40000
L_up_loop_36:
    s_sub_u32 s3, s3, 1
    s_cmp_eq_u32 s3, 0
    s_nop 7
    s_cbranch_scc1 L_up_ok_12
    s_waitcnt lgkmcnt(0)
    s_mov_b32 s64, 786432
    buffer_load_dword v186, v190, s[24:27], s64 offen sc1
    s_mov_b32 s64, 819200
    buffer_load_dword v187, v190, s[24:27], s64 offen sc1
    s_mov_b32 s64, 327680
    buffer_load_dword v188, v190, s[24:27], s64 offen sc1
    s_mov_b32 s64, 360448
    buffer_load_dword v189, v190, s[24:27], s64 offen sc1
    s_waitcnt vmcnt(0)
    v_xor_b32 v184, s78, v186
    v_xor_b32 v185, s78, v187
    v_or_b32 v184, v184, v185
    v_xor_b32 v185, s78, v188
    v_or_b32 v184, v184, v185
    v_xor_b32 v185, s78, v189
    v_or_b32 v184, v184, v185
    v_cmp_ne_u32 vcc, 0, v184
    s_nop 0
    s_cmp_eq_u64 vcc, 0
    s_cselect_b32 s64, 0, s26
    s_cmp_eq_u32 s64, 0
    s_nop 7
    s_cbranch_scc1 L_up_ok_12
    s_branch L_up_loop_36
L_xf_retry_13:
    s_mov_b32 s3, 0x40000
L_xf_loop_37:
    s_sub_u32 s3, s3, 1
    s_cmp_eq_u32 s3, 0
    s_nop 7
    s_cbranch_scc1 L_xf_ok_14
    s_waitcnt lgkmcnt(0)
    buffer_load_dword v5, v4, s[12:15], 0 offen sc1
    s_waitcnt vmcnt(0)
    v_cmp_ne_u32 vcc, s78, v5
    s_nop 0
    s_cmp_eq_u64 vcc, 0
    s_nop 7
    s_cbranch_scc1 L_xf_ok_14
    s_branch L_xf_loop_37
L_pk_retry_15:
    s_mov_b32 s3, 0x40000
L_pk_loop_38:
    s_sub_u32 s3, s3, 1
    s_cmp_eq_u32 s3, 0
    s_nop 7
    s_cbranch_scc1 L_pk_ok_16
    s_waitcnt lgkmcnt(0)
    buffer_load_dword v13, v159, s[12:15], 0 offen sc1
    s_waitcnt vmcnt(0)
    v_cmp_ne_u32 vcc, s78, v13
    s_nop 0
    s_cmp_eq_u64 vcc, 0
    s_nop 7
    s_cbranch_scc1 L_pk_ok_16
    s_branch L_pk_loop_38
L_carry_retry_17:
    s_mov_b32 s3, 0x40000
L_carry_loop_39:
    s_sub_u32 s3, s3, 1
    s_cmp_eq_u32 s3, 0
    s_nop 7
    s_cbranch_scc1 L_carry_ok_18
    s_waitcnt lgkmcnt(0)
    buffer_load_dwordx3 v[180:182], v140, s[12:15], 0 offen sc1
    buffer_load_dwordx3 v[184:186], v141, s[12:15], 0 offen sc1
    buffer_load_dwordx3 v[188:190], v142, s[12:15], 0 offen sc1
    buffer_load_dwordx3 v[192:194], v143, s[12:15], 0 offen sc1
    buffer_load_dwordx3 v[196:198], v144, s[12:15], 0 offen sc1
    s_waitcnt vmcnt(0)
    v_xor_b32 v183, v149, v198
    v_xor_b32 v187, v148, v194
    v_or_b32 v183, v183, v187
    v_xor_b32 v187, v147, v190
    v_or_b32 v183, v183, v187
    v_xor_b32 v187, v146, v186
    v_or_b32 v183, v183, v187
    v_xor_b32 v187, v145, v182
    v_or_b32 v183, v183, v187
    v_cmp_ne_u32 vcc, 0, v183
    s_nop 0
    s_cmp_eq_u64 vcc, 0
    s_nop 7
    s_cbranch_scc1 L_carry_ok_18
    s_branch L_carry_loop_39
L_h00_retry_19:
    s_mov_b32 s3, 0x40000
L_h00_loop_40:
    s_sub_u32 s3, s3, 1
    s_cmp_eq_u32 s3, 0
    s_nop 7
    s_cbranch_scc1 L_h00_ok_20
    s_waitcnt lgkmcnt(0)
    s_mov_b32 s64, 0x20000
    s_and_b32 s65, s3, 3
    s_cbranch_scc1 L_ld_42
    s_mov_b32 s64, 0x0
L_ld_42:
    buffer_load_dword v5, v4, s[12:15], s64 offen sc1
    s_waitcnt vmcnt(0)
    v_cmp_ne_u32 vcc, s78, v5
    s_nop 0
    s_cmp_eq_u64 vcc, 0
    s_nop 7
    s_cbranch_scc1 L_h00_ok_20
    s_branch L_h00_loop_40
L_gt_retry_21:
    s_mov_b32 s3, 0x40000
L_gt_loop_43:
    s_sub_u32 s3, s3, 1
    s_cmp_eq_u32 s3, 0
    s_nop 7
    s_cbranch_scc1 L_gt_ok_22
    s_waitcnt lgkmcnt(0)
    buffer_load_dwordx3 v[166:168], v165, s[12:15], 0 offen sc1
    s_waitcnt vmcnt(0)
    v_cmp_ne_u32 vcc, s78, v167
    s_nop 0
    s_cmp_eq_u64 vcc, 0
    s_nop 7
    s_cbranch_scc1 L_gt_ok_22
    s_branch L_gt_loop_43
L_xf_retry_23:
    s_mov_b32 s3, 0x40000
L_xf_loop_44:
    s_sub_u32 s3, s3, 1
    s_cmp_eq_u32 s3, 0
    s_nop 7
    s_cbranch_scc1 L_xf_ok_24
    s_waitcnt lgkmcnt(0)
    buffer_load_dword v5, v4, s[12:15], 0 offen sc1
    s_waitcnt vmcnt(0)
    v_cmp_ne_u32 vcc, s78, v5
    s_nop 0
    s_cmp_eq_u64 vcc, 0
    s_nop 7
    s_cbranch_scc1 L_xf_ok_24
    s_branch L_xf_loop_44
    s_endpgm
    s_endpgm
    s_endpgm
    s_endpgm
    s_endpgm
    s_endpgm
    s_endpgm
    s_endpgm
    s_endpgm
    s_endpgm
    s_endpgm
    s_endpgm
    s_endpgm
    s_endpgm
    s_endpgm
    s_endpgm
    s_endpgm
    s_endpgm
    s_endpgm
    s_endpgm
    s_endpgm
    s_endpgm
    s_endpgm
    s_endpgm
    s_endpgm
    s_endpgm
    s_endpgm
    s_endpgm
    s_endpgm
    s_endpgm
    s_endpgm
    s_endpgm
    s_endpgm
    s_endpgm
    s_endpgm
    s_endpgm
    s_endpgm
    s_endpgm
    s_endpgm
    s_endpgm
    s_endpgm
    s_endpgm
    s_endpgm
    s_endpgm
    s_endpgm
    s_endpgm
    s_endpgm
    s_endpgm
    s_endpgm
    s_endpgm
    s_endpgm
    s_endpgm
    s_endpgm
    s_endpgm
    s_endpgm
    s_endpgm
    s_endpgm
    s_endpgm
    s_endpgm
    s_endpgm
    s_endpgm
    s_endpgm
    s_endpgm
    s_endpgm
    s_endpgm
    s_endpgm
    s_endpgm
    s_endpgm
    s_endpgm
    s_endpgm
    s_endpgm
    s_endpgm
    s_endpgm
    s_endpgm
    s_endpgm
    s_endpgm
    s_endpgm
    s_endpgm
    s_endpgm
    s_endpgm
    s_endpgm
    s_endpgm
    s_endpgm
    s_endpgm
    s_endpgm
    s_endpgm
    s_endpgm
    s_endpgm
    s_endpgm
    s_endpgm
    s_endpgm
    s_endpgm
    s_endpgm
    s_endpgm
    s_endpgm
    s_endpgm
    s_endpgm
    s_endpgm
    s_endpgm
    s_endpgm
    s_endpgm
    s_endpgm
    s_endpgm
    s_endpgm
    s_endpgm
    s_endpgm
    s_endpgm
    s_endpgm
    s_endpgm
    s_endpgm
    s_endpgm
    s_endpgm
    s_endpgm
    s_endpgm
    s_endpgm
    s_endpgm
    s_endpgm
    s_endpgm
    s_endpgm
    s_endpgm
    s_endpgm
    s_endpgm
    s_endpgm
    s_endpgm
    s_endpgm
    s_endpgm
    s_endpgm
    s_endpgm
    s_endpgm
    s_endpgm
    s_endpgm
    s_endpgm
    s_endpgm
    s_endpgm
    s_endpgm
    s_endpgm
    s_endpgm
    s_endpgm
    s_endpgm
    s_endpgm
    s_endpgm
    s_endpgm
    s_endpgm
    s_endpgm
    s_endpgm
    s_endpgm
    s_endpgm
    s_endpgm
    s_endpgm
    s_endpgm
    s_endpgm
    s_endpgm
    s_endpgm
    s_endpgm
    s_endpgm
    s_endpgm
    s_endpgm
    s_endpgm
    s_endpgm
    s_endpgm
    s_endpgm
    s_endpgm
    s_endpgm
    s_endpgm
    s_endpgm
    s_endpgm
    s_endpgm
    s_endpgm
    s_endpgm
    s_endpgm
    s_endpgm
    s_endpgm
    s_endpgm
    s_endpgm
    s_endpgm
    s_endpgm
    s_endpgm
    s_endpgm
    s_endpgm
    s_endpgm
    s_endpgm
    s_endpgm
    s_endpgm
    s_endpgm
    s_endpgm
    s_endpgm
    s_endpgm
    s_endpgm
    s_endpgm
    s_endpgm
    s_endpgm
    s_endpgm
    s_endpgm
    s_endpgm
    s_endpgm
    s_endpgm
    s_endpgm
    s_endpgm
    s_endpgm
    s_endpgm
    s_endpgm
    s_endpgm
    s_endpgm
    s_endpgm
    s_endpgm
    s_endpgm
    s_endpgm
    s_endpgm
    s_endpgm
    s_endpgm
    s_endpgm
    s_endpgm
    s_endpgm
    s_endpgm
    s_endpgm
    s_endpgm
    s_endpgm
    s_endpgm
    s_endpgm
    s_endpgm
    s_endpgm
    s_endpgm
    s_endpgm
    s_endpgm
    s_endpgm
    s_endpgm
    s_endpgm
    s_endpgm
    s_endpgm
    s_endpgm
    s_endpgm
    s_endpgm
    s_endpgm
    s_endpgm
    s_endpgm
    s_endpgm
    s_endpgm
    s_endpgm
    s_endpgm
    s_endpgm
    s_endpgm
    s_endpgm
    s_endpgm
    s_endpgm
    s_endpgm
    s_endpgm
    s_endpgm
    s_endpgm
    s_endpgm
    s_endpgm
    s_endpgm
    s_endpgm
    s_endpgm
    s_endpgm
    s_endpgm
    s_endpgm
L_codeend:
.section .rodata,"a"
.p2align 6
.amdhsa_kernel gated_mix__ssm_conv_s5__dense_activation_silu__prompt_kernel
  .amdhsa_next_free_vgpr 512
  .amdhsa_next_free_sgpr 102
  .amdhsa_accum_offset 256
  .amdhsa_group_segment_fixed_size 0
  .amdhsa_kernarg_size 128
  .amdhsa_user_sgpr_count 2
  .amdhsa_user_sgpr_kernarg_segment_ptr 1
  .amdhsa_system_sgpr_workgroup_id_x 1
.end_amdhsa_kernel
```
